```python
import torch

def _softmax(x, axis=-1):
    return torch.softmax(x, dim=axis)
def _gelu(x):
    return torch.nn.functional.gelu(x, approximate="tanh")
def _silu(x):
    return torch.nn.functional.silu(x)
def _sigmoid(x):
    return torch.sigmoid(x)
def _layernorm(x, axis=-1, eps=1e-5):
    m = x.mean(dim=axis, keepdim=True)
    v = x.var(dim=axis, keepdim=True, unbiased=False)
    return (x - m) / torch.sqrt(v + eps)
def _scatter_add(tgt, idx, src, axis=0):
    return tgt.clone().index_add_(axis, idx, src)
def _segment_sum(src, seg, n):
    out = torch.zeros((n,) + src.shape[1:], dtype=src.dtype)
    return out.index_add_(0, seg, src)
def _pad(x, pw):
    flat = tuple(v for pair in reversed(pw) for v in pair)
    return torch.nn.functional.pad(x, flat)

kernel_name = 'gated_mix__sliding_block__ssm_conv_h3__prompt'

def setup_inputs():

    _w = (lambda a: (lambda t: t.to(torch.bfloat16) if t.is_floating_point() else t)(torch.as_tensor(a)))
    def _A_setup():
        B, S, D = 1, 2048, 512
        return {
            "x": _w((lambda *s: torch.randn(*s, dtype=torch.bfloat16) * 0.05)(B, S, D)),
            "wqkv": _w((lambda *s: torch.randn(*s, dtype=torch.bfloat16) * 0.8)(D, 3 * D)),
            "wo": _w((lambda *s: torch.randn(*s, dtype=torch.bfloat16) * 0.05)(D, D)),
        }
    _A_in = _A_setup()

    def _B_setup():
        B, S, D = 1, 2048, 512
        ks = 4
        return {
            "q": _w((lambda *s: torch.randn(*s, dtype=torch.bfloat16) * 0.05)(B, S, D)),
            "k": _w((lambda *s: torch.randn(*s, dtype=torch.bfloat16) * 0.8)(B, S, D)),
            "v": _w((lambda *s: torch.randn(*s, dtype=torch.bfloat16) * 0.8)(B, S, D)),
            "shift_k": _w((lambda *s: torch.randn(*s, dtype=torch.bfloat16) * 0.8)(D, ks) * 0.5),
            "ssm_k": _w((lambda *s: torch.randn(*s, dtype=torch.bfloat16) * 1.6)(D, S) * (1.0 / S ** 0.5)),
            "ssm_D": _w((lambda *s: torch.randn(*s, dtype=torch.bfloat16) * 0.8)(D)),
        }
    _B_in = _B_setup()

    return {
        "A_x": _A_in["x"],
        "A_wqkv": _A_in["wqkv"],
        "A_wo": _A_in["wo"],
        "B_q": _B_in["q"],
        "B_k": _B_in["k"],
        "B_v": _B_in["v"],
        "B_shift_k": _B_in["shift_k"],
        "B_ssm_k": _B_in["ssm_k"],
        "B_ssm_D": _B_in["ssm_D"],
        "gate_w": _w((lambda *s: torch.randn(*s, dtype=torch.bfloat16) * 0.05)(512) * 16.0),
    }

def reference(A_x, A_wqkv, A_wo, B_q, B_k, B_v, B_shift_k, B_ssm_k, B_ssm_D, gate_w):
    def _A_ref(x, wqkv, wo):
        B, S, D = x.shape
        H = 32; Dh = D // H; W = 256
        qkv = (lambda x, *d: x.permute(*d))((x @ wqkv).reshape(B, S, 3, H, Dh), 2, 0, 3, 1, 4)
        q, k, v = qkv[0], qkv[1], qkv[2]
        scores = torch.einsum("bhqd,bhkd->bhqk", q, k) * (Dh ** -0.5)
        idx = torch.arange(S)
        mask = (idx[:, None] - idx[None, :] >= 0) & (idx[:, None] - idx[None, :] < W)
        scores = torch.where(mask[None, None], scores, -1e9)
        p = _softmax(scores, axis=-1)
        o = torch.einsum("bhqk,bhkd->bhqd", p, v)
        return (lambda x, *d: x.permute(*d))(o, 0, 2, 1, 3).reshape(B, S, D) @ wo

    def _B_ref(q, k, v, shift_k, ssm_k, ssm_D):
        B, S, D = q.shape
        ks = shift_k.shape[-1]
        k_pad = _pad(k, ((0, 0), (ks - 1, 0), (0, 0)))
        k_shift = torch.zeros_like(k)
        for t in range(ks):
            k_shift = k_shift + k_pad[:, t:t + S, :] * shift_k[:, ks - 1 - t][None, None, :]
        kv = k_shift * v
        L = 2 * S
        kv_pad = _pad(kv, ((0, 0), (0, S), (0, 0)))
        kf_pad = _pad(ssm_k, ((0, 0), (0, S)))
        kv_f = (lambda x, axes=(-2,-1): torch.fft.rfft2(x.float(), dim=axes))(kv_pad[:, None, :, :], axes=(1, 2))
        kf_f = (lambda x, axes=(-2,-1): torch.fft.rfft2(x.float(), dim=axes))(kf_pad[:, None, :], axes=(1, 2))
        kf_f = (lambda x, *d: x.permute(*d))(kf_f, 1, 2, 0)
        y_f = kv_f * kf_f[None, :, :, :]
        y = (lambda x, s, axes=(-2,-1): torch.fft.irfft2(x, s=s, dim=axes).to(torch.bfloat16))(y_f, (1, L), axes=(1, 2))[:, 0, :S, :]
        y = y + kv * ssm_D[None, None, :]
        return q * y

    x = A_x
    g = _sigmoid((x * gate_w).sum(-1, keepdims=True))
    a = _A_ref(x, A_wqkv, A_wo)
    b = _B_ref(x, B_k, B_v, B_shift_k, B_ssm_k, B_ssm_D)
    return g * a + (1 - g) * b
```

```asm
; @launch grid=(256,1,1) block=(512,1,1) lds=163840
.amdgcn_target "amdgcn-amd-amdhsa--gfx950"
.text
.globl gated_mix__sliding_block__ssm_conv_h3__prompt_kernel
.p2align 12
.p2align 8
.type gated_mix__sliding_block__ssm_conv_h3__prompt_kernel,@function
gated_mix__sliding_block__ssm_conv_h3__prompt_kernel:
    s_load_dwordx16 s[4:19], s[0:1], 0
    s_load_dwordx8 s[20:27], s[0:1], 64
    s_load_dwordx2 s[28:29], s[0:1], 96
    s_cmp_ge_u32 s2, 256
    s_cbranch_scc1 L_end
    v_lshrrev_b32 v1, 6, v0
    v_and_b32 v0, 63, v0
    v_readfirstlane_b32 s64, v1
    s_getpc_b64 s[68:69]
    s_add_u32 s68, s68, L_tab@rel32@lo+4
    s_addc_u32 s69, s69, L_tab@rel32@hi+12
    s_cmp_lt_u32 s64, 4
    s_cbranch_scc1 L_loader
    v_lshlrev_b32 v2, 4, v0
    v_add_u32 v1, 13312, v2
    global_load_dwordx4 v[128:131], v1, s[68:69] offset:-4096
    global_load_dwordx4 v[132:135], v1, s[68:69] offset:-3072
    global_load_dwordx4 v[136:139], v1, s[68:69] offset:-2048
    global_load_dwordx4 v[140:143], v1, s[68:69] offset:-1024
    global_load_dwordx4 v[144:147], v1, s[68:69] offset:0
    v_lshlrev_b32 v3, 7, v0
    s_lshl_b32 s74, s2, 9
    s_add_u32 s74, s74, 17408
    v_add_u32 v4, s74, v3
    s_bfe_u32 s74, s2, 0x30003
    s_lshl_b32 s74, s74, 9
    s_add_u32 s74, s74, 512
    v_add_u32 v3, s74, v3
    s_mov_b64 vcc, 15
    v_cndmask_b32 v3, v3, v4, vcc
    s_cmp_eq_u32 s64, 4
    s_cselect_b64 exec, 0xff, 1
    global_load_dword v255, v3, s[68:69]
    s_mov_b64 exec, -1
    s_bfe_u32 s74, s2, 196611
    s_mul_i32 s74, s74, 3072
    v_lshlrev_b32 v3, 7, v0
    v_add_u32 v3, s74, v3
    v_min_u32 v3, (L_codeend - gated_mix__sliding_block__ssm_conv_h3__prompt_kernel - 260), v3
    s_getpc_b64 s[76:77]
    s_and_b32 s76, s76, 0xffffff00
    s_cmp_eq_u32 s64, 5
    s_cselect_b64 exec, 16777215, 1
    global_load_dword v255, v3, s[76:77]
    s_mov_b64 exec, -1
    s_lshl_b32 s74, s64, 6
    s_load_dwordx16 s[80:95], s[68:69], s74
    s_branch L_compute
L_loader:
    s_setprio 3
    s_bfe_u32 s65, s2, 131073
    s_bfe_u32 s76, s2, 0x30003
    s_lshl3_add_u32 s65, s65, s76
    s_bfe_u32 s66, s2, 65536
    s_lshr_b32 s76, s2, 6
    s_lshl1_add_u32 s67, s76, s65
    s_lshl1_add_u32 s66, s76, s66
    s_xor_b32 s66, s66, 2
    s_and_b32 s67, s67, 7
    s_and_b32 s71, s64, 3
    v_lshrrev_b32 v2, 3, v0
    v_and_b32 v3, 7, v0
    v_lshrrev_b32 v4, 4, v0
    v_and_b32 v5, 1, v4
    s_lshl_b32 s74, s71, 3
    v_add_u32 v6, s74, v2
    s_lshl_b32 s75, s71, 1
    v_add_u32 v7, s75, v5
    v_xor_b32 v7, v7, v3
    v_lshlrev_b32 v7, 4, v7
    v_lshl_add_u32 v20, v6, 10, v7
    s_lshl_b32 s76, s65, 16
    s_lshl_b32 s79, s66, 7
    s_add_u32 s76, s76, s79
    s_xor_b32 s76, s76, 128
    s_add_u32 s77, s71, 1
    s_xor_b32 s77, s77, s71
    s_and_b32 s77, s77, 3
    s_lshl_b32 s77, s77, 5
    v_xor_b32 v21, s77, v20
    s_lshr_b32 s77, s71, 1
    v_xor_b32 v8, s77, v0
    v_lshlrev_b32 v8, 4, v8
    s_lshl_b32 s77, s71, 10
    s_add_u32 s77, s77, s76
    s_sub_u32 s77, s77, 0x1000
    v_add_u32 v8, s77, v8
    s_lshl2_add_u32 s77, s66, s71
    s_xor_b32 s77, s77, 4
    s_lshl_b32 s77, s77, 7
    v_lshlrev_b32 v9, 4, v0
    v_add_u32 v9, s77, v9
    s_add_u32 s77, s75, s67
    v_add_u32 v10, s77, v2
    v_and_b32 v10, 7, v10
    v_lshlrev_b32 v10, 7, v10
    v_lshl_add_u32 v10, v3, 4, v10
    v_lshlrev_b32 v11, 2, v5
    v_xor_b32 v11, v11, v3
    v_lshlrev_b32 v11, 4, v11
    v_lshl_add_u32 v11, v2, 10, v11
    s_lshl2_add_u32 s77, s65, s71
    s_lshl_b32 s77, s77, 12
    s_add_u32 s77, s77, s79
    v_add_u32 v11, s77, v11
    v_add_u32 v6, s74, v6
    v_xor_b32 v7, v4, v3
    v_lshlrev_b32 v7, 4, v7
    v_lshl_add_u32 v16, v6, 10, v7
    v_xor_b32 v17, 64, v16
    v_add_u32 v17, 7168, v17
    v_lshlrev_b32 v7, 2, v5
    v_xor_b32 v7, v7, v3
    v_lshlrev_b32 v7, 4, v7
    v_mul_u32_u24 v18, 0xc00, v6
    v_add_u32 v18, v18, v7
    v_add_u32 v19, 23552, v18
    s_lshl_b32 s72, s71, 12
    s_lshl_b32 s75, s71, 10
    s_lshl_b32 s77, s71, 7
    s_add_u32 s78, s76, 0x8000
    s_mov_b32 s46, 2097152
    s_mov_b32 s47, 0x20000
    s_mov_b32 s50, 2097152
    s_mov_b32 s51, 0x20000
    s_mov_b32 s34, 2097152
    s_mov_b32 s35, 0x20000
    s_mov_b32 s38, 1574912
    s_mov_b32 s39, 0x20000
    s_mov_b32 s62, 2097152
    s_mov_b32 s63, 0x20000
    s_add_u32 m0, s77, 159744
    s_mov_b64 exec, 0xff
    s_waitcnt lgkmcnt(0)
    global_load_lds_dwordx4 v9, s[16:17]
    s_add_u32 m0, s77, 132096
    s_mov_b64 s[44:45], s[12:13]
    buffer_load_dwordx4 v8, s[44:47], 0 offen lds
    s_lshl2_add_u32 m0, s77, 150016
    s_mov_b32 exec_lo, -1
    global_load_lds_dwordx4 v11, s[8:9]
    s_mov_b64 exec, -1
    s_add_u32 m0, s75, 132608
    s_mov_b64 s[48:49], s[14:15]
    buffer_load_dwordx4 v21, s[44:47], s76 offen lds
    s_add_u32 m0, s75, 136704
    s_mov_b64 s[32:33], s[4:5]
    buffer_load_dwordx4 v21, s[44:47], s78 offen lds
    s_add_u32 m0, s75, 140800
    s_lshl_b32 s77, s77, 1
    buffer_load_dwordx4 v20, s[48:51], s76 offen lds
    s_add_u32 m0, s75, 144896
    s_nop 0
    buffer_load_dwordx4 v20, s[48:51], s78 offen lds
    s_add_u32 m0, s77, 158208
    s_mov_b64 exec, 0xffff
    global_load_lds_dwordx4 v10, s[22:23]
    s_mov_b64 exec, -1
    s_sub_u32 s36, s6, 2048
    s_mov_b64 s[60:61], s[24:25]
    s_subb_u32 s37, s7, 0
    s_lshl_b32 s24, s67, 7
    s_lshl_b32 s74, s65, 16
    s_add_u32 s24, s24, s74
    s_mul_i32 s25, s67, 0x30000
    s_add_u32 s25, s25, s79
    s_add_u32 s25, s25, 1024
    s_add_u32 m0, s72, 0
    s_nop 0
    buffer_load_dwordx4 v16, s[32:35], s24 offen lds
    buffer_load_dwordx4 v18, s[36:39], s25 offen offset:2048 lds
    buffer_load_dwordx4 v17, s[32:35], s24 offen offset:1024 lds
    buffer_load_dwordx4 v19, s[36:39], s25 offen offset:3072 lds
    s_add_u32 s74, s24, 128
    s_and_b32 s74, s74, 0x3ff
    s_andn2_b32 s24, s24, 0x3ff
    s_or_b32 s24, s24, s74
    s_add_u32 s25, s25, 0x30000
    s_sub_u32 s74, s25, 0x180000
    s_cselect_b32 s25, s25, s74
    s_setprio 0
    s_mov_b32 s58, 33554432
    s_mov_b32 s59, 0x20000
    s_mov_b64 s[56:57], s[28:29]
    s_mov_b32 s54, 2097152
    s_mov_b32 s55, 0x20000
    s_mov_b64 s[52:53], s[18:19]
    s_lshl_b32 s74, s64, 6
    s_load_dwordx16 s[80:95], s[68:69], s74
    s_load_dword s70, s[28:29], 0
    s_lshl2_add_u32 s74, s2, s71
    s_lshl_b32 s74, s74, 7
    s_load_dwordx16 s[4:19], s[68:69], s74 offset:17408
    s_load_dwordx4 s[20:23], s[68:69], s74 offset:17472
    s_mov_b32 s31, 1
    s_lshl_b32 s44, s71, 14
    v_mov_b32 v44, 0
    v_mov_b32 v45, 0
    v_mov_b32 v46, 0
    v_mov_b32 v47, 0
    v_lshlrev_b32 v8, 2, v0
    v_add_u32 v8, 160256, v8
    ds_write_b32 v8, v44
    v_and_b32 v39, 7, v0
    s_mov_b32 s27, 0x3f803f80
    v_mov_b32 v4, 0xff61b1e6
    v_mov_b32 v5, 0
    s_lshl_b32 vcc_lo, -1, 0
    s_lshl_b32 vcc_hi, -1, 4
    v_cndmask_b32 v48, v4, v5, vcc
    v_cndmask_b32 v104, v5, v4, vcc
    s_lshl_b32 vcc_lo, -1, 1
    s_lshl_b32 vcc_hi, -1, 5
    v_cndmask_b32 v49, v4, v5, vcc
    v_cndmask_b32 v105, v5, v4, vcc
    s_lshl_b32 vcc_lo, -1, 2
    s_lshl_b32 vcc_hi, -1, 6
    v_cndmask_b32 v50, v4, v5, vcc
    v_cndmask_b32 v106, v5, v4, vcc
    s_lshl_b32 vcc_lo, -1, 3
    s_lshl_b32 vcc_hi, -1, 7
    v_cndmask_b32 v51, v4, v5, vcc
    v_cndmask_b32 v107, v5, v4, vcc
    s_lshl_b32 vcc_lo, -1, 8
    s_lshl_b32 vcc_hi, -1, 12
    v_cndmask_b32 v52, v4, v5, vcc
    v_cndmask_b32 v108, v5, v4, vcc
    s_lshl_b32 vcc_lo, -1, 9
    s_lshl_b32 vcc_hi, -1, 13
    v_cndmask_b32 v53, v4, v5, vcc
    v_cndmask_b32 v109, v5, v4, vcc
    s_lshl_b32 vcc_lo, -1, 10
    s_lshl_b32 vcc_hi, -1, 14
    v_cndmask_b32 v54, v4, v5, vcc
    v_cndmask_b32 v110, v5, v4, vcc
    s_lshl_b32 vcc_lo, -1, 11
    s_lshl_b32 vcc_hi, -1, 15
    v_cndmask_b32 v55, v4, v5, vcc
    v_cndmask_b32 v111, v5, v4, vcc
    s_lshl_b32 vcc_lo, -1, 16
    s_lshl_b32 vcc_hi, -1, 20
    v_cndmask_b32 v56, v4, v5, vcc
    v_cndmask_b32 v112, v5, v4, vcc
    s_lshl_b32 vcc_lo, -1, 17
    s_lshl_b32 vcc_hi, -1, 21
    v_cndmask_b32 v57, v4, v5, vcc
    v_cndmask_b32 v113, v5, v4, vcc
    s_lshl_b32 vcc_lo, -1, 18
    s_lshl_b32 vcc_hi, -1, 22
    v_cndmask_b32 v58, v4, v5, vcc
    v_cndmask_b32 v114, v5, v4, vcc
    s_lshl_b32 vcc_lo, -1, 19
    s_lshl_b32 vcc_hi, -1, 23
    v_cndmask_b32 v59, v4, v5, vcc
    v_cndmask_b32 v115, v5, v4, vcc
    s_lshl_b32 vcc_lo, -1, 24
    s_lshl_b32 vcc_hi, -1, 28
    v_cndmask_b32 v60, v4, v5, vcc
    v_cndmask_b32 v116, v5, v4, vcc
    s_lshl_b32 vcc_lo, -1, 25
    s_lshl_b32 vcc_hi, -1, 29
    v_cndmask_b32 v61, v4, v5, vcc
    v_cndmask_b32 v117, v5, v4, vcc
    s_lshl_b32 vcc_lo, -1, 26
    s_lshl_b32 vcc_hi, -1, 30
    v_cndmask_b32 v62, v4, v5, vcc
    v_cndmask_b32 v118, v5, v4, vcc
    s_lshl_b32 vcc_lo, -1, 27
    s_lshl_b32 vcc_hi, -1, 31
    v_cndmask_b32 v63, v4, v5, vcc
    v_cndmask_b32 v119, v5, v4, vcc
    s_mov_b32 vcc_lo, 0x110000
    s_mov_b32 vcc_hi, 0x110000
    v_mov_b32 v65, s27
    v_cndmask_b32 v64, 0, v65, vcc
    v_mov_b32 v65, v64
    v_mov_b32 v66, v64
    v_mov_b32 v67, v64
    v_mov_b32 v68, v64
    v_mov_b32 v69, v64
    v_mov_b32 v70, v64
    v_mov_b32 v71, v64
    v_mov_b32 v72, v64
    v_mov_b32 v73, v64
    v_mov_b32 v74, v64
    v_mov_b32 v75, v64
    v_mov_b32 v76, v64
    v_mov_b32 v77, v64
    v_mov_b32 v78, v64
    v_mov_b32 v79, v64
    s_waitcnt vmcnt(5)
    s_barrier
    s_branch L_b1
L_compute:
    s_bfe_u32 s65, s2, 131073
    s_bfe_u32 s76, s2, 0x30003
    s_lshl3_add_u32 s65, s65, s76
    s_bfe_u32 s66, s2, 65536
    s_lshr_b32 s76, s2, 6
    s_lshl1_add_u32 s67, s76, s65
    s_lshl1_add_u32 s66, s76, s66
    s_xor_b32 s66, s66, 2
    s_and_b32 s67, s67, 7
    s_and_b32 s71, s64, 3
    s_and_b32 s76, s2, 7
    s_lshl_b32 s76, s76, 5
    s_lshr_b32 s75, s2, 3
    s_add_u32 s76, s76, s75
    s_lshr_b32 s75, s71, 1
    s_lshl1_add_u32 s76, s76, s75
    s_lshl_b32 s76, s76, 1
    s_lshl_b32 s46, s76, 11
    v_mov_b32 v252, s76
    v_mov_b32 v253, 0
    s_bitcmp0_b32 s71, 0
    s_cselect_b32 s32, -1, 0
    s_mov_b32 s31, 0
    s_and_b32 s74, s71, 1
    s_lshr_b32 s75, s71, 1
    s_lshl2_add_u32 s76, s66, s71
    s_xor_b32 s78, s76, 4
    s_lshl_b32 s39, s78, 16
    s_lshl_b32 s77, s65, 9
    s_sub_u32 s39, s39, s77
    s_add_u32 s39, s39, 1064448
    s_lshl_b32 s40, s78, 5
    s_add_u32 s40, s40, s65
    s_lshl_b32 s40, s40, 2
    s_add_u32 s40, s40, 4096
    s_xor_b32 s77, s74, 1
    s_lshl1_add_u32 s77, s65, s77
    s_add_u32 s38, s77, 1
    s_min_u32 s38, s38, 9
    s_lshl_b32 s77, s77, 5
    s_add_u32 s77, s77, s76
    s_lshl_b32 s36, s77, 10
    s_add_u32 s36, s36, 9437184
    s_lshr_b32 s37, s77, 4
    s_mul_i32 s37, s37, 16
    s_add_u32 s37, s37, s77
    s_lshl_b32 s37, s37, 2
    s_add_u32 s37, s37, 24576
    s_lshl1_add_u32 s76, s66, s74
    s_lshl1_add_u32 s77, s65, s75
    s_lshl_b32 s41, s76, 7
    s_add_u32 s41, s41, s77
    s_lshl_b32 s41, s41, 11
    s_add_u32 s41, s41, 3145728
    s_add_u32 s42, s41, 0x20000
    s_lshl_b32 s43, s76, 6
    s_add_u32 s43, s43, s77
    s_lshr_b32 s77, s43, 3
    s_mul_i32 s77, s77, 24
    s_add_u32 s43, s43, s77
    s_lshl_b32 s43, s43, 2
    s_add_u32 s43, s43, 8192
    s_mov_b32 s58, 33554432
    s_mov_b32 s59, 0x20000
    s_waitcnt lgkmcnt(0)
    global_load_ushort v252, v252, s[20:21]
    global_load_dword v253, v253, s[28:29]
    s_mov_b64 s[56:57], s[28:29]
    s_mov_b64 s[44:45], s[6:7]
    s_mov_b64 s[4:5], s[36:37]
    s_mov_b64 s[6:7], s[38:39]
    s_mov_b64 s[8:9], s[40:41]
    s_mov_b64 s[10:11], s[42:43]
    s_waitcnt vmcnt(4)
    v_xor_b32 v192, s80, v128
    v_xor_b32 v193, s80, v129
    v_mov_b32 v194, v130
    v_xor_b32 v8, s81, v131
    v_xor_b32 v9, 32, v8
    v_xor_b32 v10, 64, v8
    v_xor_b32 v11, 0x60, v8
    v_xor_b32 v12, s82, v132
    v_xor_b32 v13, 0x2000, v12
    v_add_u32 v3, 0x10000, v12
    v_add_u32 v4, 0x10000, v13
    v_add_u32 v1, s83, v133
    v_mov_b32 v5, v134
    v_add_u32 v6, s84, v135
    v_add_u32 v7, s84, v136
    v_add_u32 v114, s85, v137
    v_add_u32 v112, s86, v138
    v_add_u32 v113, s87, v139
    v_add_u32 v14, s88, v136
    v_add_u32 v15, s89, v137
    v_add_u32 v120, s90, v136
    v_add_u32 v123, s90, v140
    v_add_u32 v121, s91, v136
    v_add_u32 v124, s91, v140
    v_add_u32 v122, s92, v136
    v_add_u32 v125, s92, v140
    s_mov_b32 s30, 0
    s_mov_b32 s27, 0x3f803f80
    s_mov_b32 s0, 0xffff
    s_mov_b32 s1, 0xffff
    s_mov_b32 s73, 0x40000
    s_mov_b32 s3, 0xffff0000
    v_mov_b32 v126, 160256
    v_mov_b32 v127, 1
    s_mov_b32 s33, s93
    s_mov_b32 s34, s94
    v_and_b32 v116, s32, v141
    v_and_b32 v117, s32, v142
    v_and_b32 v118, s32, v143
    v_and_b32 v119, s32, v144
    v_mov_b32 v190, v145
    v_add_u32 v195, s95, v146
    s_setprio 1
    s_barrier
    ds_read_b64 v[196:197], v195
    ds_read_b64 v[198:199], v195 offset:64
    ds_read_b64_tr_b16 v[200:201], v192 offset:512
    ds_read_b64_tr_b16 v[202:203], v193 offset:1024
    ds_read_b64_tr_b16 v[204:205], v193 offset:1536
    ds_read_b64_tr_b16 v[206:207], v192 offset:9216
    ds_read_b64_tr_b16 v[208:209], v192 offset:9728
    v_xor_b32 v192, 16, v192
    v_xor_b32 v193, 16, v193
    ds_read_b64_tr_b16 v[210:211], v192 offset:512
    ds_read_b64_tr_b16 v[212:213], v193 offset:1024
    ds_read_b64_tr_b16 v[214:215], v193 offset:1536
    ds_read_b64_tr_b16 v[216:217], v192 offset:9216
    ds_read_b64_tr_b16 v[218:219], v192 offset:9728
    s_cmp_lg_u32 s71, 0
    s_cbranch_scc1 Lwf_18
    v_xor_b32 v191, 64, v190
    ds_read_b64_tr_b16 v[176:177], v190
    ds_read_b64_tr_b16 v[178:179], v190 offset:1024
    ds_read_b64_tr_b16 v[180:181], v191
    ds_read_b64_tr_b16 v[182:183], v191 offset:1024
    s_lshl_b32 s74, s66, 5
    s_add_u32 s74, s74, s65
    s_lshl_b32 s74, s74, 11
    s_add_u32 s74, s74, 11534336
    s_waitcnt lgkmcnt(0)
    buffer_store_dwordx4 v[176:179], v2, s[56:59], s74 offen sc1
    buffer_store_dwordx4 v[180:183], v2, s[56:59], s74 offen offset:1024 sc1
Lwf_18:
    s_waitcnt lgkmcnt(5)
    v_alignbit_b32 v196, v196, v196, 16
    v_alignbit_b32 v197, v197, v197, 16
    v_alignbit_b32 v220, v201, v200, 16
    v_alignbit_b32 v221, v202, v201, 16
    v_alignbit_b32 v222, v203, v202, 16
    v_alignbit_b32 v223, v204, v203, 16
    v_alignbit_b32 v224, v205, v204, 16
    v_dot2_f32_bf16 v227, v201, v197, 0
    v_dot2_f32_bf16 v229, v202, v197, 0
    v_dot2_f32_bf16 v231, v203, v197, 0
    v_dot2_f32_bf16 v233, v204, v197, 0
    v_dot2_f32_bf16 v226, v220, v197, 0
    v_dot2_f32_bf16 v228, v221, v197, 0
    v_dot2_f32_bf16 v230, v222, v197, 0
    v_dot2_f32_bf16 v232, v223, v197, 0
    v_dot2_f32_bf16 v227, v202, v196, v227
    v_dot2_f32_bf16 v229, v203, v196, v229
    v_dot2_f32_bf16 v231, v204, v196, v231
    v_dot2_f32_bf16 v233, v205, v196, v233
    v_dot2_f32_bf16 v226, v221, v196, v226
    v_dot2_f32_bf16 v228, v222, v196, v228
    v_dot2_f32_bf16 v230, v223, v196, v230
    v_dot2_f32_bf16 v232, v224, v196, v232
    v_lshlrev_b32 v234, 16, v206
    v_and_b32 v235, s3, v206
    v_lshlrev_b32 v236, 16, v207
    v_and_b32 v237, s3, v207
    v_lshlrev_b32 v238, 16, v208
    v_and_b32 v239, s3, v208
    v_lshlrev_b32 v240, 16, v209
    v_and_b32 v241, s3, v209
    v_pk_mul_f32 v[226:227], v[226:227], v[234:235]
    v_pk_mul_f32 v[228:229], v[228:229], v[236:237]
    v_pk_mul_f32 v[230:231], v[230:231], v[238:239]
    v_pk_mul_f32 v[232:233], v[232:233], v[240:241]
    v_cvt_pk_bf16_f32 v244, v233, v232
    v_cvt_pk_bf16_f32 v245, v231, v230
    v_cvt_pk_bf16_f32 v246, v229, v228
    v_cvt_pk_bf16_f32 v247, v227, v226
    buffer_store_dwordx4 v[244:247], v194, s[56:59], s7 offen sc1
    s_waitcnt lgkmcnt(0)
    v_alignbit_b32 v198, v198, v198, 16
    v_alignbit_b32 v199, v199, v199, 16
    v_alignbit_b32 v220, v211, v210, 16
    v_alignbit_b32 v221, v212, v211, 16
    v_alignbit_b32 v222, v213, v212, 16
    v_alignbit_b32 v223, v214, v213, 16
    v_alignbit_b32 v224, v215, v214, 16
    v_dot2_f32_bf16 v227, v211, v199, 0
    v_dot2_f32_bf16 v229, v212, v199, 0
    v_dot2_f32_bf16 v231, v213, v199, 0
    v_dot2_f32_bf16 v233, v214, v199, 0
    v_dot2_f32_bf16 v226, v220, v199, 0
    v_dot2_f32_bf16 v228, v221, v199, 0
    v_dot2_f32_bf16 v230, v222, v199, 0
    v_dot2_f32_bf16 v232, v223, v199, 0
    v_dot2_f32_bf16 v227, v212, v198, v227
    v_dot2_f32_bf16 v229, v213, v198, v229
    v_dot2_f32_bf16 v231, v214, v198, v231
    v_dot2_f32_bf16 v233, v215, v198, v233
    v_dot2_f32_bf16 v226, v221, v198, v226
    v_dot2_f32_bf16 v228, v222, v198, v228
    v_dot2_f32_bf16 v230, v223, v198, v230
    v_dot2_f32_bf16 v232, v224, v198, v232
    v_lshlrev_b32 v234, 16, v216
    v_and_b32 v235, s3, v216
    v_lshlrev_b32 v236, 16, v217
    v_and_b32 v237, s3, v217
    v_lshlrev_b32 v238, 16, v218
    v_and_b32 v239, s3, v218
    v_lshlrev_b32 v240, 16, v219
    v_and_b32 v241, s3, v219
    v_pk_mul_f32 v[226:227], v[226:227], v[234:235]
    v_pk_mul_f32 v[228:229], v[228:229], v[236:237]
    v_pk_mul_f32 v[230:231], v[230:231], v[238:239]
    v_pk_mul_f32 v[232:233], v[232:233], v[240:241]
    v_cvt_pk_bf16_f32 v248, v233, v232
    v_cvt_pk_bf16_f32 v249, v231, v230
    v_cvt_pk_bf16_f32 v250, v229, v228
    v_cvt_pk_bf16_f32 v251, v227, v226
    s_add_u32 s7, s7, 0x8000
    buffer_store_dwordx4 v[248:251], v194, s[56:59], s7 offen sc1
    s_branch L_a1
L_b1:
    s_add_u32 m0, s72, 16384
    s_nop 0
    buffer_load_dwordx4 v16, s[32:35], s24 offen lds
    buffer_load_dwordx4 v18, s[36:39], s25 offen offset:2048 lds
    buffer_load_dwordx4 v17, s[32:35], s24 offen offset:1024 lds
    buffer_load_dwordx4 v19, s[36:39], s25 offen offset:3072 lds
    s_add_u32 s74, s24, 128
    s_and_b32 s74, s74, 0x3ff
    s_andn2_b32 s24, s24, 0x3ff
    s_or_b32 s24, s24, s74
    s_add_u32 s25, s25, 0x30000
    s_sub_u32 s74, s25, 0x180000
    s_cselect_b32 s25, s25, s74
    s_add_u32 m0, s72, 32768
    s_nop 0
    buffer_load_dwordx4 v16, s[32:35], s24 offen lds
    buffer_load_dwordx4 v18, s[36:39], s25 offen offset:2048 lds
    buffer_load_dwordx4 v17, s[32:35], s24 offen offset:1024 lds
    buffer_load_dwordx4 v19, s[36:39], s25 offen offset:3072 lds
    s_add_u32 s74, s24, 128
    s_and_b32 s74, s74, 0x3ff
    s_andn2_b32 s24, s24, 0x3ff
    s_or_b32 s24, s24, s74
    s_add_u32 s25, s25, 0x30000
    s_sub_u32 s74, s25, 0x180000
    s_cselect_b32 s25, s25, s74
    s_add_u32 m0, s72, 49152
    s_nop 0
    buffer_load_dwordx4 v16, s[32:35], s24 offen lds
    buffer_load_dwordx4 v18, s[36:39], s25 offen offset:2048 lds
    buffer_load_dwordx4 v17, s[32:35], s24 offen offset:1024 lds
    buffer_load_dwordx4 v19, s[36:39], s25 offen offset:3072 lds
    s_add_u32 s74, s24, 128
    s_and_b32 s74, s74, 0x3ff
    s_andn2_b32 s24, s24, 0x3ff
    s_or_b32 s24, s24, s74
    s_add_u32 s25, s25, 0x30000
    s_sub_u32 s74, s25, 0x180000
    s_cselect_b32 s25, s25, s74
    v_lshlrev_b32 v1, 4, v0
    v_add_u32 v1, 5120, v1
    global_load_dwordx4 v[128:131], v1, s[68:69] offset:-4096
    global_load_dwordx4 v[132:135], v1, s[68:69] offset:-3072
    global_load_dwordx4 v[136:139], v1, s[68:69] offset:-2048
    global_load_dwordx4 v[140:143], v1, s[68:69] offset:-1024
    s_waitcnt vmcnt(16)
    s_barrier
    s_add_u32 m0, s72, 65536
    s_nop 0
    buffer_load_dwordx4 v16, s[32:35], s24 offen lds
    buffer_load_dwordx4 v18, s[36:39], s25 offen offset:2048 lds
    buffer_load_dwordx4 v17, s[32:35], s24 offen offset:1024 lds
    buffer_load_dwordx4 v19, s[36:39], s25 offen offset:3072 lds
    s_add_u32 s74, s24, 128
    s_and_b32 s74, s74, 0x3ff
    s_andn2_b32 s24, s24, 0x3ff
    s_or_b32 s24, s24, s74
    s_add_u32 s25, s25, 0x30000
    s_sub_u32 s74, s25, 0x180000
    s_cselect_b32 s25, s25, s74
    s_waitcnt vmcnt(16)
    s_barrier
    s_add_u32 m0, s72, 81920
    s_nop 0
    buffer_load_dwordx4 v16, s[32:35], s24 offen lds
    buffer_load_dwordx4 v18, s[36:39], s25 offen offset:2048 lds
    buffer_load_dwordx4 v17, s[32:35], s24 offen offset:1024 lds
    buffer_load_dwordx4 v19, s[36:39], s25 offen offset:3072 lds
    s_add_u32 s74, s24, 128
    s_and_b32 s74, s74, 0x3ff
    s_andn2_b32 s24, s24, 0x3ff
    s_or_b32 s24, s24, s74
    s_add_u32 s25, s25, 0x30000
    s_sub_u32 s74, s25, 0x180000
    s_cselect_b32 s25, s25, s74
    s_waitcnt vmcnt(16)
    s_barrier
    s_add_u32 m0, s72, 0
    s_nop 0
    buffer_load_dwordx4 v16, s[32:35], s24 offen lds
    buffer_load_dwordx4 v18, s[36:39], s25 offen offset:2048 lds
    buffer_load_dwordx4 v17, s[32:35], s24 offen offset:1024 lds
    buffer_load_dwordx4 v19, s[36:39], s25 offen offset:3072 lds
    s_add_u32 s74, s24, 128
    s_and_b32 s74, s74, 0x3ff
    s_andn2_b32 s24, s24, 0x3ff
    s_or_b32 s24, s24, s74
    s_add_u32 s25, s25, 0x30000
    s_sub_u32 s74, s25, 0x180000
    s_cselect_b32 s25, s25, s74
    s_waitcnt lgkmcnt(0)
    s_waitcnt vmcnt(16)
    s_barrier
    s_add_u32 m0, s72, 16384
    s_nop 0
    buffer_load_dwordx4 v16, s[32:35], s24 offen lds
    buffer_load_dwordx4 v18, s[36:39], s25 offen offset:2048 lds
    buffer_load_dwordx4 v17, s[32:35], s24 offen offset:1024 lds
    buffer_load_dwordx4 v19, s[36:39], s25 offen offset:3072 lds
    s_add_u32 s74, s24, 128
    s_and_b32 s74, s74, 0x3ff
    s_andn2_b32 s24, s24, 0x3ff
    s_or_b32 s24, s24, s74
    s_add_u32 s25, s25, 0x30000
    s_sub_u32 s74, s25, 0x180000
    s_cselect_b32 s25, s25, s74
    s_add_u32 s25, s25, 1024
    s_waitcnt vmcnt(12)
    s_barrier
    s_add_u32 m0, s72, 32768
    s_add_u32 s75, s25, 2048
    buffer_load_dwordx4 v18, s[36:39], s75 offen lds
    buffer_load_dwordx4 v19, s[36:39], s75 offen offset:1024 lds
    s_add_u32 s25, s25, 0x30000
    s_sub_u32 s74, s25, 0x180000
    s_cselect_b32 s25, s25, s74
    buffer_load_dwordx4 v18, s[36:39], s25 offen offset:2048 lds
    buffer_load_dwordx4 v19, s[36:39], s25 offen offset:3072 lds
    s_add_u32 s25, s25, 0x30000
    s_sub_u32 s74, s25, 0x180000
    s_cselect_b32 s25, s25, s74
    v_add_u32 v14, s80, v128
    v_add_u32 v15, s81, v129
    v_add_u32 v120, s82, v128
    v_add_u32 v123, s82, v130
    v_add_u32 v121, s83, v128
    v_add_u32 v124, s83, v130
    v_add_u32 v122, s84, v128
    v_add_u32 v125, s84, v130
    s_mov_b32 s30, 0
    s_mov_b32 s27, 0x3f803f80
    s_mov_b32 s0, 0xffff
    s_mov_b32 s1, 0xffff
    s_mov_b32 s73, 0x40000
    s_mov_b32 s3, 0xffff0000
    s_waitcnt vmcnt(12)
    s_barrier
    s_add_u32 m0, s72, 49152
    s_add_u32 s75, s25, 2048
    buffer_load_dwordx4 v18, s[36:39], s75 offen lds
    buffer_load_dwordx4 v19, s[36:39], s75 offen offset:1024 lds
    s_add_u32 s25, s25, 0x30000
    s_sub_u32 s74, s25, 0x180000
    s_cselect_b32 s25, s25, s74
    buffer_load_dwordx4 v18, s[36:39], s25 offen offset:2048 lds
    buffer_load_dwordx4 v19, s[36:39], s25 offen offset:3072 lds
    s_add_u32 s25, s25, 0x30000
    s_sub_u32 s74, s25, 0x180000
    s_cselect_b32 s25, s25, s74
    v_mov_b32 v126, 160256
    v_mov_b32 v127, 1
    v_mov_b32 v2, v128
    v_mov_b32 v28, v131
    v_mov_b32 v23, v132
    v_add_u32 v31, s85, v128
    v_add_u32 v26, s86, v133
    v_mov_b32 v24, v134
    v_mov_b32 v4, v135
    v_add_u32 v11, s87, v136
    v_add_u32 v6, s88, v137
    v_add_u32 v7, s89, v137
    v_add_u32 v8, s87, v138
    v_mov_b32 v9, v139
    s_waitcnt vmcnt(12)
    s_barrier
    s_add_u32 m0, s72, 65536
    s_add_u32 s75, s25, 2048
    buffer_load_dwordx4 v18, s[36:39], s75 offen lds
    buffer_load_dwordx4 v19, s[36:39], s75 offen offset:1024 lds
    s_add_u32 s25, s25, 0x30000
    s_sub_u32 s74, s25, 0x180000
    s_cselect_b32 s25, s25, s74
    buffer_load_dwordx4 v18, s[36:39], s25 offen offset:2048 lds
    buffer_load_dwordx4 v19, s[36:39], s25 offen offset:3072 lds
    s_add_u32 s25, s25, 0x30000
    s_sub_u32 s74, s25, 0x180000
    s_cselect_b32 s25, s25, s74
    v_mov_b32 v10, v140
    v_add_u32 v12, s90, v141
    v_add_u32 v13, s91, v142
    v_mov_b32 v1, v143
    s_mov_b32 s45, s92
    s_add_u32 s70, s70, 2654435769
    s_xor_b32 s47, s18, 1024
    s_xor_b32 s40, s21, 1024
    s_xor_b32 s41, s21, 2048
    s_xor_b32 s42, s21, 3072
    s_mov_b32 s48, 0xff
    s_mov_b32 s49, 0
    v_lshlrev_b32 v25, 2, v0
    v_add_u32 v39, s22, v39
    s_waitcnt vmcnt(12)
    s_barrier
    s_add_u32 m0, s72, 81920
    s_add_u32 s75, s25, 2048
    buffer_load_dwordx4 v18, s[36:39], s75 offen lds
    buffer_load_dwordx4 v19, s[36:39], s75 offen offset:1024 lds
    s_add_u32 s25, s25, 0x30000
    s_sub_u32 s74, s25, 0x180000
    s_cselect_b32 s25, s25, s74
    buffer_load_dwordx4 v18, s[36:39], s25 offen offset:2048 lds
    buffer_load_dwordx4 v19, s[36:39], s25 offen offset:3072 lds
    s_add_u32 s25, s25, 0x30000
    s_sub_u32 s74, s25, 0x180000
    s_cselect_b32 s25, s25, s74
    s_sub_u32 s25, s25, 2048
    v_max_i32 v39, 0, v39
    v_lshrrev_b32 v3, 3, v39
    v_mul_u32_u24 v3, 24, v3
    v_add_lshl_u32 v39, v39, v3, 2
    v_add_u32 v39, s19, v39
    v_and_b32 v38, 60, v25
    s_mov_b32 exec_hi, 0
    v_add_u32 v10, s15, v10
    s_not_b64 exec, exec
    v_xor_b32 v10, s17, v10
    s_mov_b64 exec, -1
    s_waitcnt vmcnt(12)
    s_barrier
    s_add_u32 m0, s72, 0
    s_add_u32 s75, s25, 2048
    buffer_load_dwordx4 v18, s[36:39], s75 offen lds
    buffer_load_dwordx4 v19, s[36:39], s75 offen offset:1024 lds
    s_add_u32 s25, s25, 0x30000
    s_sub_u32 s74, s25, 0x180000
    s_cselect_b32 s25, s25, s74
    buffer_load_dwordx4 v18, s[36:39], s25 offen offset:2048 lds
    buffer_load_dwordx4 v19, s[36:39], s25 offen offset:3072 lds
    s_add_u32 s25, s25, 0x30000
    s_sub_u32 s74, s25, 0x180000
    s_cselect_b32 s25, s25, s74
    s_waitcnt vmcnt(12)
    s_barrier
    s_add_u32 m0, s72, 16384
    s_add_u32 s75, s25, 2048
    buffer_load_dwordx4 v18, s[36:39], s75 offen lds
    buffer_load_dwordx4 v19, s[36:39], s75 offen offset:1024 lds
    s_add_u32 s25, s25, 0x30000
    s_sub_u32 s74, s25, 0x180000
    s_cselect_b32 s25, s25, s74
    buffer_load_dwordx4 v18, s[36:39], s25 offen offset:2048 lds
    buffer_load_dwordx4 v19, s[36:39], s25 offen offset:3072 lds
    s_add_u32 s25, s25, 0x30000
    s_sub_u32 s74, s25, 0x180000
    s_cselect_b32 s25, s25, s74
    s_waitcnt vmcnt(12)
    s_barrier
    s_add_u32 m0, s72, 32768
    s_add_u32 s75, s25, 2048
    buffer_load_dwordx4 v18, s[36:39], s75 offen lds
    buffer_load_dwordx4 v19, s[36:39], s75 offen offset:1024 lds
    s_add_u32 s25, s25, 0x30000
    s_sub_u32 s74, s25, 0x180000
    s_cselect_b32 s25, s25, s74
    buffer_load_dwordx4 v18, s[36:39], s25 offen offset:2048 lds
    buffer_load_dwordx4 v19, s[36:39], s25 offen offset:3072 lds
    s_add_u32 s25, s25, 0x30000
    s_sub_u32 s74, s25, 0x180000
    s_cselect_b32 s25, s25, s74
    s_waitcnt vmcnt(12)
    s_barrier
    s_add_u32 m0, s72, 49152
    s_add_u32 s75, s25, 2048
    buffer_load_dwordx4 v18, s[36:39], s75 offen lds
    buffer_load_dwordx4 v19, s[36:39], s75 offen offset:1024 lds
    s_add_u32 s25, s25, 0x30000
    s_sub_u32 s74, s25, 0x180000
    s_cselect_b32 s25, s25, s74
    buffer_load_dwordx4 v18, s[36:39], s25 offen offset:2048 lds
    buffer_load_dwordx4 v19, s[36:39], s25 offen offset:3072 lds
    s_add_u32 s25, s25, 0x30000
    s_sub_u32 s74, s25, 0x180000
    s_cselect_b32 s25, s25, s74
    s_load_dwordx8 s[88:95], s[28:29], s8
    s_load_dword s51, s[28:29], s8 offset:32
    s_waitcnt vmcnt(12)
    s_barrier
    s_waitcnt vmcnt(8)
    s_barrier
    s_mov_b32 m0, s45
    buffer_load_dword v22, v28, s[52:55], s9 offen
    buffer_load_dwordx4 v2, s[52:55], s10 offen offset:0 lds
    buffer_load_dwordx4 v2, s[52:55], s10 offen offset:1024 lds
    buffer_load_dwordx4 v2, s[52:55], s10 offen offset:2048 lds
    buffer_load_dwordx4 v2, s[52:55], s10 offen offset:3072 lds
    s_waitcnt lgkmcnt(0)
    buffer_load_dword v32, v38, s[56:59], s23 offen sc1
    buffer_load_dwordx4 v[128:131], v24, s[56:59], s7 offen sc1
    buffer_load_dwordx4 v[136:139], v24, s[56:59], s7 offen offset:2048 sc1
    s_cmp_eq_u32 s71, 3
    s_cselect_b32 s75, 33554432, s7
    s_lshl_b64 exec, 3, 62
    buffer_load_dword v141, v24, s[56:59], s75 offen offset:2112 sc1
    s_mov_b64 exec, -1
    s_waitcnt vmcnt(13)
    s_barrier
    s_waitcnt vmcnt(9)
    s_barrier
    s_xor_b32 s50, s51, s70
    s_xor_b32 s74, s88, s70
    s_or_b32 s50, s50, s74
    s_xor_b32 s74, s89, s70
    s_or_b32 s50, s50, s74
    s_xor_b32 s74, s90, s70
    s_or_b32 s50, s50, s74
    s_xor_b32 s74, s91, s70
    s_or_b32 s50, s50, s74
    s_xor_b32 s74, s92, s70
    s_or_b32 s50, s50, s74
    s_xor_b32 s74, s93, s70
    s_or_b32 s50, s50, s74
    s_xor_b32 s74, s94, s70
    s_or_b32 s50, s50, s74
    s_xor_b32 s74, s95, s70
    s_or_b32 s50, s50, s74
    s_barrier
    s_setprio 2
    s_cmp_lg_u32 s50, 0
    s_cbranch_scc1 Lur_1
Lub_2:
    v_mov_b32 v5, s70
    s_mov_b64 exec, s[48:49]
    v_mov_b32 v5, 0
    buffer_atomic_or v5, v39, s[56:59], 0 offen sc0 sc1
    s_mov_b64 exec, -1
    s_mov_b64 exec, 0xfffffff
    ds_write_b128 v31, v[44:47]
    s_mov_b64 exec, -1
    s_waitcnt vmcnt(1)
    ds_write_b32 v23, v22
    v_mov_b32_dpp v133, v128 wave_rol:1 row_mask:0xf bank_mask:0xf
    v_mov_b32_dpp v134, v136 wave_rol:1 row_mask:0xf bank_mask:0xf
    s_lshl_b64 vcc, 3, 62
    v_mov_b32_dpp v132, v133 wave_rol:1 row_mask:0xf bank_mask:0xf
    v_mov_b32_dpp v140, v134 wave_rol:1 row_mask:0xf bank_mask:0xf
    v_cndmask_b32 v132, v132, v140, vcc
    v_cndmask_b32 v140, v140, v141, vcc
    ds_write_b128 v26, v[128:131] offset:4576
    v_alignbit_b32 v144, v129, v128, 16
    v_alignbit_b32 v145, v130, v129, 16
    v_alignbit_b32 v146, v131, v130, 16
    v_alignbit_b32 v147, v132, v131, 16
    ds_write_b128 v26, v[144:147] offset:0
    ds_write_b128 v26, v[136:139] offset:5088
    v_alignbit_b32 v148, v137, v136, 16
    v_alignbit_b32 v149, v138, v137, 16
    v_alignbit_b32 v150, v139, v138, 16
    v_alignbit_b32 v151, v140, v139, 16
    ds_write_b128 v26, v[148:151] offset:512
    s_mov_b64 exec, 1
    ds_add_u32 v126, v127 offset:40
    s_mov_b64 exec, -1
    v_cmp_ne_u32 vcc, s70, v32
    s_nop 0
    s_cbranch_vccnz Lwr_6
Lwb_7:
    ds_read_b128 v[80:83], v14
    ds_read_b128 v[96:99], v120 offset:0
    ds_read_b64 v[84:85], v15
    s_mov_b64 exec, s[0:1]
    ds_read_b128 v[64:67], v123 offset:0
    ds_read_b128 v[68:71], v123 offset:512
    s_mov_b64 exec, -1
    s_waitcnt lgkmcnt(3)
    v_mfma_f32_32x32x16_bf16 v[16:31], v[96:99], v[80:83], v[48:63]
    s_waitcnt lgkmcnt(2)
    v_add_f32 v84, v84, v85
    v_mul_f32 v84, 0xbfb8aa3b, v84
    v_exp_f32 v84, v84
    s_nop 0
    v_add_f32 v84, 1.0, v84
    s_nop 5
    v_exp_f32 v16, v16
    v_exp_f32 v17, v17
    v_exp_f32 v18, v18
    v_exp_f32 v19, v19
    v_cvt_pk_bf16_f32 v88, v16, v17
    v_exp_f32 v20, v20
    v_exp_f32 v21, v21
    v_cvt_pk_bf16_f32 v89, v18, v19
    v_exp_f32 v22, v22
    v_exp_f32 v23, v23
    v_cvt_pk_bf16_f32 v90, v20, v21
    s_waitcnt vmcnt(0)
    s_cmp_eq_u32 s65, 0
    s_cbranch_scc1 Lk0_12
    s_branch Lpc_14
Lpl_13:
    v_mov_b32 v5, s70
    s_mov_b64 exec, s[48:49]
    v_mov_b32 v5, 0
    buffer_atomic_or v5, v39, s[56:59], 0 offen sc0 sc1
    s_mov_b64 exec, -1
    s_waitcnt vmcnt(0)
Lpc_14:
    v_cmp_ne_u32 vcc, s70, v5
    s_nop 0
    s_cbranch_vccz Lpd_15
    s_sleep 1
    s_sub_u32 s73, s73, 8
    s_cmp_gt_i32 s73, 0
    s_cbranch_scc1 Lpl_13
Lpd_15:
Lk0_12:
    s_add_u32 m0, s44, 12288
    s_add_u32 s76, s20, 12288
    s_cmp_lt_u32 s65, 1
    s_cselect_b32 s76, 33554432, s76
    buffer_load_dwordx4 v2, s[56:59], s76 offen offset:2048 sc1 lds
    buffer_load_dwordx4 v2, s[56:59], s76 offen offset:3072 sc1 lds
    buffer_load_dwordx4 v2, s[56:59], s76 offen offset:0 sc1 lds
    buffer_load_dwordx4 v2, s[56:59], s76 offen offset:1024 sc1 lds
    s_add_u32 m0, s44, 8192
    s_add_u32 s76, s20, 8192
    s_cmp_lt_u32 s65, 2
    s_cselect_b32 s76, 33554432, s76
    buffer_load_dwordx4 v2, s[56:59], s76 offen offset:2048 sc1 lds
    buffer_load_dwordx4 v2, s[56:59], s76 offen offset:3072 sc1 lds
    buffer_load_dwordx4 v2, s[56:59], s76 offen offset:0 sc1 lds
    buffer_load_dwordx4 v2, s[56:59], s76 offen offset:1024 sc1 lds
Lkf_11:
    s_lshl_b32 s76, s71, 2
    v_add_u32 v5, s76, v126
    s_add_u32 m0, s44, 4096
    s_add_u32 s76, s20, 4096
    s_cmp_lt_u32 s65, 3
    s_cselect_b32 s76, 33554432, s76
    buffer_load_dwordx4 v2, s[56:59], s76 offen offset:2048 sc1 lds
    buffer_load_dwordx4 v2, s[56:59], s76 offen offset:3072 sc1 lds
    buffer_load_dwordx4 v2, s[56:59], s76 offen offset:0 sc1 lds
    buffer_load_dwordx4 v2, s[56:59], s76 offen offset:1024 sc1 lds
    s_add_u32 m0, s44, 0
    s_add_u32 s76, s20, 0
    s_cmp_lt_u32 s65, 4
    s_cselect_b32 s76, 33554432, s76
    buffer_load_dwordx4 v2, s[56:59], s76 offen offset:2048 sc1 lds
    buffer_load_dwordx4 v2, s[56:59], s76 offen offset:3072 sc1 lds
    buffer_load_dwordx4 v2, s[56:59], s76 offen offset:0 sc1 lds
    buffer_load_dwordx4 v2, s[56:59], s76 offen offset:1024 sc1 lds
    s_waitcnt vmcnt(14)
    ds_read_b128 v[100:103], v121 offset:0
    s_cmp_gt_u32 s6, 1
    s_cselect_b64 exec, s[0:1], -1
    ds_read_b128 v[72:75], v124 offset:0
    ds_read_b128 v[76:79], v124 offset:512
    s_mov_b64 exec, -1
    v_exp_f32 v24, v24
    v_cvt_pk_bf16_f32 v91, v22, v23
    v_exp_f32 v25, v25
    v_exp_f32 v26, v26
    s_waitcnt lgkmcnt(3)
    v_mfma_f32_32x32x16_bf16 v[48:63], v[64:67], v[88:91], 0
    v_exp_f32 v27, v27
    v_cvt_pk_bf16_f32 v92, v24, v25
    v_exp_f32 v28, v28
    s_waitcnt lgkmcnt(2)
    v_mfma_f32_32x32x16_bf16 v[32:47], v[100:103], v[80:83], 0
    s_waitcnt vmcnt(12)
    ds_read_b128 v[96:99], v122 offset:12288
    v_exp_f32 v29, v29
    v_cvt_pk_bf16_f32 v93, v26, v27
    v_exp_f32 v30, v30
    v_exp_f32 v31, v31
    v_cvt_pk_bf16_f32 v94, v28, v29
    s_nop 4
    v_exp_f32 v32, v32
    v_cvt_pk_bf16_f32 v95, v30, v31
    v_exp_f32 v33, v33
    v_exp_f32 v34, v34
    v_mfma_f32_32x32x16_bf16 v[48:63], v[68:71], v[92:95], v[48:63]
    v_exp_f32 v35, v35
    v_cvt_pk_bf16_f32 v88, v32, v33
    v_add_u32 v15, 0, v2
    buffer_load_dwordx4 v[128:131], v15, s[56:59], s21 offen sc1
    buffer_load_dwordx4 v[132:135], v15, s[56:59], s40 offen sc1
    v_exp_f32 v36, v36
    s_cmp_gt_u32 s6, 2
    s_cselect_b64 exec, s[0:1], -1
    ds_read_b128 v[64:67], v125 offset:12288
    ds_read_b128 v[68:71], v125 offset:12800
    s_mov_b64 exec, -1
    v_exp_f32 v37, v37
    v_cvt_pk_bf16_f32 v89, v34, v35
    v_exp_f32 v38, v38
    s_waitcnt lgkmcnt(2)
    v_exp_f32 v39, v39
    v_mfma_f32_32x32x16_bf16 v[16:31], v[96:99], v[80:83], 0
    v_cvt_pk_bf16_f32 v90, v36, v37
    v_exp_f32 v40, v40
    v_cvt_pk_bf16_f32 v91, v38, v39
    v_exp_f32 v41, v41
    s_waitcnt vmcnt(12)
    v_exp_f32 v42, v42
    ds_read_b128 v[100:103], v122 offset:10240
    v_exp_f32 v43, v43
    v_mfma_f32_32x32x16_bf16 v[48:63], v[72:75], v[88:91], v[48:63]
    v_cvt_pk_bf16_f32 v92, v40, v41
    v_exp_f32 v44, v44
    buffer_load_dwordx4 v[192:195], v15, s[56:59], s41 offen sc1
    buffer_load_dwordx4 v[196:199], v15, s[56:59], s42 offen sc1
    v_exp_f32 v45, v45
    v_cvt_pk_bf16_f32 v93, v42, v43
    v_exp_f32 v46, v46
    v_exp_f32 v47, v47
    v_cvt_pk_bf16_f32 v94, v44, v45
    v_exp_f32 v16, v16
    v_cvt_pk_bf16_f32 v95, v46, v47
    v_exp_f32 v17, v17
    v_exp_f32 v18, v18
    v_mfma_f32_32x32x16_bf16 v[48:63], v[76:79], v[92:95], v[48:63]
    v_exp_f32 v19, v19
    v_cvt_pk_bf16_f32 v88, v16, v17
    v_add_u32 v15, 4096, v2
    buffer_load_dwordx4 v[136:139], v15, s[56:59], s21 offen sc1
    buffer_load_dwordx4 v[140:143], v15, s[56:59], s40 offen sc1
    v_exp_f32 v20, v20
    s_cmp_gt_u32 s6, 3
    s_cselect_b64 exec, s[0:1], -1
    ds_read_b128 v[72:75], v125 offset:10240
    ds_read_b128 v[76:79], v125 offset:10752
    s_mov_b64 exec, -1
    v_exp_f32 v21, v21
    v_cvt_pk_bf16_f32 v89, v18, v19
    v_exp_f32 v22, v22
    s_waitcnt lgkmcnt(2)
    v_exp_f32 v23, v23
    v_mfma_f32_32x32x16_bf16 v[32:47], v[100:103], v[80:83], 0
    v_cvt_pk_bf16_f32 v90, v20, v21
    v_exp_f32 v24, v24
    v_cvt_pk_bf16_f32 v91, v22, v23
    v_exp_f32 v25, v25
    s_waitcnt vmcnt(14)
    v_exp_f32 v26, v26
    ds_read_b128 v[96:99], v122 offset:8192
    v_exp_f32 v27, v27
    v_mfma_f32_32x32x16_bf16 v[48:63], v[64:67], v[88:91], v[48:63]
    v_cvt_pk_bf16_f32 v92, v24, v25
    v_exp_f32 v28, v28
    buffer_load_dwordx4 v[200:203], v15, s[56:59], s41 offen sc1
    buffer_load_dwordx4 v[204:207], v15, s[56:59], s42 offen sc1
    v_exp_f32 v29, v29
    v_cvt_pk_bf16_f32 v93, v26, v27
    v_exp_f32 v30, v30
    v_exp_f32 v31, v31
    v_cvt_pk_bf16_f32 v94, v28, v29
    v_exp_f32 v32, v32
    v_cvt_pk_bf16_f32 v95, v30, v31
    v_exp_f32 v33, v33
    v_exp_f32 v34, v34
    v_mfma_f32_32x32x16_bf16 v[48:63], v[68:71], v[92:95], v[48:63]
    v_exp_f32 v35, v35
    v_cvt_pk_bf16_f32 v88, v32, v33
    v_add_u32 v15, 8192, v2
    buffer_load_dwordx4 v[144:147], v15, s[56:59], s21 offen sc1
    buffer_load_dwordx4 v[148:151], v15, s[56:59], s40 offen sc1
    v_exp_f32 v36, v36
    s_cmp_gt_u32 s6, 4
    s_cselect_b64 exec, s[0:1], -1
    ds_read_b128 v[64:67], v125 offset:8192
    ds_read_b128 v[68:71], v125 offset:8704
    s_mov_b64 exec, -1
    v_exp_f32 v37, v37
    v_cvt_pk_bf16_f32 v89, v34, v35
    v_exp_f32 v38, v38
    s_waitcnt lgkmcnt(2)
    v_exp_f32 v39, v39
    v_mfma_f32_32x32x16_bf16 v[16:31], v[96:99], v[80:83], 0
    v_cvt_pk_bf16_f32 v90, v36, v37
    v_exp_f32 v40, v40
    v_cvt_pk_bf16_f32 v91, v38, v39
    v_exp_f32 v41, v41
    s_waitcnt vmcnt(10)
    v_exp_f32 v42, v42
    ds_read_b128 v[100:103], v122 offset:6144
    v_exp_f32 v43, v43
    v_mfma_f32_32x32x16_bf16 v[48:63], v[72:75], v[88:91], v[48:63]
    v_cvt_pk_bf16_f32 v92, v40, v41
    v_exp_f32 v44, v44
    s_mov_b64 exec, 1
    ds_add_u32 v5, v127 offset:0
    s_mov_b64 exec, -1
    buffer_load_dwordx4 v[208:211], v15, s[56:59], s41 offen sc1
    buffer_load_dwordx4 v[212:215], v15, s[56:59], s42 offen sc1
    v_exp_f32 v45, v45
    v_cvt_pk_bf16_f32 v93, v42, v43
    v_exp_f32 v46, v46
    v_exp_f32 v47, v47
    v_cvt_pk_bf16_f32 v94, v44, v45
    v_exp_f32 v16, v16
    v_cvt_pk_bf16_f32 v95, v46, v47
    v_exp_f32 v17, v17
    v_exp_f32 v18, v18
    v_mfma_f32_32x32x16_bf16 v[48:63], v[76:79], v[92:95], v[48:63]
    v_exp_f32 v19, v19
    v_cvt_pk_bf16_f32 v88, v16, v17
    v_add_u32 v15, 12288, v2
    buffer_load_dwordx4 v[152:155], v15, s[56:59], s21 offen sc1
    buffer_load_dwordx4 v[156:159], v15, s[56:59], s40 offen sc1
    v_exp_f32 v20, v20
    s_cmp_gt_u32 s6, 5
    s_cselect_b64 exec, s[0:1], -1
    ds_read_b128 v[72:75], v125 offset:6144
    ds_read_b128 v[76:79], v125 offset:6656
    s_mov_b64 exec, -1
    v_exp_f32 v21, v21
    v_cvt_pk_bf16_f32 v89, v18, v19
    v_exp_f32 v22, v22
    s_waitcnt lgkmcnt(3)
    v_exp_f32 v23, v23
    v_mfma_f32_32x32x16_bf16 v[32:47], v[100:103], v[80:83], 0
    v_cvt_pk_bf16_f32 v90, v20, v21
    v_exp_f32 v24, v24
    v_cvt_pk_bf16_f32 v91, v22, v23
    v_exp_f32 v25, v25
    v_exp_f32 v26, v26
    ds_read_b128 v[96:99], v122 offset:4096
    v_exp_f32 v27, v27
    v_mfma_f32_32x32x16_bf16 v[48:63], v[64:67], v[88:91], v[48:63]
    v_cvt_pk_bf16_f32 v92, v24, v25
    v_exp_f32 v28, v28
    buffer_load_dwordx4 v[216:219], v15, s[56:59], s41 offen sc1
    buffer_load_dwordx4 v[220:223], v15, s[56:59], s42 offen sc1
    v_exp_f32 v29, v29
    v_cvt_pk_bf16_f32 v93, v26, v27
    v_exp_f32 v30, v30
    v_exp_f32 v31, v31
    v_cvt_pk_bf16_f32 v94, v28, v29
    v_exp_f32 v32, v32
    v_cvt_pk_bf16_f32 v95, v30, v31
    v_exp_f32 v33, v33
    v_exp_f32 v34, v34
    v_mfma_f32_32x32x16_bf16 v[48:63], v[68:71], v[92:95], v[48:63]
    v_exp_f32 v35, v35
    v_cvt_pk_bf16_f32 v88, v32, v33
    v_add_u32 v15, 16384, v2
    buffer_load_dwordx4 v[160:163], v15, s[56:59], s21 offen sc1
    buffer_load_dwordx4 v[164:167], v15, s[56:59], s40 offen sc1
    v_exp_f32 v36, v36
    s_cmp_gt_u32 s6, 6
    s_cselect_b64 exec, s[0:1], -1
    ds_read_b128 v[64:67], v125 offset:4096
    ds_read_b128 v[68:71], v125 offset:4608
    s_mov_b64 exec, -1
    v_exp_f32 v37, v37
    v_cvt_pk_bf16_f32 v89, v34, v35
    v_exp_f32 v38, v38
    s_waitcnt lgkmcnt(2)
    v_exp_f32 v39, v39
    v_mfma_f32_32x32x16_bf16 v[16:31], v[96:99], v[80:83], 0
    v_cvt_pk_bf16_f32 v90, v36, v37
    v_exp_f32 v40, v40
    v_cvt_pk_bf16_f32 v91, v38, v39
    v_exp_f32 v41, v41
    v_exp_f32 v42, v42
    ds_read_b128 v[100:103], v122 offset:2048
    v_exp_f32 v43, v43
    v_mfma_f32_32x32x16_bf16 v[48:63], v[72:75], v[88:91], v[48:63]
    v_cvt_pk_bf16_f32 v92, v40, v41
    v_exp_f32 v44, v44
    buffer_load_dwordx4 v[224:227], v15, s[56:59], s41 offen sc1
    buffer_load_dwordx4 v[228:231], v15, s[56:59], s42 offen sc1
    v_exp_f32 v45, v45
    v_cvt_pk_bf16_f32 v93, v42, v43
    v_exp_f32 v46, v46
    v_exp_f32 v47, v47
    v_cvt_pk_bf16_f32 v94, v44, v45
    v_exp_f32 v16, v16
    v_cvt_pk_bf16_f32 v95, v46, v47
    v_exp_f32 v17, v17
    v_exp_f32 v18, v18
    v_mfma_f32_32x32x16_bf16 v[48:63], v[76:79], v[92:95], v[48:63]
    v_exp_f32 v19, v19
    v_cvt_pk_bf16_f32 v88, v16, v17
    v_add_u32 v15, 20480, v2
    buffer_load_dwordx4 v[168:171], v15, s[56:59], s21 offen sc1
    buffer_load_dwordx4 v[172:175], v15, s[56:59], s40 offen sc1
    v_exp_f32 v20, v20
    s_cmp_gt_u32 s6, 7
    s_cselect_b64 exec, s[0:1], -1
    ds_read_b128 v[72:75], v125 offset:2048
    ds_read_b128 v[76:79], v125 offset:2560
    s_mov_b64 exec, -1
    v_exp_f32 v21, v21
    v_cvt_pk_bf16_f32 v89, v18, v19
    v_exp_f32 v22, v22
    s_waitcnt lgkmcnt(2)
    v_exp_f32 v23, v23
    v_mfma_f32_32x32x16_bf16 v[32:47], v[100:103], v[80:83], 0
    v_cvt_pk_bf16_f32 v90, v20, v21
    v_exp_f32 v24, v24
    v_cvt_pk_bf16_f32 v91, v22, v23
    v_exp_f32 v25, v25
    v_exp_f32 v26, v26
    ds_read_b128 v[96:99], v122 offset:0
    v_exp_f32 v27, v27
    v_mfma_f32_32x32x16_bf16 v[48:63], v[64:67], v[88:91], v[48:63]
    v_cvt_pk_bf16_f32 v92, v24, v25
    v_exp_f32 v28, v28
    buffer_load_dwordx4 v[232:235], v15, s[56:59], s41 offen sc1
    buffer_load_dwordx4 v[236:239], v15, s[56:59], s42 offen sc1
    v_exp_f32 v29, v29
    v_cvt_pk_bf16_f32 v93, v26, v27
    v_exp_f32 v30, v30
    v_exp_f32 v31, v31
    v_cvt_pk_bf16_f32 v94, v28, v29
    v_exp_f32 v32, v32
    v_cvt_pk_bf16_f32 v95, v30, v31
    v_exp_f32 v33, v33
    v_exp_f32 v34, v34
    v_mfma_f32_32x32x16_bf16 v[48:63], v[68:71], v[92:95], v[48:63]
    v_exp_f32 v35, v35
    v_cvt_pk_bf16_f32 v88, v32, v33
    v_add_u32 v15, 24576, v2
    buffer_load_dwordx4 v[176:179], v15, s[56:59], s21 offen sc1
    buffer_load_dwordx4 v[180:183], v15, s[56:59], s40 offen sc1
    v_exp_f32 v36, v36
    s_cmp_gt_u32 s6, 8
    s_cselect_b64 exec, s[0:1], -1
    ds_read_b128 v[64:67], v125 offset:0
    ds_read_b128 v[68:71], v125 offset:512
    s_mov_b64 exec, -1
    v_exp_f32 v37, v37
    v_cvt_pk_bf16_f32 v89, v34, v35
    v_exp_f32 v38, v38
    s_waitcnt lgkmcnt(2)
    v_exp_f32 v39, v39
    v_mfma_f32_32x32x16_bf16 v[16:31], v[96:99], v[80:83], v[104:119]
    v_cvt_pk_bf16_f32 v90, v36, v37
    v_exp_f32 v40, v40
    v_cvt_pk_bf16_f32 v91, v38, v39
    v_exp_f32 v41, v41
    v_exp_f32 v42, v42
    v_exp_f32 v43, v43
    v_mfma_f32_32x32x16_bf16 v[48:63], v[72:75], v[88:91], v[48:63]
    v_cvt_pk_bf16_f32 v92, v40, v41
    v_exp_f32 v44, v44
    buffer_load_dwordx4 v[240:243], v15, s[56:59], s41 offen sc1
    buffer_load_dwordx4 v[244:247], v15, s[56:59], s42 offen sc1
    v_exp_f32 v45, v45
    v_cvt_pk_bf16_f32 v93, v42, v43
    v_exp_f32 v46, v46
    v_exp_f32 v47, v47
    v_cvt_pk_bf16_f32 v94, v44, v45
    v_exp_f32 v16, v16
    v_cvt_pk_bf16_f32 v95, v46, v47
    v_exp_f32 v17, v17
    v_exp_f32 v18, v18
    v_mfma_f32_32x32x16_bf16 v[48:63], v[76:79], v[92:95], v[48:63]
    v_exp_f32 v19, v19
    v_cvt_pk_bf16_f32 v88, v16, v17
    v_add_u32 v15, 28672, v2
    buffer_load_dwordx4 v[184:187], v15, s[56:59], s21 offen sc1
    buffer_load_dwordx4 v[188:191], v15, s[56:59], s40 offen sc1
    v_exp_f32 v20, v20
    v_exp_f32 v21, v21
    v_cvt_pk_bf16_f32 v89, v18, v19
    v_exp_f32 v22, v22
    v_exp_f32 v23, v23
    v_cvt_pk_bf16_f32 v90, v20, v21
    v_exp_f32 v24, v24
    v_cvt_pk_bf16_f32 v91, v22, v23
    v_exp_f32 v25, v25
    v_exp_f32 v26, v26
    s_waitcnt lgkmcnt(0)
    v_exp_f32 v27, v27
    v_mfma_f32_32x32x16_bf16 v[48:63], v[64:67], v[88:91], v[48:63]
    v_cvt_pk_bf16_f32 v92, v24, v25
    v_exp_f32 v28, v28
    buffer_load_dwordx4 v[248:251], v15, s[56:59], s41 offen sc1
    buffer_load_dwordx4 v[252:255], v15, s[56:59], s42 offen sc1
    v_exp_f32 v29, v29
    v_cvt_pk_bf16_f32 v93, v26, v27
    v_exp_f32 v30, v30
    v_exp_f32 v31, v31
    v_cvt_pk_bf16_f32 v94, v28, v29
    v_cvt_pk_bf16_f32 v95, v30, v31
    s_nop 1
    v_mfma_f32_32x32x16_bf16 v[48:63], v[68:71], v[92:95], v[48:63]
L_attn_finB:
    s_mov_b32 s78, 0x30800000
    s_mov_b32 s79, 0x4e800000
    s_waitcnt lgkmcnt(0)
    s_nop 8
    v_mul_f32 v85, v84, v56
    v_cmp_nle_f32 vcc, s78, v56
    v_cmp_nge_f32 s[74:75], s79, v56
    v_rcp_f32 v86, v85
    s_or_b64 vcc, vcc, s[74:75]
    s_cbranch_vccnz L_attn_slow
L_attn_okB:
    v_mul_f32 v48, v48, v86
    v_mul_f32 v49, v49, v86
    v_mul_f32 v50, v50, v86
    v_mul_f32 v51, v51, v86
    v_mul_f32 v52, v52, v86
    v_mul_f32 v53, v53, v86
    v_mul_f32 v54, v54, v86
    v_mul_f32 v55, v55, v86
    v_cvt_pk_bf16_f32 v48, v48, v49
    v_cvt_pk_bf16_f32 v49, v50, v51
    v_cvt_pk_bf16_f32 v50, v52, v53
    v_cvt_pk_bf16_f32 v51, v54, v55
    buffer_store_dwordx4 v[48:51], v2, s[56:59], s4 offen sc1
    v_mov_b32 v5, 0
    s_mov_b32 exec_hi, 0xffff
    buffer_atomic_or v5, v10, s[56:59], 0 offen sc0 sc1
    s_mov_b64 exec, -1
Lsp_16:
    ds_read_b32 v3, v126 offset:32
    s_waitcnt lgkmcnt(0)
    v_readfirstlane_b32 s79, v3
    s_nop 0
    s_cmp_ge_u32 s79, 4
    s_cbranch_scc1 Lsd_17
    s_sleep 1
    s_sub_u32 s73, s73, 1
    s_cmp_gt_i32 s73, 0
    s_cbranch_scc1 Lsp_16
Lsd_17:
    ds_read_b128 v[16:19], v6 offset:0
    ds_read_b128 v[32:35], v7 offset:0
    ds_read_b128 v[20:23], v6 offset:16
    ds_read_b128 v[36:39], v7 offset:16
    ds_read_b128 v[24:27], v6 offset:2048
    ds_read_b128 v[40:43], v7 offset:2048
    ds_read_b128 v[28:31], v6 offset:2064
    ds_read_b128 v[44:47], v7 offset:2064
    s_waitcnt lgkmcnt(4)
    v_add_f32 v16, v16, v32
    v_add_f32 v17, v17, v33
    v_add_f32 v18, v18, v34
    v_add_f32 v19, v19, v35
    v_add_f32 v20, v20, v36
    v_add_f32 v21, v21, v37
    v_add_f32 v22, v22, v38
    v_add_f32 v23, v23, v39
    v_cvt_pk_bf16_f32 v88, v16, v17
    v_cvt_pk_bf16_f32 v89, v18, v19
    v_cvt_pk_bf16_f32 v90, v20, v21
    v_cvt_pk_bf16_f32 v91, v22, v23
    buffer_store_dwordx4 v[88:91], v2, s[56:59], s11 offen offset:0 sc1
    s_waitcnt lgkmcnt(0)
    v_add_f32 v24, v24, v40
    v_add_f32 v25, v25, v41
    v_add_f32 v26, v26, v42
    v_add_f32 v27, v27, v43
    v_add_f32 v28, v28, v44
    v_add_f32 v29, v29, v45
    v_add_f32 v30, v30, v46
    v_add_f32 v31, v31, v47
    v_cvt_pk_bf16_f32 v92, v24, v25
    v_cvt_pk_bf16_f32 v93, v26, v27
    v_cvt_pk_bf16_f32 v94, v28, v29
    v_cvt_pk_bf16_f32 v95, v30, v31
    buffer_store_dwordx4 v[92:95], v2, s[56:59], s11 offen offset:1024 sc1
    s_lshl_b32 s75, s71, 11
    s_add_u32 m0, s75, 81920
    s_add_u32 s74, s13, 15360
    buffer_load_dwordx4 v4, s[32:35], s13 offen lds
    buffer_load_dwordx4 v4, s[32:35], s74 offen offset:1024 lds
    s_setprio 0
    v_rcp_f32 v124, v84
    v_mov_b32 v120, v8
    v_mov_b32 v121, v9
    v_mov_b32 v122, v10
    v_mov_b32 v112, v12
    v_mov_b32 v14, v13
    v_mov_b32 v123, v1
    v_mov_b32 v32, v11
    v_xor_b32 v33, 16, v11
    v_xor_b32 v34, 32, v11
    v_xor_b32 v35, 48, v11
    v_sub_f32 v124, 1.0, v124
    v_xor_b32 v15, 16, v14
    v_mov_b32 v125, v124
    v_mov_b32 v116, 0
    v_mov_b32 v117, 0
    v_mov_b32 v118, 0
    v_mov_b32 v119, 0
    s_waitcnt vmcnt(5)
    v_mov_b32 v4, s70
    s_mov_b64 exec, 1
    buffer_atomic_swap v4, off, s[56:59], s5 sc1
    s_mov_b64 exec, -1
    s_add_u32 s30, s16, 8192
    s_add_u32 s15, s14, 64512
    s_mov_b32 s6, 7
    s_mov_b32 s24, 0
    s_mov_b32 s25, 8
    v_mul_u32_u24 v3, 8192, v0
    s_waitcnt vmcnt(3)
    s_mov_b64 exec, 15
    buffer_atomic_swap v4, v3, s[56:59], s12 offen sc1
    s_mov_b64 exec, -1
    s_branch L_pl_q
L_pl_w:
    s_mov_b32 s25, s24
    s_sub_u32 s73, s73, 8
    s_waitcnt vmcnt(0)
L_pl_w2:
    v_cmp_ne_u32 vcc, s70, v5
    s_cmp_gt_i32 s73, 0
    s_cselect_b64 vcc, vcc, 0
    s_cmp_eq_u32 vcc_lo, 0
    s_cselect_b32 s74, 1, 0
    s_and_b32 s75, vcc_hi, 0xff
    s_cselect_b32 s75, 0, 2
    s_or_b32 s74, s74, s75
    s_and_b32 s75, vcc_hi, 0xff00
    s_cselect_b32 s75, 0, 4
    s_or_b32 s74, s74, s75
    s_and_b32 s24, s74, s6
    s_cbranch_scc0 L_pl_p
    s_andn2_b32 s6, s6, s24
    s_bitcmp1_b32 s24, 2
    s_cbranch_scc0 L_pl_i1
    buffer_load_dwordx4 v[80:83], v2, s[56:59], s47 offen offset:0 sc1
    buffer_load_dwordx4 v[84:87], v2, s[56:59], s47 offen offset:2048 sc1
    s_add_u32 s47, s47, 4096
    buffer_load_dwordx4 v[88:91], v2, s[56:59], s47 offen offset:0 sc1
    buffer_load_dwordx4 v[92:95], v2, s[56:59], s47 offen offset:2048 sc1
    s_add_u32 s47, s47, 4096
    buffer_load_dwordx4 v[96:99], v2, s[56:59], s47 offen offset:0 sc1
    buffer_load_dwordx4 v[100:103], v2, s[56:59], s47 offen offset:2048 sc1
    s_add_u32 s47, s47, 4096
    buffer_load_dwordx4 v[104:107], v2, s[56:59], s47 offen offset:0 sc1
    buffer_load_dwordx4 v[108:111], v2, s[56:59], s47 offen offset:2048 sc1
L_pl_i1:
    s_bitcmp1_b32 s24, 1
    s_cbranch_scc0 L_pl_i0
    buffer_load_dwordx4 v[48:51], v2, s[56:59], s18 offen offset:0 sc1
    buffer_load_dwordx4 v[52:55], v2, s[56:59], s18 offen offset:2048 sc1
    s_add_u32 s18, s18, 4096
    buffer_load_dwordx4 v[56:59], v2, s[56:59], s18 offen offset:0 sc1
    buffer_load_dwordx4 v[60:63], v2, s[56:59], s18 offen offset:2048 sc1
    s_add_u32 s18, s18, 4096
    buffer_load_dwordx4 v[64:67], v2, s[56:59], s18 offen offset:0 sc1
    buffer_load_dwordx4 v[68:71], v2, s[56:59], s18 offen offset:2048 sc1
    s_add_u32 s18, s18, 4096
    buffer_load_dwordx4 v[72:75], v2, s[56:59], s18 offen offset:0 sc1
    buffer_load_dwordx4 v[76:79], v2, s[56:59], s18 offen offset:2048 sc1
L_pl_i0:
    s_bitcmp1_b32 s24, 0
    s_cbranch_scc0 L_pl_p
    buffer_load_dwordx4 v121, s[56:59], s14 offen sc1 lds
    buffer_load_dwordx4 v121, s[56:59], s15 offen offset:1024 sc1 lds
L_pl_p:
    s_cmp_eq_u32 s6, 0
    s_cbranch_scc1 L_pl_q
    v_mov_b32 v5, 0
    s_bitcmp1_b32 s6, 0
    s_cselect_b32 exec_lo, -1, 0
    s_mov_b32 exec_hi, 0xffff
    buffer_atomic_or v5, v122, s[56:59], 0 offen sc0 sc1
    s_mov_b64 exec, -1
L_pl_q:
    s_cmp_eq_u32 s25, 0
    s_cbranch_scc1 L_pl_n
    s_bitcmp1_b32 s25, 3
    s_cbranch_scc0 L_pl_p0
    s_waitcnt vmcnt(2)
    ds_read_b64 v[6:7], v32
    ds_read_b64 v[8:9], v33
    ds_read_b64 v[10:11], v34
    ds_read_b64 v[12:13], v35
    s_waitcnt lgkmcnt(0)
    v_mfma_f32_32x32x16_bf16 v[16:31], v[116:119], v[116:119], 0
    v_mfma_f32_32x32x16_bf16 v[32:47], v[116:119], v[116:119], 0
    s_mov_b32 s25, 0
    s_branch L_pl_w2
L_pl_p0:
    s_bitcmp1_b32 s25, 0
    s_cbranch_scc0 L_pl_p1
    ds_read_b64_tr_b16 v[114:115], v120 offset:0
    ds_read_b64_tr_b16 v[116:117], v120 offset:512
    ds_read_b64_tr_b16 v[118:119], v120 offset:1024
    ds_read_b64_tr_b16 v[120:121], v120 offset:1536
    v_lshlrev_b32 v0, 16, v6
    v_and_b32 v1, s3, v6
    s_waitcnt lgkmcnt(3)
    v_pk_mul_f32 v[0:1], v[0:1], v[124:125]
    v_lshlrev_b32 v126, 16, v114
    v_and_b32 v127, s3, v114
    v_pk_fma_f32 v[16:17], v[0:1], v[126:127], v[16:17]
    v_lshlrev_b32 v0, 16, v7
    v_and_b32 v1, s3, v7
    v_pk_mul_f32 v[0:1], v[0:1], v[124:125]
    v_lshlrev_b32 v126, 16, v115
    v_and_b32 v127, s3, v115
    v_pk_fma_f32 v[18:19], v[0:1], v[126:127], v[18:19]
    v_lshlrev_b32 v0, 16, v8
    v_and_b32 v1, s3, v8
    s_waitcnt lgkmcnt(2)
    v_pk_mul_f32 v[0:1], v[0:1], v[124:125]
    v_lshlrev_b32 v126, 16, v116
    v_and_b32 v127, s3, v116
    v_pk_fma_f32 v[20:21], v[0:1], v[126:127], v[20:21]
    v_lshlrev_b32 v0, 16, v9
    v_and_b32 v1, s3, v9
    v_pk_mul_f32 v[0:1], v[0:1], v[124:125]
    v_lshlrev_b32 v126, 16, v117
    v_and_b32 v127, s3, v117
    v_pk_fma_f32 v[22:23], v[0:1], v[126:127], v[22:23]
    v_lshlrev_b32 v0, 16, v10
    v_and_b32 v1, s3, v10
    s_waitcnt lgkmcnt(1)
    v_pk_mul_f32 v[0:1], v[0:1], v[124:125]
    v_lshlrev_b32 v126, 16, v118
    v_and_b32 v127, s3, v118
    v_pk_fma_f32 v[24:25], v[0:1], v[126:127], v[24:25]
    v_lshlrev_b32 v0, 16, v11
    v_and_b32 v1, s3, v11
    v_pk_mul_f32 v[0:1], v[0:1], v[124:125]
    v_lshlrev_b32 v126, 16, v119
    v_and_b32 v127, s3, v119
    v_pk_fma_f32 v[26:27], v[0:1], v[126:127], v[26:27]
    v_lshlrev_b32 v0, 16, v12
    v_and_b32 v1, s3, v12
    s_waitcnt lgkmcnt(0)
    v_pk_mul_f32 v[0:1], v[0:1], v[124:125]
    v_lshlrev_b32 v126, 16, v120
    v_and_b32 v127, s3, v120
    v_pk_fma_f32 v[28:29], v[0:1], v[126:127], v[28:29]
    v_lshlrev_b32 v0, 16, v13
    v_and_b32 v1, s3, v13
    v_pk_mul_f32 v[0:1], v[0:1], v[124:125]
    v_lshlrev_b32 v126, 16, v121
    v_and_b32 v127, s3, v121
    v_pk_fma_f32 v[30:31], v[0:1], v[126:127], v[30:31]
    v_xor_b32 v113, 32, v112
    v_xor_b32 v114, 64, v112
    v_xor_b32 v115, 96, v112
    v_xor_b32 v116, 128, v112
    v_xor_b32 v117, 160, v112
    v_xor_b32 v118, 192, v112
    v_xor_b32 v119, 224, v112
L_pl_p1:
    s_bitcmp1_b32 s25, 1
    s_cbranch_scc0 L_pl_p2
    v_mfma_f32_32x32x16_bf16 v[16:31], v[128:131], v[48:51], v[16:31]
    v_mfma_f32_32x32x16_bf16 v[32:47], v[132:135], v[48:51], v[32:47]
    v_mfma_f32_32x32x16_bf16 v[16:31], v[136:139], v[52:55], v[16:31]
    v_mfma_f32_32x32x16_bf16 v[32:47], v[140:143], v[52:55], v[32:47]
    v_mfma_f32_32x32x16_bf16 v[16:31], v[144:147], v[56:59], v[16:31]
    v_mfma_f32_32x32x16_bf16 v[32:47], v[148:151], v[56:59], v[32:47]
    v_mfma_f32_32x32x16_bf16 v[16:31], v[152:155], v[60:63], v[16:31]
    v_mfma_f32_32x32x16_bf16 v[32:47], v[156:159], v[60:63], v[32:47]
    v_mfma_f32_32x32x16_bf16 v[16:31], v[160:163], v[64:67], v[16:31]
    v_mfma_f32_32x32x16_bf16 v[32:47], v[164:167], v[64:67], v[32:47]
    v_mfma_f32_32x32x16_bf16 v[16:31], v[168:171], v[68:71], v[16:31]
    v_mfma_f32_32x32x16_bf16 v[32:47], v[172:175], v[68:71], v[32:47]
    v_mfma_f32_32x32x16_bf16 v[16:31], v[176:179], v[72:75], v[16:31]
    v_mfma_f32_32x32x16_bf16 v[32:47], v[180:183], v[72:75], v[32:47]
    v_mfma_f32_32x32x16_bf16 v[16:31], v[184:187], v[76:79], v[16:31]
    v_mfma_f32_32x32x16_bf16 v[32:47], v[188:191], v[76:79], v[32:47]
L_pl_p2:
    s_bitcmp1_b32 s25, 2
    s_cbranch_scc0 L_pl_n
    v_mfma_f32_32x32x16_bf16 v[16:31], v[192:195], v[80:83], v[16:31]
    v_mfma_f32_32x32x16_bf16 v[32:47], v[196:199], v[80:83], v[32:47]
    v_mfma_f32_32x32x16_bf16 v[16:31], v[200:203], v[84:87], v[16:31]
    v_mfma_f32_32x32x16_bf16 v[32:47], v[204:207], v[84:87], v[32:47]
    v_mfma_f32_32x32x16_bf16 v[16:31], v[208:211], v[88:91], v[16:31]
    v_mfma_f32_32x32x16_bf16 v[32:47], v[212:215], v[88:91], v[32:47]
    v_mfma_f32_32x32x16_bf16 v[16:31], v[216:219], v[92:95], v[16:31]
    v_mfma_f32_32x32x16_bf16 v[32:47], v[220:223], v[92:95], v[32:47]
    v_mfma_f32_32x32x16_bf16 v[16:31], v[224:227], v[96:99], v[16:31]
    v_mfma_f32_32x32x16_bf16 v[32:47], v[228:231], v[96:99], v[32:47]
    v_mfma_f32_32x32x16_bf16 v[16:31], v[232:235], v[100:103], v[16:31]
    v_mfma_f32_32x32x16_bf16 v[32:47], v[236:239], v[100:103], v[32:47]
    v_mfma_f32_32x32x16_bf16 v[16:31], v[240:243], v[104:107], v[16:31]
    v_mfma_f32_32x32x16_bf16 v[32:47], v[244:247], v[104:107], v[32:47]
    v_mfma_f32_32x32x16_bf16 v[16:31], v[248:251], v[108:111], v[16:31]
    v_mfma_f32_32x32x16_bf16 v[32:47], v[252:255], v[108:111], v[32:47]
L_pl_n:
    s_cmp_lg_u32 s6, 0
    s_cbranch_scc1 L_pl_w
    s_cmp_eq_u32 s24, 0
    s_cbranch_scc1 L_pl_x
    s_cmp_lg_u32 s24, 4
    s_cbranch_scc1 L_pl_w
L_pl_l:
    s_waitcnt vmcnt(7)
    v_mfma_f32_32x32x16_bf16 v[16:31], v[192:195], v[80:83], v[16:31]
    v_mfma_f32_32x32x16_bf16 v[32:47], v[196:199], v[80:83], v[32:47]
    s_waitcnt vmcnt(6)
    v_mfma_f32_32x32x16_bf16 v[16:31], v[200:203], v[84:87], v[16:31]
    v_mfma_f32_32x32x16_bf16 v[32:47], v[204:207], v[84:87], v[32:47]
    s_waitcnt vmcnt(5)
    v_mfma_f32_32x32x16_bf16 v[16:31], v[208:211], v[88:91], v[16:31]
    v_mfma_f32_32x32x16_bf16 v[32:47], v[212:215], v[88:91], v[32:47]
    s_waitcnt vmcnt(4)
    v_mfma_f32_32x32x16_bf16 v[16:31], v[216:219], v[92:95], v[16:31]
    v_mfma_f32_32x32x16_bf16 v[32:47], v[220:223], v[92:95], v[32:47]
    s_waitcnt vmcnt(3)
    v_mfma_f32_32x32x16_bf16 v[16:31], v[224:227], v[96:99], v[16:31]
    v_mfma_f32_32x32x16_bf16 v[32:47], v[228:231], v[96:99], v[32:47]
    s_waitcnt vmcnt(2)
    v_mfma_f32_32x32x16_bf16 v[16:31], v[232:235], v[100:103], v[16:31]
    v_mfma_f32_32x32x16_bf16 v[32:47], v[236:239], v[100:103], v[32:47]
    s_waitcnt vmcnt(1)
    v_mfma_f32_32x32x16_bf16 v[16:31], v[240:243], v[104:107], v[16:31]
    v_mfma_f32_32x32x16_bf16 v[32:47], v[244:247], v[104:107], v[32:47]
    s_waitcnt vmcnt(0)
    v_mfma_f32_32x32x16_bf16 v[16:31], v[248:251], v[108:111], v[16:31]
    v_mfma_f32_32x32x16_bf16 v[32:47], v[252:255], v[108:111], v[32:47]
L_pl_x:
    s_nop 10
    ds_write_b128 v112, v[16:19]
    ds_write_b128 v113, v[20:23]
    ds_write_b128 v114, v[24:27]
    ds_write_b128 v115, v[28:31]
    ds_write_b128 v116, v[32:35]
    ds_write_b128 v117, v[36:39]
    ds_write_b128 v118, v[40:43]
    ds_write_b128 v119, v[44:47]
    s_waitcnt lgkmcnt(0)
    s_barrier
    ds_read_b128 v[48:51], v14 offset:0
    ds_read_b128 v[52:55], v15 offset:0
    ds_read_b128 v[56:59], v14 offset:33280
    ds_read_b128 v[60:63], v15 offset:33280
    ds_read_b128 v[64:67], v14 offset:2048
    ds_read_b128 v[68:71], v15 offset:2048
    ds_read_b128 v[72:75], v14 offset:35328
    ds_read_b128 v[76:79], v15 offset:35328
    s_waitcnt lgkmcnt(4)
    v_pk_add_f32 v[48:49], v[48:49], v[56:57]
    v_pk_add_f32 v[50:51], v[50:51], v[58:59]
    v_pk_add_f32 v[52:53], v[52:53], v[60:61]
    v_pk_add_f32 v[54:55], v[54:55], v[62:63]
    v_cvt_pk_bf16_f32 v48, v48, v49
    v_cvt_pk_bf16_f32 v49, v50, v51
    v_cvt_pk_bf16_f32 v50, v52, v53
    v_cvt_pk_bf16_f32 v51, v54, v55
    buffer_store_dwordx4 v[48:51], v123, s[60:63], s16 offen sc1
    s_waitcnt lgkmcnt(0)
    v_pk_add_f32 v[64:65], v[64:65], v[72:73]
    v_pk_add_f32 v[66:67], v[66:67], v[74:75]
    v_pk_add_f32 v[68:69], v[68:69], v[76:77]
    v_pk_add_f32 v[70:71], v[70:71], v[78:79]
    v_cvt_pk_bf16_f32 v64, v64, v65
    v_cvt_pk_bf16_f32 v65, v66, v67
    v_cvt_pk_bf16_f32 v66, v68, v69
    v_cvt_pk_bf16_f32 v67, v70, v71
    buffer_store_dwordx4 v[64:67], v123, s[60:63], s30 offen sc1
L_end:
    s_endpgm
L_a1:
    s_barrier
    ds_read_b128 v[128:131], v8 offset:0
    ds_read_b64_tr_b16 v[64:65], v12 offset:2048
    ds_read_b64_tr_b16 v[66:67], v12 offset:2560
    ds_read_b128 v[132:135], v9 offset:0
    ds_read_b64_tr_b16 v[68:69], v12 offset:6144
    ds_read_b64_tr_b16 v[70:71], v12 offset:6656
    ds_read_b128 v[136:139], v10 offset:0
    ds_read_b64_tr_b16 v[72:73], v13 offset:2048
    ds_read_b64_tr_b16 v[74:75], v13 offset:2560
    ds_read_b128 v[140:143], v11 offset:0
    ds_read_b64_tr_b16 v[76:77], v13 offset:6144
    ds_read_b64_tr_b16 v[78:79], v13 offset:6656
    ds_read_b128 v[32:35], v1 offset:0
    ds_read_b128 v[36:39], v1 offset:32
    s_waitcnt lgkmcnt(0)
    s_barrier
    ds_read_b128 v[144:147], v8 offset:16384
    ds_read_b64_tr_b16 v[80:81], v12 offset:18432
    ds_read_b64_tr_b16 v[82:83], v12 offset:18944
    v_mfma_f32_32x32x16_bf16 v[16:31], v[64:67], v[128:131], 0
    ds_read_b128 v[148:151], v9 offset:16384
    ds_read_b64_tr_b16 v[84:85], v12 offset:22528
    ds_read_b64_tr_b16 v[86:87], v12 offset:23040
    v_mfma_f32_32x32x16_bf16 v[16:31], v[68:71], v[132:135], v[16:31]
    ds_read_b128 v[152:155], v10 offset:16384
    ds_read_b64_tr_b16 v[88:89], v13 offset:18432
    ds_read_b64_tr_b16 v[90:91], v13 offset:18944
    v_mfma_f32_32x32x16_bf16 v[16:31], v[72:75], v[136:139], v[16:31]
    ds_read_b128 v[156:159], v11 offset:16384
    ds_read_b64_tr_b16 v[92:93], v13 offset:22528
    ds_read_b64_tr_b16 v[94:95], v13 offset:23040
    v_mfma_f32_32x32x16_bf16 v[16:31], v[76:79], v[140:143], v[16:31]
    ds_read_b128 v[40:43], v1 offset:128
    v_mfma_f32_32x32x16_bf16 v[48:63], v[32:35], v[128:131], 0
    ds_read_b128 v[44:47], v1 offset:160
    v_mfma_f32_32x32x16_bf16 v[48:63], v[36:39], v[132:135], v[48:63]
    s_waitcnt lgkmcnt(0)
    s_barrier
    ds_read_b128 v[160:163], v8 offset:32768
    ds_read_b64_tr_b16 v[96:97], v12 offset:34816
    ds_read_b64_tr_b16 v[98:99], v12 offset:35328
    v_mfma_f32_32x32x16_bf16 v[16:31], v[80:83], v[144:147], v[16:31]
    ds_read_b128 v[164:167], v9 offset:32768
    ds_read_b64_tr_b16 v[100:101], v12 offset:38912
    ds_read_b64_tr_b16 v[102:103], v12 offset:39424
    v_mfma_f32_32x32x16_bf16 v[16:31], v[84:87], v[148:151], v[16:31]
    ds_read_b128 v[168:171], v10 offset:32768
    ds_read_b64_tr_b16 v[104:105], v13 offset:34816
    ds_read_b64_tr_b16 v[106:107], v13 offset:35328
    v_mfma_f32_32x32x16_bf16 v[16:31], v[88:91], v[152:155], v[16:31]
    ds_read_b128 v[172:175], v11 offset:32768
    ds_read_b64_tr_b16 v[108:109], v13 offset:38912
    ds_read_b64_tr_b16 v[110:111], v13 offset:39424
    v_mfma_f32_32x32x16_bf16 v[16:31], v[92:95], v[156:159], v[16:31]
    ds_read_b128 v[32:35], v1 offset:256
    v_mfma_f32_32x32x16_bf16 v[48:63], v[40:43], v[144:147], v[48:63]
    ds_read_b128 v[36:39], v1 offset:288
    v_mfma_f32_32x32x16_bf16 v[48:63], v[44:47], v[148:151], v[48:63]
    s_waitcnt lgkmcnt(0)
    s_waitcnt vmcnt(2)
    s_barrier
    ds_read_b128 v[176:179], v8 offset:49152
    ds_read_b64_tr_b16 v[64:65], v12 offset:51200
    ds_read_b64_tr_b16 v[66:67], v12 offset:51712
    v_mfma_f32_32x32x16_bf16 v[16:31], v[96:99], v[160:163], v[16:31]
    ds_read_b128 v[180:183], v9 offset:49152
    ds_read_b64_tr_b16 v[68:69], v12 offset:55296
    ds_read_b64_tr_b16 v[70:71], v12 offset:55808
    v_mfma_f32_32x32x16_bf16 v[16:31], v[100:103], v[164:167], v[16:31]
    ds_read_b128 v[184:187], v10 offset:49152
    ds_read_b64_tr_b16 v[72:73], v13 offset:51200
    ds_read_b64_tr_b16 v[74:75], v13 offset:51712
    v_mfma_f32_32x32x16_bf16 v[16:31], v[104:107], v[168:171], v[16:31]
    ds_read_b128 v[188:191], v11 offset:49152
    ds_read_b64_tr_b16 v[76:77], v13 offset:55296
    ds_read_b64_tr_b16 v[78:79], v13 offset:55808
    v_mfma_f32_32x32x16_bf16 v[16:31], v[108:111], v[172:175], v[16:31]
    ds_read_b128 v[40:43], v1 offset:384
    v_mfma_f32_32x32x16_bf16 v[48:63], v[32:35], v[160:163], v[48:63]
    v_add_u32 v8, 0x10000, v8
    v_add_u32 v9, 0x10000, v9
    v_add_u32 v10, 0x10000, v10
    v_add_u32 v11, 0x10000, v11
    ds_read_b128 v[44:47], v1 offset:416
    v_mfma_f32_32x32x16_bf16 v[48:63], v[36:39], v[164:167], v[48:63]
    s_waitcnt lgkmcnt(0)
    s_waitcnt vmcnt(0)
    v_readfirstlane_b32 s70, v253
    v_and_b32 v116, v116, v252
    v_and_b32 v117, v117, v252
    v_and_b32 v118, v118, v252
    v_and_b32 v119, v119, v252
    s_add_u32 s70, s70, 2654435769
    v_mov_b32 v255, s70
    s_mov_b64 exec, 1
    buffer_atomic_swap v255, off, s[56:59], s8 sc1
    s_mov_b64 exec, -1
    s_lshl2_add_u32 s74, s2, s71
    s_and_b32 s74, s74, 511
    s_mul_i32 s74, s74, 128
    s_add_u32 s74, s74, 8192
    v_mov_b32 v254, 0
    s_mov_b64 exec, 1
    buffer_atomic_or v254, off, s[56:59], s74 sc1
    s_mov_b64 exec, -1
    s_barrier
    ds_read_b128 v[192:195], v8 offset:0
    ds_read_b64_tr_b16 v[80:81], v3 offset:2048
    ds_read_b64_tr_b16 v[82:83], v3 offset:2560
    v_mfma_f32_32x32x16_bf16 v[16:31], v[64:67], v[176:179], v[16:31]
    ds_read_b128 v[196:199], v9 offset:0
    ds_read_b64_tr_b16 v[84:85], v3 offset:6144
    ds_read_b64_tr_b16 v[86:87], v3 offset:6656
    v_mfma_f32_32x32x16_bf16 v[16:31], v[68:71], v[180:183], v[16:31]
    ds_read_b128 v[200:203], v10 offset:0
    ds_read_b64_tr_b16 v[88:89], v4 offset:2048
    ds_read_b64_tr_b16 v[90:91], v4 offset:2560
    v_mfma_f32_32x32x16_bf16 v[16:31], v[72:75], v[184:187], v[16:31]
    ds_read_b128 v[204:207], v11 offset:0
    ds_read_b64_tr_b16 v[92:93], v4 offset:6144
    ds_read_b64_tr_b16 v[94:95], v4 offset:6656
    v_mfma_f32_32x32x16_bf16 v[16:31], v[76:79], v[188:191], v[16:31]
    ds_read_b128 v[32:35], v1 offset:512
    v_mfma_f32_32x32x16_bf16 v[48:63], v[40:43], v[176:179], v[48:63]
    ds_read_b128 v[36:39], v1 offset:544
    v_mfma_f32_32x32x16_bf16 v[48:63], v[44:47], v[180:183], v[48:63]
    s_waitcnt lgkmcnt(0)
    s_barrier
    ds_read_b128 v[208:211], v8 offset:16384
    ds_read_b64_tr_b16 v[96:97], v3 offset:18432
    ds_read_b64_tr_b16 v[98:99], v3 offset:18944
    v_mfma_f32_32x32x16_bf16 v[16:31], v[80:83], v[192:195], v[16:31]
    ds_read_b128 v[212:215], v9 offset:16384
    ds_read_b64_tr_b16 v[100:101], v3 offset:22528
    ds_read_b64_tr_b16 v[102:103], v3 offset:23040
    v_mfma_f32_32x32x16_bf16 v[16:31], v[84:87], v[196:199], v[16:31]
    ds_read_b128 v[216:219], v10 offset:16384
    ds_read_b64_tr_b16 v[104:105], v4 offset:18432
    ds_read_b64_tr_b16 v[106:107], v4 offset:18944
    v_mfma_f32_32x32x16_bf16 v[16:31], v[88:91], v[200:203], v[16:31]
    ds_read_b128 v[220:223], v11 offset:16384
    ds_read_b64_tr_b16 v[108:109], v4 offset:22528
    ds_read_b64_tr_b16 v[110:111], v4 offset:23040
    v_mfma_f32_32x32x16_bf16 v[16:31], v[92:95], v[204:207], v[16:31]
    ds_read_b128 v[40:43], v1 offset:640
    v_mfma_f32_32x32x16_bf16 v[48:63], v[32:35], v[192:195], v[48:63]
    v_subrev_u32 v8, 0x10000, v8
    v_subrev_u32 v9, 0x10000, v9
    v_subrev_u32 v10, 0x10000, v10
    v_subrev_u32 v11, 0x10000, v11
    ds_read_b128 v[44:47], v1 offset:672
    v_mfma_f32_32x32x16_bf16 v[48:63], v[36:39], v[196:199], v[48:63]
    s_waitcnt lgkmcnt(0)
    s_barrier
    ds_read_b128 v[224:227], v8 offset:0
    ds_read_b64_tr_b16 v[64:65], v12 offset:2048
    ds_read_b64_tr_b16 v[66:67], v12 offset:2560
    v_mfma_f32_32x32x16_bf16 v[16:31], v[96:99], v[208:211], v[16:31]
    ds_read_b128 v[228:231], v9 offset:0
    ds_read_b64_tr_b16 v[68:69], v12 offset:6144
    ds_read_b64_tr_b16 v[70:71], v12 offset:6656
    v_mfma_f32_32x32x16_bf16 v[16:31], v[100:103], v[212:215], v[16:31]
    ds_read_b128 v[232:235], v10 offset:0
    ds_read_b64_tr_b16 v[72:73], v13 offset:2048
    ds_read_b64_tr_b16 v[74:75], v13 offset:2560
    v_mfma_f32_32x32x16_bf16 v[16:31], v[104:107], v[216:219], v[16:31]
    ds_read_b128 v[236:239], v11 offset:0
    ds_read_b64_tr_b16 v[76:77], v13 offset:6144
    ds_read_b64_tr_b16 v[78:79], v13 offset:6656
    v_mfma_f32_32x32x16_bf16 v[16:31], v[108:111], v[220:223], v[16:31]
    ds_read_b128 v[32:35], v1 offset:768
    v_mfma_f32_32x32x16_bf16 v[48:63], v[40:43], v[208:211], v[48:63]
    ds_read_b128 v[36:39], v1 offset:800
    v_mfma_f32_32x32x16_bf16 v[48:63], v[44:47], v[212:215], v[48:63]
    s_waitcnt lgkmcnt(0)
    s_barrier
    ds_read_b128 v[240:243], v8 offset:16384
    ds_read_b64_tr_b16 v[80:81], v12 offset:18432
    ds_read_b64_tr_b16 v[82:83], v12 offset:18944
    v_mfma_f32_32x32x16_bf16 v[16:31], v[64:67], v[224:227], v[16:31]
    ds_read_b128 v[244:247], v9 offset:16384
    ds_read_b64_tr_b16 v[84:85], v12 offset:22528
    ds_read_b64_tr_b16 v[86:87], v12 offset:23040
    v_mfma_f32_32x32x16_bf16 v[16:31], v[68:71], v[228:231], v[16:31]
    ds_read_b128 v[248:251], v10 offset:16384
    ds_read_b64_tr_b16 v[88:89], v13 offset:18432
    ds_read_b64_tr_b16 v[90:91], v13 offset:18944
    v_mfma_f32_32x32x16_bf16 v[16:31], v[72:75], v[232:235], v[16:31]
    ds_read_b128 v[252:255], v11 offset:16384
    ds_read_b64_tr_b16 v[92:93], v13 offset:22528
    ds_read_b64_tr_b16 v[94:95], v13 offset:23040
    v_mfma_f32_32x32x16_bf16 v[16:31], v[76:79], v[236:239], v[16:31]
    ds_read_b128 v[40:43], v1 offset:896
    v_mfma_f32_32x32x16_bf16 v[48:63], v[32:35], v[224:227], v[48:63]
    ds_read_b128 v[44:47], v1 offset:928
    v_mfma_f32_32x32x16_bf16 v[48:63], v[36:39], v[228:231], v[48:63]
    s_waitcnt lgkmcnt(0)
    s_barrier
    ds_read_b64_tr_b16 v[96:97], v12 offset:32768
    ds_read_b64_tr_b16 v[98:99], v12 offset:33280
    v_mfma_f32_32x32x16_bf16 v[16:31], v[80:83], v[240:243], v[16:31]
    ds_read_b64_tr_b16 v[100:101], v12 offset:36864
    ds_read_b64_tr_b16 v[102:103], v12 offset:37376
    v_mfma_f32_32x32x16_bf16 v[16:31], v[84:87], v[244:247], v[16:31]
    ds_read_b64_tr_b16 v[104:105], v13 offset:32768
    ds_read_b64_tr_b16 v[106:107], v13 offset:33280
    v_mfma_f32_32x32x16_bf16 v[16:31], v[88:91], v[248:251], v[16:31]
    ds_read_b64_tr_b16 v[108:109], v13 offset:36864
    ds_read_b64_tr_b16 v[110:111], v13 offset:37376
    v_mfma_f32_32x32x16_bf16 v[16:31], v[92:95], v[252:255], v[16:31]
    ds_read_b64_tr_b16 v[64:65], v12 offset:34816
    ds_read_b64_tr_b16 v[66:67], v12 offset:35328
    v_mfma_f32_32x32x16_bf16 v[48:63], v[40:43], v[240:243], v[48:63]
    ds_read_b64_tr_b16 v[68:69], v12 offset:38912
    ds_read_b64_tr_b16 v[70:71], v12 offset:39424
    v_mfma_f32_32x32x16_bf16 v[48:63], v[44:47], v[244:247], v[48:63]
    ds_read_b64_tr_b16 v[72:73], v13 offset:34816
    ds_read_b64_tr_b16 v[74:75], v13 offset:35328
    s_waitcnt lgkmcnt(12)
    v_mfma_f32_32x32x16_bf16 v[32:47], v[128:131], v[96:99], 0
    s_mov_b32 s74, 0x3eb8aa3b
    s_nop 0
    v_mul_f32 v16, s74, v16
    ds_read_b64_tr_b16 v[76:77], v13 offset:38912
    ds_read_b64_tr_b16 v[78:79], v13 offset:39424
    s_waitcnt lgkmcnt(12)
    v_mfma_f32_32x32x16_bf16 v[32:47], v[132:135], v[100:103], v[32:47]
    v_mul_f32 v17, s74, v17
    v_mul_f32 v18, s74, v18
    s_waitcnt lgkmcnt(10)
    v_mfma_f32_32x32x16_bf16 v[32:47], v[136:139], v[104:107], v[32:47]
    v_mul_f32 v19, s74, v19
    v_mul_f32 v20, s74, v20
    v_mul_f32 v21, s74, v21
    v_mul_f32 v22, s74, v22
    s_waitcnt lgkmcnt(8)
    v_mfma_f32_32x32x16_bf16 v[32:47], v[140:143], v[108:111], v[32:47]
    v_mul_f32 v23, s74, v23
    v_mul_f32 v24, s74, v24
    v_mul_f32 v25, s74, v25
    v_mul_f32 v26, s74, v26
    s_waitcnt lgkmcnt(0)
    s_barrier
    ds_read_b64_tr_b16 v[80:81], v12 offset:49152
    ds_read_b64_tr_b16 v[82:83], v12 offset:49664
    v_mfma_f32_32x32x16_bf16 v[32:47], v[144:147], v[64:67], v[32:47]
    v_mul_f32 v27, s74, v27
    v_mul_f32 v28, s74, v28
    v_mul_f32 v29, s74, v29
    ds_read_b64_tr_b16 v[84:85], v12 offset:53248
    ds_read_b64_tr_b16 v[86:87], v12 offset:53760
    v_mfma_f32_32x32x16_bf16 v[32:47], v[148:151], v[68:71], v[32:47]
    v_mul_f32 v30, s74, v30
    v_mul_f32 v31, s74, v31
    v_cvt_pk_bf16_f32 v16, v16, v17
    ds_read_b64_tr_b16 v[88:89], v13 offset:49152
    ds_read_b64_tr_b16 v[90:91], v13 offset:49664
    v_mfma_f32_32x32x16_bf16 v[32:47], v[152:155], v[72:75], v[32:47]
    v_cvt_pk_bf16_f32 v17, v18, v19
    v_cvt_pk_bf16_f32 v18, v20, v21
    v_cvt_pk_bf16_f32 v19, v22, v23
    ds_read_b64_tr_b16 v[92:93], v13 offset:53248
    ds_read_b64_tr_b16 v[94:95], v13 offset:53760
    v_mfma_f32_32x32x16_bf16 v[32:47], v[156:159], v[76:79], v[32:47]
    v_cvt_pk_bf16_f32 v20, v24, v25
    v_cvt_pk_bf16_f32 v21, v26, v27
    v_cvt_pk_bf16_f32 v22, v28, v29
    ds_read_b64_tr_b16 v[96:97], v12 offset:51200
    ds_read_b64_tr_b16 v[98:99], v12 offset:51712
    s_waitcnt lgkmcnt(8)
    v_mfma_f32_32x32x16_bf16 v[32:47], v[160:163], v[80:83], v[32:47]
    v_cvt_pk_bf16_f32 v23, v30, v31
    v_mov_b32 v1, v48
    ds_read_b64_tr_b16 v[100:101], v12 offset:55296
    ds_read_b64_tr_b16 v[102:103], v12 offset:55808
    s_waitcnt lgkmcnt(8)
    v_mfma_f32_32x32x16_bf16 v[32:47], v[164:167], v[84:87], v[32:47]
    buffer_store_dwordx4 v[16:19], v2, s[56:59], s9 offen sc1
    ds_read_b64_tr_b16 v[104:105], v13 offset:51200
    ds_read_b64_tr_b16 v[106:107], v13 offset:51712
    s_waitcnt lgkmcnt(8)
    v_mfma_f32_32x32x16_bf16 v[32:47], v[168:171], v[88:91], v[32:47]
    ds_read_b64_tr_b16 v[108:109], v13 offset:55296
    ds_read_b64_tr_b16 v[110:111], v13 offset:55808
    s_waitcnt lgkmcnt(8)
    v_mfma_f32_32x32x16_bf16 v[32:47], v[172:175], v[92:95], v[32:47]
    s_waitcnt lgkmcnt(0)
    s_barrier
    ds_read_b64_tr_b16 v[64:65], v3 offset:0
    ds_read_b64_tr_b16 v[66:67], v3 offset:512
    v_mfma_f32_32x32x16_bf16 v[32:47], v[176:179], v[96:99], v[32:47]
    ds_read_b64_tr_b16 v[68:69], v3 offset:4096
    ds_read_b64_tr_b16 v[70:71], v3 offset:4608
    v_mfma_f32_32x32x16_bf16 v[32:47], v[180:183], v[100:103], v[32:47]
    ds_read_b64_tr_b16 v[72:73], v4 offset:0
    ds_read_b64_tr_b16 v[74:75], v4 offset:512
    v_mfma_f32_32x32x16_bf16 v[32:47], v[184:187], v[104:107], v[32:47]
    ds_read_b64_tr_b16 v[76:77], v4 offset:4096
    ds_read_b64_tr_b16 v[78:79], v4 offset:4608
    v_mfma_f32_32x32x16_bf16 v[32:47], v[188:191], v[108:111], v[32:47]
    ds_read_b64_tr_b16 v[80:81], v3 offset:2048
    ds_read_b64_tr_b16 v[82:83], v3 offset:2560
    s_waitcnt lgkmcnt(8)
    v_mfma_f32_32x32x16_bf16 v[32:47], v[192:195], v[64:67], v[32:47]
    ds_read_b64_tr_b16 v[84:85], v3 offset:6144
    ds_read_b64_tr_b16 v[86:87], v3 offset:6656
    s_waitcnt lgkmcnt(8)
    v_mfma_f32_32x32x16_bf16 v[32:47], v[196:199], v[68:71], v[32:47]
    ds_read_b64_tr_b16 v[88:89], v4 offset:2048
    ds_read_b64_tr_b16 v[90:91], v4 offset:2560
    s_waitcnt lgkmcnt(8)
    v_mfma_f32_32x32x16_bf16 v[32:47], v[200:203], v[72:75], v[32:47]
    ds_read_b64_tr_b16 v[92:93], v4 offset:6144
    ds_read_b64_tr_b16 v[94:95], v4 offset:6656
    s_waitcnt lgkmcnt(8)
    v_mfma_f32_32x32x16_bf16 v[32:47], v[204:207], v[76:79], v[32:47]
    s_waitcnt lgkmcnt(0)
    s_barrier
    ds_read_b64_tr_b16 v[96:97], v3 offset:16384
    ds_read_b64_tr_b16 v[98:99], v3 offset:16896
    v_mfma_f32_32x32x16_bf16 v[32:47], v[208:211], v[80:83], v[32:47]
    ds_read_b64_tr_b16 v[100:101], v3 offset:20480
    ds_read_b64_tr_b16 v[102:103], v3 offset:20992
    v_mfma_f32_32x32x16_bf16 v[32:47], v[212:215], v[84:87], v[32:47]
    ds_read_b64_tr_b16 v[104:105], v4 offset:16384
    ds_read_b64_tr_b16 v[106:107], v4 offset:16896
    v_mfma_f32_32x32x16_bf16 v[32:47], v[216:219], v[88:91], v[32:47]
    ds_read_b64_tr_b16 v[108:109], v4 offset:20480
    ds_read_b64_tr_b16 v[110:111], v4 offset:20992
    v_mfma_f32_32x32x16_bf16 v[32:47], v[220:223], v[92:95], v[32:47]
    ds_read_b64_tr_b16 v[64:65], v3 offset:18432
    ds_read_b64_tr_b16 v[66:67], v3 offset:18944
    s_waitcnt lgkmcnt(8)
    v_mfma_f32_32x32x16_bf16 v[32:47], v[224:227], v[96:99], v[32:47]
    ds_read_b64_tr_b16 v[68:69], v3 offset:22528
    ds_read_b64_tr_b16 v[70:71], v3 offset:23040
    s_waitcnt lgkmcnt(8)
    v_mfma_f32_32x32x16_bf16 v[32:47], v[228:231], v[100:103], v[32:47]
    buffer_store_dwordx4 v[20:23], v2, s[56:59], s10 offen sc1
    ds_read_b64_tr_b16 v[72:73], v4 offset:18432
    ds_read_b64_tr_b16 v[74:75], v4 offset:18944
    s_waitcnt lgkmcnt(8)
    v_mfma_f32_32x32x16_bf16 v[32:47], v[232:235], v[104:107], v[32:47]
    ds_read_b64_tr_b16 v[76:77], v4 offset:22528
    ds_read_b64_tr_b16 v[78:79], v4 offset:23040
    s_waitcnt lgkmcnt(8)
    v_mfma_f32_32x32x16_bf16 v[32:47], v[236:239], v[108:111], v[32:47]
    s_waitcnt lgkmcnt(0)
    s_barrier
    ds_read_b64_tr_b16 v[80:81], v12 offset:0
    ds_read_b64_tr_b16 v[82:83], v12 offset:512
    v_mfma_f32_32x32x16_bf16 v[32:47], v[240:243], v[64:67], v[32:47]
    ds_read_b64_tr_b16 v[84:85], v12 offset:4096
    ds_read_b64_tr_b16 v[86:87], v12 offset:4608
    v_mfma_f32_32x32x16_bf16 v[32:47], v[244:247], v[68:71], v[32:47]
    ds_read_b64_tr_b16 v[88:89], v13 offset:0
    ds_read_b64_tr_b16 v[90:91], v13 offset:512
    v_mfma_f32_32x32x16_bf16 v[32:47], v[248:251], v[72:75], v[32:47]
    ds_read_b64_tr_b16 v[92:93], v13 offset:4096
    ds_read_b64_tr_b16 v[94:95], v13 offset:4608
    v_mfma_f32_32x32x16_bf16 v[32:47], v[252:255], v[76:79], v[32:47]
    ds_read_b64_tr_b16 v[96:97], v12 offset:2048
    ds_read_b64_tr_b16 v[98:99], v12 offset:2560
    s_waitcnt lgkmcnt(8)
    v_mfma_f32_32x32x16_bf16 v[48:63], v[80:83], v[128:131], 0
    ds_read_b64_tr_b16 v[100:101], v12 offset:6144
    ds_read_b64_tr_b16 v[102:103], v12 offset:6656
    s_waitcnt lgkmcnt(8)
    v_mfma_f32_32x32x16_bf16 v[48:63], v[84:87], v[132:135], v[48:63]
    s_nop 3
    v_cvt_pk_bf16_f32 v32, v32, v33
    v_cvt_pk_bf16_f32 v33, v34, v35
    ds_read_b64_tr_b16 v[104:105], v13 offset:2048
    ds_read_b64_tr_b16 v[106:107], v13 offset:2560
    s_waitcnt lgkmcnt(8)
    v_mfma_f32_32x32x16_bf16 v[48:63], v[88:91], v[136:139], v[48:63]
    v_cvt_pk_bf16_f32 v34, v36, v37
    v_cvt_pk_bf16_f32 v35, v38, v39
    ds_read_b64_tr_b16 v[108:109], v13 offset:6144
    ds_read_b64_tr_b16 v[110:111], v13 offset:6656
    s_waitcnt lgkmcnt(8)
    v_mfma_f32_32x32x16_bf16 v[48:63], v[92:95], v[140:143], v[48:63]
    v_cvt_pk_bf16_f32 v36, v40, v41
    v_cvt_pk_bf16_f32 v37, v42, v43
    v_cvt_pk_bf16_f32 v38, v44, v45
    v_cvt_pk_bf16_f32 v39, v46, v47
    buffer_store_dwordx4 v[32:35], v5, s[56:59], s9 offen offset:1024 sc1
    buffer_store_dwordx4 v[36:39], v5, s[56:59], s9 offen offset:1536 sc1
    s_waitcnt lgkmcnt(0)
    s_barrier
    ds_read_b64_tr_b16 v[64:65], v12 offset:16384
    ds_read_b64_tr_b16 v[66:67], v12 offset:16896
    v_mfma_f32_32x32x16_bf16 v[48:63], v[96:99], v[144:147], v[48:63]
    ds_read_b64_tr_b16 v[68:69], v12 offset:20480
    ds_read_b64_tr_b16 v[70:71], v12 offset:20992
    v_mfma_f32_32x32x16_bf16 v[48:63], v[100:103], v[148:151], v[48:63]
    ds_read_b64_tr_b16 v[72:73], v13 offset:16384
    ds_read_b64_tr_b16 v[74:75], v13 offset:16896
    v_mfma_f32_32x32x16_bf16 v[48:63], v[104:107], v[152:155], v[48:63]
    ds_read_b64_tr_b16 v[76:77], v13 offset:20480
    ds_read_b64_tr_b16 v[78:79], v13 offset:20992
    v_mfma_f32_32x32x16_bf16 v[48:63], v[108:111], v[156:159], v[48:63]
    ds_read_b64_tr_b16 v[80:81], v12 offset:18432
    ds_read_b64_tr_b16 v[82:83], v12 offset:18944
    s_waitcnt lgkmcnt(8)
    v_mfma_f32_32x32x16_bf16 v[48:63], v[64:67], v[160:163], v[48:63]
    v_mov_b32 v144, 0xff61b1e6
    v_mov_b32 v145, 0
    ds_read_b64_tr_b16 v[84:85], v12 offset:22528
    ds_read_b64_tr_b16 v[86:87], v12 offset:23040
    s_waitcnt lgkmcnt(8)
    v_mfma_f32_32x32x16_bf16 v[48:63], v[68:71], v[164:167], v[48:63]
    s_lshl_b32 vcc_lo, -1, 0
    s_lshl_b32 vcc_hi, -1, 4
    ds_read_b64_tr_b16 v[88:89], v13 offset:18432
    ds_read_b64_tr_b16 v[90:91], v13 offset:18944
    s_waitcnt lgkmcnt(8)
    v_mfma_f32_32x32x16_bf16 v[48:63], v[72:75], v[168:171], v[48:63]
    v_cndmask_b32 v128, v144, v145, vcc
    s_lshl_b32 vcc_lo, -1, 1
    ds_read_b64_tr_b16 v[92:93], v13 offset:22528
    ds_read_b64_tr_b16 v[94:95], v13 offset:23040
    s_waitcnt lgkmcnt(8)
    v_mfma_f32_32x32x16_bf16 v[48:63], v[76:79], v[172:175], v[48:63]
    s_lshl_b32 vcc_hi, -1, 5
    v_cndmask_b32 v129, v144, v145, vcc
    s_waitcnt lgkmcnt(0)
    s_barrier
    ds_read_b64_tr_b16 v[96:97], v12 offset:32768
    ds_read_b64_tr_b16 v[98:99], v12 offset:33280
    v_mfma_f32_32x32x16_bf16 v[48:63], v[80:83], v[176:179], v[48:63]
    s_lshl_b32 vcc_lo, -1, 2
    s_lshl_b32 vcc_hi, -1, 6
    v_cndmask_b32 v130, v144, v145, vcc
    ds_read_b64_tr_b16 v[100:101], v12 offset:36864
    ds_read_b64_tr_b16 v[102:103], v12 offset:37376
    v_mfma_f32_32x32x16_bf16 v[48:63], v[84:87], v[180:183], v[48:63]
    s_lshl_b32 vcc_lo, -1, 3
    s_lshl_b32 vcc_hi, -1, 7
    v_cndmask_b32 v131, v144, v145, vcc
    ds_read_b64_tr_b16 v[104:105], v13 offset:32768
    ds_read_b64_tr_b16 v[106:107], v13 offset:33280
    v_mfma_f32_32x32x16_bf16 v[48:63], v[88:91], v[184:187], v[48:63]
    s_lshl_b32 vcc_lo, -1, 8
    s_lshl_b32 vcc_hi, -1, 12
    v_cndmask_b32 v132, v144, v145, vcc
    ds_read_b64_tr_b16 v[108:109], v13 offset:36864
    ds_read_b64_tr_b16 v[110:111], v13 offset:37376
    v_mfma_f32_32x32x16_bf16 v[48:63], v[92:95], v[188:191], v[48:63]
    s_lshl_b32 vcc_lo, -1, 9
    s_lshl_b32 vcc_hi, -1, 13
    v_cndmask_b32 v133, v144, v145, vcc
    ds_read_b64_tr_b16 v[64:65], v12 offset:34816
    ds_read_b64_tr_b16 v[66:67], v12 offset:35328
    s_waitcnt lgkmcnt(8)
    v_mfma_f32_32x32x16_bf16 v[48:63], v[96:99], v[192:195], v[48:63]
    s_lshl_b32 vcc_lo, -1, 10
    s_lshl_b32 vcc_hi, -1, 14
    ds_read_b64_tr_b16 v[68:69], v12 offset:38912
    ds_read_b64_tr_b16 v[70:71], v12 offset:39424
    s_waitcnt lgkmcnt(8)
    v_mfma_f32_32x32x16_bf16 v[48:63], v[100:103], v[196:199], v[48:63]
    v_cndmask_b32 v134, v144, v145, vcc
    s_lshl_b32 vcc_lo, -1, 11
    ds_read_b64_tr_b16 v[72:73], v13 offset:34816
    ds_read_b64_tr_b16 v[74:75], v13 offset:35328
    s_waitcnt lgkmcnt(8)
    v_mfma_f32_32x32x16_bf16 v[48:63], v[104:107], v[200:203], v[48:63]
    s_lshl_b32 vcc_hi, -1, 15
    v_cndmask_b32 v135, v144, v145, vcc
    ds_read_b64_tr_b16 v[76:77], v13 offset:38912
    ds_read_b64_tr_b16 v[78:79], v13 offset:39424
    s_waitcnt lgkmcnt(8)
    v_mfma_f32_32x32x16_bf16 v[48:63], v[108:111], v[204:207], v[48:63]
    s_lshl_b32 vcc_lo, -1, 16
    s_lshl_b32 vcc_hi, -1, 20
    s_waitcnt lgkmcnt(0)
    s_waitcnt vmcnt(0)
    v_mov_b32 v115, s70
    s_mov_b64 exec, 1
    buffer_atomic_swap v115, off, s[56:59], s11 sc1
    s_mov_b64 exec, -1
    s_barrier
    ds_read_b64_tr_b16 v[80:81], v12 offset:49152
    ds_read_b64_tr_b16 v[82:83], v12 offset:49664
    v_mfma_f32_32x32x16_bf16 v[48:63], v[64:67], v[208:211], v[48:63]
    v_cndmask_b32 v136, v144, v145, vcc
    s_lshl_b32 vcc_lo, -1, 17
    s_lshl_b32 vcc_hi, -1, 21
    ds_read_b64_tr_b16 v[84:85], v12 offset:53248
    ds_read_b64_tr_b16 v[86:87], v12 offset:53760
    v_mfma_f32_32x32x16_bf16 v[48:63], v[68:71], v[212:215], v[48:63]
    v_cndmask_b32 v137, v144, v145, vcc
    s_lshl_b32 vcc_lo, -1, 18
    s_lshl_b32 vcc_hi, -1, 22
    ds_read_b64_tr_b16 v[88:89], v13 offset:49152
    ds_read_b64_tr_b16 v[90:91], v13 offset:49664
    v_mfma_f32_32x32x16_bf16 v[48:63], v[72:75], v[216:219], v[48:63]
    v_cndmask_b32 v138, v144, v145, vcc
    s_lshl_b32 vcc_lo, -1, 19
    s_lshl_b32 vcc_hi, -1, 23
    ds_read_b64_tr_b16 v[92:93], v13 offset:53248
    ds_read_b64_tr_b16 v[94:95], v13 offset:53760
    v_mfma_f32_32x32x16_bf16 v[48:63], v[76:79], v[220:223], v[48:63]
    v_cndmask_b32 v139, v144, v145, vcc
    s_lshl_b32 vcc_lo, -1, 24
    s_lshl_b32 vcc_hi, -1, 28
    ds_read_b64_tr_b16 v[96:97], v12 offset:51200
    ds_read_b64_tr_b16 v[98:99], v12 offset:51712
    s_waitcnt lgkmcnt(8)
    v_mfma_f32_32x32x16_bf16 v[48:63], v[80:83], v[224:227], v[48:63]
    v_cndmask_b32 v140, v144, v145, vcc
    s_lshl_b32 vcc_lo, -1, 25
    ds_read_b64_tr_b16 v[100:101], v12 offset:55296
    ds_read_b64_tr_b16 v[102:103], v12 offset:55808
    s_waitcnt lgkmcnt(8)
    v_mfma_f32_32x32x16_bf16 v[48:63], v[84:87], v[228:231], v[48:63]
    s_lshl_b32 vcc_hi, -1, 29
    v_cndmask_b32 v141, v144, v145, vcc
    ds_read_b64_tr_b16 v[104:105], v13 offset:51200
    ds_read_b64_tr_b16 v[106:107], v13 offset:51712
    s_waitcnt lgkmcnt(8)
    v_mfma_f32_32x32x16_bf16 v[48:63], v[88:91], v[232:235], v[48:63]
    s_lshl_b32 vcc_lo, -1, 26
    s_lshl_b32 vcc_hi, -1, 30
    ds_read_b64_tr_b16 v[108:109], v13 offset:55296
    ds_read_b64_tr_b16 v[110:111], v13 offset:55808
    s_waitcnt lgkmcnt(8)
    v_mfma_f32_32x32x16_bf16 v[48:63], v[92:95], v[236:239], v[48:63]
    v_cndmask_b32 v142, v144, v145, vcc
    s_lshl_b32 vcc_lo, -1, 27
    s_waitcnt lgkmcnt(6)
    v_mfma_f32_32x32x16_bf16 v[48:63], v[96:99], v[240:243], v[48:63]
    s_lshl_b32 vcc_hi, -1, 31
    v_cndmask_b32 v143, v144, v145, vcc
    ds_write_b32 v114, v1
    ds_write_b128 v7, v[16:19]
    s_waitcnt lgkmcnt(6)
    v_mfma_f32_32x32x16_bf16 v[48:63], v[100:103], v[244:247], v[48:63]
    ds_write_b128 v7, v[20:23] offset:4096
    s_waitcnt lgkmcnt(5)
    v_mfma_f32_32x32x16_bf16 v[48:63], v[104:107], v[248:251], v[48:63]
    ds_write_b128 v6, v[32:35] offset:1024
    s_waitcnt lgkmcnt(4)
    v_mfma_f32_32x32x16_bf16 v[48:63], v[108:111], v[252:255], v[48:63]
    ds_write_b128 v6, v[36:39] offset:1536
    s_mov_b32 s74, 0x3eb8aa3b
    s_mov_b32 s75, s74
    v_add_u32 v3, s33, v2
    s_nop 7
    v_cvt_pk_bf16_f32 v48, v48, v49
    v_cvt_pk_bf16_f32 v49, v50, v51
    v_cvt_pk_bf16_f32 v50, v52, v53
    v_cvt_pk_bf16_f32 v51, v54, v55
    ds_write_b128 v3, v[48:51]
    v_cvt_pk_bf16_f32 v52, v56, v57
    v_cvt_pk_bf16_f32 v53, v58, v59
    v_cvt_pk_bf16_f32 v54, v60, v61
    v_cvt_pk_bf16_f32 v55, v62, v63
    ds_write_b128 v3, v[52:55] offset:2048
    v_mov_b32 v8, v112
    v_mov_b32 v9, v113
    v_mov_b32 v84, v116
    v_mov_b32 v85, v117
    v_mov_b32 v86, v118
    v_mov_b32 v87, v119
    s_setprio 0
    s_waitcnt lgkmcnt(0)
    s_barrier
    s_or_b32 s74, s2, s71
    s_cbranch_scc0 Lee_19
Leb_20:
    ds_read_b128 v[80:83], v14
    s_mov_b32 vcc_lo, 0x110000
    s_mov_b32 vcc_hi, 0x110000
    v_mov_b32 v65, s27
    v_cndmask_b32 v64, 0, v65, vcc
    v_mov_b32 v65, v64
    v_mov_b32 v66, v64
    v_mov_b32 v67, v64
    v_mov_b32 v68, v64
    v_mov_b32 v69, v64
    v_mov_b32 v70, v64
    v_mov_b32 v71, v64
    v_mov_b32 v72, v64
    ds_read_b128 v[96:99], v120 offset:0
    ds_read_b64 v[4:5], v15
    s_mov_b64 exec, s[0:1]
    ds_read_b128 v[64:67], v123 offset:0
    ds_read_b128 v[68:71], v123 offset:512
    s_mov_b64 exec, -1
    s_waitcnt lgkmcnt(3)
    v_mfma_f32_32x32x16_bf16 v[16:31], v[96:99], v[80:83], v[128:143]
    s_waitcnt lgkmcnt(2)
    v_add_f32 v4, v4, v5
    v_mul_f32 v4, 0xbfb8aa3b, v4
    v_exp_f32 v4, v4
    s_nop 0
    v_add_f32 v4, 1.0, v4
    s_nop 5
    v_exp_f32 v16, v16
    v_exp_f32 v17, v17
    v_exp_f32 v18, v18
    v_exp_f32 v19, v19
    v_cvt_pk_bf16_f32 v88, v16, v17
    v_exp_f32 v20, v20
    v_exp_f32 v21, v21
    v_cvt_pk_bf16_f32 v89, v18, v19
    v_exp_f32 v22, v22
    v_exp_f32 v23, v23
    v_cvt_pk_bf16_f32 v90, v20, v21
    v_exp_f32 v24, v24
    v_exp_f32 v25, v25
    v_cvt_pk_bf16_f32 v91, v22, v23
    v_exp_f32 v26, v26
    v_exp_f32 v27, v27
    v_cvt_pk_bf16_f32 v92, v24, v25
    s_waitcnt lgkmcnt(0)
    v_mfma_f32_32x32x16_bf16 v[48:63], v[64:67], v[88:91], 0
    v_exp_f32 v28, v28
    v_exp_f32 v29, v29
    v_cvt_pk_bf16_f32 v93, v26, v27
    v_exp_f32 v30, v30
    v_exp_f32 v31, v31
    v_cvt_pk_bf16_f32 v94, v28, v29
    v_cvt_pk_bf16_f32 v95, v30, v31
    s_nop 1
    v_mfma_f32_32x32x16_bf16 v[48:63], v[68:71], v[92:95], v[48:63]
    s_or_b32 s74, s2, s71
    s_cbranch_scc0 Lee_21
Leb_22:
Lsp_25:
    ds_read_b32 v3, v126 offset:40
    s_waitcnt lgkmcnt(0)
    v_readfirstlane_b32 s79, v3
    s_nop 0
    s_cmp_ge_u32 s79, 4
    s_cbranch_scc1 Lsd_26
    s_sleep 1
    s_sub_u32 s73, s73, 1
    s_cmp_gt_i32 s73, 0
    s_cbranch_scc1 Lsp_25
Lsd_26:
    ds_read_b64 v[128:129], v8 offset:0
    ds_read_b64 v[130:131], v8 offset:8
    ds_read_b128 v[160:163], v9 offset:3584
    ds_read_b64 v[132:133], v8 offset:512
    ds_read_b64 v[134:135], v8 offset:520
    ds_read_b128 v[164:167], v9 offset:3072
    ds_read_b64 v[136:137], v8 offset:1024
    ds_read_b64 v[138:139], v8 offset:1032
    ds_read_b128 v[168:171], v9 offset:2560
    ds_read_b64 v[140:141], v8 offset:1536
    ds_read_b64 v[142:143], v8 offset:1544
    ds_read_b128 v[172:175], v9 offset:2048
    s_waitcnt lgkmcnt(9)
    v_mfma_f32_16x16x32_bf16 v[16:19], v[160:163], v[128:131], 0
    ds_read_b64 v[144:145], v8 offset:2048
    ds_read_b64 v[146:147], v8 offset:2056
    s_waitcnt lgkmcnt(8)
    v_mfma_f32_16x16x32_bf16 v[20:23], v[164:167], v[128:131], 0
    ds_read_b128 v[176:179], v9 offset:1536
    v_mfma_f32_16x16x32_bf16 v[20:23], v[160:163], v[132:135], v[20:23]
    ds_read_b64 v[148:149], v8 offset:2560
    ds_read_b64 v[150:151], v8 offset:2568
    v_mfma_f32_16x16x32_bf16 v[24:27], v[164:167], v[132:135], 0
    ds_read_b128 v[180:183], v9 offset:1024
    s_waitcnt lgkmcnt(9)
    v_mfma_f32_16x16x32_bf16 v[24:27], v[168:171], v[128:131], v[24:27]
    ds_read_b64 v[152:153], v8 offset:3072
    ds_read_b64 v[154:155], v8 offset:3080
    v_mfma_f32_16x16x32_bf16 v[28:31], v[168:171], v[132:135], 0
    ds_read_b128 v[184:187], v9 offset:512
    v_mfma_f32_16x16x32_bf16 v[24:27], v[160:163], v[136:139], v[24:27]
    ds_read_b64 v[156:157], v8 offset:3584
    ds_read_b64 v[158:159], v8 offset:3592
    v_mfma_f32_16x16x32_bf16 v[28:31], v[164:167], v[136:139], v[28:31]
    ds_read_b128 v[188:191], v9 offset:0
    v_mfma_f32_16x16x32_bf16 v[32:35], v[168:171], v[136:139], 0
    ds_read_b64 v[192:193], v8 offset:64
    ds_read_b64 v[194:195], v8 offset:72
    s_waitcnt lgkmcnt(14)
    v_mfma_f32_16x16x32_bf16 v[28:31], v[172:175], v[128:131], v[28:31]
    v_and_b32 v10, 15, v0
    v_mfma_f32_16x16x32_bf16 v[32:35], v[172:175], v[132:135], v[32:35]
    ds_read_b128 v[224:227], v9 offset:3648
    v_mfma_f32_16x16x32_bf16 v[36:39], v[172:175], v[136:139], 0
    v_lshlrev_b32 v10, 3, v10
    v_mfma_f32_16x16x32_bf16 v[28:31], v[160:163], v[140:143], v[28:31]
    ds_read_b64 v[196:197], v8 offset:576
    ds_read_b64 v[198:199], v8 offset:584
    v_mfma_f32_16x16x32_bf16 v[32:35], v[164:167], v[140:143], v[32:35]
    v_lshrrev_b32 v11, 4, v0
    v_mfma_f32_16x16x32_bf16 v[36:39], v[168:171], v[140:143], v[36:39]
    ds_read_b128 v[228:231], v9 offset:3136
    v_mfma_f32_16x16x32_bf16 v[40:43], v[172:175], v[140:143], 0
    v_lshl_add_u32 v10, v11, 8, v10
    s_waitcnt lgkmcnt(14)
    v_mfma_f32_16x16x32_bf16 v[32:35], v[176:179], v[128:131], v[32:35]
    ds_read_b64 v[200:201], v8 offset:1088
    ds_read_b64 v[202:203], v8 offset:1096
    v_mfma_f32_16x16x32_bf16 v[36:39], v[176:179], v[132:135], v[36:39]
    v_add_u32 v10, s34, v10
    v_mfma_f32_16x16x32_bf16 v[40:43], v[176:179], v[136:139], v[40:43]
    ds_read_b128 v[232:235], v9 offset:2624
    v_mfma_f32_16x16x32_bf16 v[44:47], v[176:179], v[140:143], 0
    s_lshl_b32 s76, s71, 2
    v_mfma_f32_16x16x32_bf16 v[32:35], v[160:163], v[144:147], v[32:35]
    ds_read_b64 v[204:205], v8 offset:1600
    ds_read_b64 v[206:207], v8 offset:1608
    v_mfma_f32_16x16x32_bf16 v[36:39], v[164:167], v[144:147], v[36:39]
    v_add_u32 v12, s76, v126
    v_mfma_f32_16x16x32_bf16 v[40:43], v[168:171], v[144:147], v[40:43]
    ds_read_b128 v[236:239], v9 offset:2112
    v_mfma_f32_16x16x32_bf16 v[44:47], v[172:175], v[144:147], v[44:47]
    s_nop 0
    s_waitcnt lgkmcnt(14)
    v_mfma_f32_16x16x32_bf16 v[36:39], v[180:183], v[128:131], v[36:39]
    ds_read_b64 v[208:209], v8 offset:2112
    ds_read_b64 v[210:211], v8 offset:2120
    v_mfma_f32_16x16x32_bf16 v[40:43], v[180:183], v[132:135], v[40:43]
    v_mov_b32 v73, v72
    v_mfma_f32_16x16x32_bf16 v[44:47], v[180:183], v[136:139], v[44:47]
    ds_read_b128 v[240:243], v9 offset:1600
    v_mfma_f32_16x16x32_bf16 v[36:39], v[160:163], v[148:151], v[36:39]
    v_mov_b32 v74, v72
    v_mfma_f32_16x16x32_bf16 v[40:43], v[164:167], v[148:151], v[40:43]
    ds_read_b64 v[212:213], v8 offset:2624
    ds_read_b64 v[214:215], v8 offset:2632
    v_mfma_f32_16x16x32_bf16 v[44:47], v[168:171], v[148:151], v[44:47]
    v_mov_b32 v75, v72
    v_mfma_f32_16x16x32_bf16 v[40:43], v[184:187], v[128:131], v[40:43]
    ds_read_b128 v[244:247], v9 offset:1088
    v_mfma_f32_16x16x32_bf16 v[44:47], v[184:187], v[132:135], v[44:47]
    v_mov_b32 v76, v72
    v_mfma_f32_16x16x32_bf16 v[40:43], v[160:163], v[152:155], v[40:43]
    ds_read_b64 v[216:217], v8 offset:3136
    ds_read_b64 v[218:219], v8 offset:3144
    v_mfma_f32_16x16x32_bf16 v[44:47], v[164:167], v[152:155], v[44:47]
    v_mov_b32 v77, v72
    s_waitcnt lgkmcnt(14)
    v_mfma_f32_16x16x32_bf16 v[44:47], v[188:191], v[128:131], v[44:47]
    ds_read_b128 v[248:251], v9 offset:576
    v_mfma_f32_16x16x32_bf16 v[44:47], v[160:163], v[156:159], v[44:47]
    v_mov_b32 v78, v72
    v_mfma_f32_16x16x32_bf16 v[16:19], v[160:163], v[84:87], v[16:19]
    v_mfma_f32_16x16x32_bf16 v[20:23], v[164:167], v[84:87], v[20:23]
    v_mfma_f32_16x16x32_bf16 v[24:27], v[168:171], v[84:87], v[24:27]
    v_mfma_f32_16x16x32_bf16 v[28:31], v[172:175], v[84:87], v[28:31]
    v_mfma_f32_16x16x32_bf16 v[32:35], v[176:179], v[84:87], v[32:35]
    v_mfma_f32_16x16x32_bf16 v[36:39], v[180:183], v[84:87], v[36:39]
    v_mfma_f32_16x16x32_bf16 v[40:43], v[184:187], v[84:87], v[40:43]
    v_mfma_f32_16x16x32_bf16 v[44:47], v[188:191], v[84:87], v[44:47]
    v_mfma_f32_16x16x32_bf16 v[16:19], v[224:227], v[192:195], v[16:19]
    ds_read_b64 v[220:221], v8 offset:3648
    ds_read_b64 v[222:223], v8 offset:3656
    v_mfma_f32_16x16x32_bf16 v[20:23], v[228:231], v[192:195], v[20:23]
    ds_read_b128 v[252:255], v9 offset:64
    v_mfma_f32_16x16x32_bf16 v[20:23], v[224:227], v[196:199], v[20:23]
    ds_read_b64 v[128:129], v8 offset:128
    ds_read_b64 v[130:131], v8 offset:136
    v_mfma_f32_16x16x32_bf16 v[24:27], v[228:231], v[196:199], v[24:27]
    v_mov_b32 v79, v72
    s_waitcnt lgkmcnt(14)
    v_mfma_f32_16x16x32_bf16 v[24:27], v[232:235], v[192:195], v[24:27]
    ds_read_b128 v[160:163], v9 offset:3712
    v_mfma_f32_16x16x32_bf16 v[28:31], v[232:235], v[196:199], v[28:31]
    v_mov_b32 v13, 0xff61b1e6
    v_mfma_f32_16x16x32_bf16 v[24:27], v[224:227], v[200:203], v[24:27]
    ds_read_b64 v[132:133], v8 offset:640
    ds_read_b64 v[134:135], v8 offset:648
    v_mfma_f32_16x16x32_bf16 v[28:31], v[228:231], v[200:203], v[28:31]
    s_lshl_b32 vcc_lo, -1, 0
    s_lshl_b32 vcc_hi, -1, 4
    v_mfma_f32_16x16x32_bf16 v[32:35], v[232:235], v[200:203], v[32:35]
    ds_read_b128 v[164:167], v9 offset:3200
    v_mfma_f32_16x16x32_bf16 v[28:31], v[236:239], v[192:195], v[28:31]
    v_cndmask_b32 v104, 0, v13, vcc
    v_mfma_f32_16x16x32_bf16 v[32:35], v[236:239], v[196:199], v[32:35]
    ds_read_b64 v[136:137], v8 offset:1152
    ds_read_b64 v[138:139], v8 offset:1160
    v_mfma_f32_16x16x32_bf16 v[36:39], v[236:239], v[200:203], v[36:39]
    s_lshl_b32 vcc_lo, -1, 1
    s_lshl_b32 vcc_hi, -1, 5
    v_mfma_f32_16x16x32_bf16 v[28:31], v[224:227], v[204:207], v[28:31]
    ds_read_b128 v[168:171], v9 offset:2688
    v_mfma_f32_16x16x32_bf16 v[32:35], v[228:231], v[204:207], v[32:35]
    v_cndmask_b32 v105, 0, v13, vcc
    v_mfma_f32_16x16x32_bf16 v[36:39], v[232:235], v[204:207], v[36:39]
    ds_read_b64 v[140:141], v8 offset:1664
    ds_read_b64 v[142:143], v8 offset:1672
    v_mfma_f32_16x16x32_bf16 v[40:43], v[236:239], v[204:207], v[40:43]
    s_lshl_b32 vcc_lo, -1, 2
    s_lshl_b32 vcc_hi, -1, 6
    s_waitcnt lgkmcnt(14)
    v_mfma_f32_16x16x32_bf16 v[32:35], v[240:243], v[192:195], v[32:35]
    ds_read_b128 v[172:175], v9 offset:2176
    v_mfma_f32_16x16x32_bf16 v[36:39], v[240:243], v[196:199], v[36:39]
    v_cndmask_b32 v106, 0, v13, vcc
    v_mfma_f32_16x16x32_bf16 v[40:43], v[240:243], v[200:203], v[40:43]
    ds_read_b64 v[144:145], v8 offset:2176
    ds_read_b64 v[146:147], v8 offset:2184
    v_mfma_f32_16x16x32_bf16 v[44:47], v[240:243], v[204:207], v[44:47]
    s_lshl_b32 vcc_lo, -1, 3
    s_lshl_b32 vcc_hi, -1, 7
    v_mfma_f32_16x16x32_bf16 v[32:35], v[224:227], v[208:211], v[32:35]
    ds_read_b128 v[176:179], v9 offset:1664
    v_mfma_f32_16x16x32_bf16 v[36:39], v[228:231], v[208:211], v[36:39]
    v_cndmask_b32 v107, 0, v13, vcc
    v_mfma_f32_16x16x32_bf16 v[40:43], v[232:235], v[208:211], v[40:43]
    ds_read_b64 v[148:149], v8 offset:2688
    ds_read_b64 v[150:151], v8 offset:2696
    v_mfma_f32_16x16x32_bf16 v[44:47], v[236:239], v[208:211], v[44:47]
    s_lshl_b32 vcc_lo, -1, 8
    s_lshl_b32 vcc_hi, -1, 12
    v_mfma_f32_16x16x32_bf16 v[36:39], v[244:247], v[192:195], v[36:39]
    ds_read_b128 v[180:183], v9 offset:1152
    v_mfma_f32_16x16x32_bf16 v[40:43], v[244:247], v[196:199], v[40:43]
    v_cndmask_b32 v108, 0, v13, vcc
    v_mfma_f32_16x16x32_bf16 v[44:47], v[244:247], v[200:203], v[44:47]
    ds_read_b64 v[152:153], v8 offset:3200
    ds_read_b64 v[154:155], v8 offset:3208
    v_mfma_f32_16x16x32_bf16 v[36:39], v[224:227], v[212:215], v[36:39]
    s_lshl_b32 vcc_lo, -1, 9
    s_lshl_b32 vcc_hi, -1, 13
    v_mfma_f32_16x16x32_bf16 v[40:43], v[228:231], v[212:215], v[40:43]
    ds_read_b128 v[184:187], v9 offset:640
    v_mfma_f32_16x16x32_bf16 v[44:47], v[232:235], v[212:215], v[44:47]
    v_cndmask_b32 v109, 0, v13, vcc
    v_mfma_f32_16x16x32_bf16 v[40:43], v[248:251], v[192:195], v[40:43]
    ds_read_b64 v[156:157], v8 offset:3712
    ds_read_b64 v[158:159], v8 offset:3720
    v_mfma_f32_16x16x32_bf16 v[44:47], v[248:251], v[196:199], v[44:47]
    s_lshl_b32 vcc_lo, -1, 10
    s_lshl_b32 vcc_hi, -1, 14
    v_mfma_f32_16x16x32_bf16 v[40:43], v[224:227], v[216:219], v[40:43]
    ds_read_b128 v[188:191], v9 offset:128
    v_mfma_f32_16x16x32_bf16 v[44:47], v[228:231], v[216:219], v[44:47]
    v_cndmask_b32 v110, 0, v13, vcc
    s_waitcnt lgkmcnt(14)
    v_mfma_f32_16x16x32_bf16 v[44:47], v[252:255], v[192:195], v[44:47]
    s_lshl_b32 vcc_lo, -1, 11
    s_lshl_b32 vcc_hi, -1, 15
    v_mfma_f32_16x16x32_bf16 v[44:47], v[224:227], v[220:223], v[44:47]
    v_cndmask_b32 v111, 0, v13, vcc
    v_mfma_f32_16x16x32_bf16 v[16:19], v[160:163], v[128:131], v[16:19]
    ds_read_b64 v[192:193], v8 offset:192
    ds_read_b64 v[194:195], v8 offset:200
    v_mfma_f32_16x16x32_bf16 v[20:23], v[164:167], v[128:131], v[20:23]
    s_lshl_b32 vcc_lo, -1, 16
    s_lshl_b32 vcc_hi, -1, 20
    v_mfma_f32_16x16x32_bf16 v[20:23], v[160:163], v[132:135], v[20:23]
    ds_read_b128 v[224:227], v9 offset:3776
    v_mfma_f32_16x16x32_bf16 v[24:27], v[164:167], v[132:135], v[24:27]
    v_cndmask_b32 v112, 0, v13, vcc
    v_mfma_f32_16x16x32_bf16 v[24:27], v[168:171], v[128:131], v[24:27]
    ds_read_b64 v[196:197], v8 offset:704
    ds_read_b64 v[198:199], v8 offset:712
    v_mfma_f32_16x16x32_bf16 v[28:31], v[168:171], v[132:135], v[28:31]
    s_lshl_b32 vcc_lo, -1, 17
    s_lshl_b32 vcc_hi, -1, 21
    v_mfma_f32_16x16x32_bf16 v[24:27], v[160:163], v[136:139], v[24:27]
    ds_read_b128 v[228:231], v9 offset:3264
    v_mfma_f32_16x16x32_bf16 v[28:31], v[164:167], v[136:139], v[28:31]
    v_cndmask_b32 v113, 0, v13, vcc
    v_mfma_f32_16x16x32_bf16 v[32:35], v[168:171], v[136:139], v[32:35]
    ds_read_b64 v[200:201], v8 offset:1216
    ds_read_b64 v[202:203], v8 offset:1224
    s_waitcnt lgkmcnt(14)
    v_mfma_f32_16x16x32_bf16 v[28:31], v[172:175], v[128:131], v[28:31]
    s_lshl_b32 vcc_lo, -1, 18
    s_lshl_b32 vcc_hi, -1, 22
    v_mfma_f32_16x16x32_bf16 v[32:35], v[172:175], v[132:135], v[32:35]
    ds_read_b128 v[232:235], v9 offset:2752
    v_mfma_f32_16x16x32_bf16 v[36:39], v[172:175], v[136:139], v[36:39]
    v_cndmask_b32 v114, 0, v13, vcc
    v_mfma_f32_16x16x32_bf16 v[28:31], v[160:163], v[140:143], v[28:31]
    ds_read_b64 v[204:205], v8 offset:1728
    ds_read_b64 v[206:207], v8 offset:1736
    v_mfma_f32_16x16x32_bf16 v[32:35], v[164:167], v[140:143], v[32:35]
    s_lshl_b32 vcc_lo, -1, 19
    s_lshl_b32 vcc_hi, -1, 23
    v_mfma_f32_16x16x32_bf16 v[36:39], v[168:171], v[140:143], v[36:39]
    ds_read_b128 v[236:239], v9 offset:2240
    v_mfma_f32_16x16x32_bf16 v[40:43], v[172:175], v[140:143], v[40:43]
    v_cndmask_b32 v115, 0, v13, vcc
    v_mfma_f32_16x16x32_bf16 v[32:35], v[176:179], v[128:131], v[32:35]
    ds_read_b64 v[208:209], v8 offset:2240
    ds_read_b64 v[210:211], v8 offset:2248
    v_mfma_f32_16x16x32_bf16 v[36:39], v[176:179], v[132:135], v[36:39]
    s_lshl_b32 vcc_lo, -1, 24
    s_lshl_b32 vcc_hi, -1, 28
    v_mfma_f32_16x16x32_bf16 v[40:43], v[176:179], v[136:139], v[40:43]
    ds_read_b128 v[240:243], v9 offset:1728
    v_mfma_f32_16x16x32_bf16 v[44:47], v[176:179], v[140:143], v[44:47]
    v_cndmask_b32 v116, 0, v13, vcc
    v_mfma_f32_16x16x32_bf16 v[32:35], v[160:163], v[144:147], v[32:35]
    ds_read_b64 v[212:213], v8 offset:2752
    ds_read_b64 v[214:215], v8 offset:2760
    v_mfma_f32_16x16x32_bf16 v[36:39], v[164:167], v[144:147], v[36:39]
    s_lshl_b32 vcc_lo, -1, 25
    s_lshl_b32 vcc_hi, -1, 29
    v_mfma_f32_16x16x32_bf16 v[40:43], v[168:171], v[144:147], v[40:43]
    ds_read_b128 v[244:247], v9 offset:1216
    v_mfma_f32_16x16x32_bf16 v[44:47], v[172:175], v[144:147], v[44:47]
    v_cndmask_b32 v117, 0, v13, vcc
    v_mfma_f32_16x16x32_bf16 v[36:39], v[180:183], v[128:131], v[36:39]
    ds_read_b64 v[216:217], v8 offset:3264
    ds_read_b64 v[218:219], v8 offset:3272
    v_mfma_f32_16x16x32_bf16 v[40:43], v[180:183], v[132:135], v[40:43]
    s_lshl_b32 vcc_lo, -1, 26
    s_lshl_b32 vcc_hi, -1, 30
    v_mfma_f32_16x16x32_bf16 v[44:47], v[180:183], v[136:139], v[44:47]
    ds_read_b128 v[248:251], v9 offset:704
    v_mfma_f32_16x16x32_bf16 v[36:39], v[160:163], v[148:151], v[36:39]
    v_cndmask_b32 v118, 0, v13, vcc
    v_mfma_f32_16x16x32_bf16 v[40:43], v[164:167], v[148:151], v[40:43]
    ds_read_b64 v[220:221], v8 offset:3776
    ds_read_b64 v[222:223], v8 offset:3784
    v_mfma_f32_16x16x32_bf16 v[44:47], v[168:171], v[148:151], v[44:47]
    s_lshl_b32 vcc_lo, -1, 27
    s_lshl_b32 vcc_hi, -1, 31
    s_waitcnt lgkmcnt(14)
    v_mfma_f32_16x16x32_bf16 v[40:43], v[184:187], v[128:131], v[40:43]
    ds_read_b128 v[252:255], v9 offset:192
    v_mfma_f32_16x16x32_bf16 v[44:47], v[184:187], v[132:135], v[44:47]
    v_cndmask_b32 v119, 0, v13, vcc
    v_mfma_f32_16x16x32_bf16 v[40:43], v[160:163], v[152:155], v[40:43]
    v_mfma_f32_16x16x32_bf16 v[44:47], v[164:167], v[152:155], v[44:47]
    v_mfma_f32_16x16x32_bf16 v[44:47], v[188:191], v[128:131], v[44:47]
    v_mfma_f32_16x16x32_bf16 v[44:47], v[160:163], v[156:159], v[44:47]
    v_mfma_f32_16x16x32_bf16 v[16:19], v[224:227], v[192:195], v[16:19]
    v_mfma_f32_16x16x32_bf16 v[20:23], v[228:231], v[192:195], v[20:23]
    v_mfma_f32_16x16x32_bf16 v[20:23], v[224:227], v[196:199], v[20:23]
    v_mfma_f32_16x16x32_bf16 v[24:27], v[232:235], v[192:195], v[24:27]
    v_mfma_f32_16x16x32_bf16 v[24:27], v[228:231], v[196:199], v[24:27]
    v_mfma_f32_16x16x32_bf16 v[24:27], v[224:227], v[200:203], v[24:27]
    s_nop 2
    ds_write_b64 v10, v[16:17] offset:0
    s_waitcnt lgkmcnt(13)
    v_mfma_f32_16x16x32_bf16 v[28:31], v[236:239], v[192:195], v[28:31]
    ds_write_b64 v10, v[18:19] offset:128
    v_mfma_f32_16x16x32_bf16 v[28:31], v[232:235], v[196:199], v[28:31]
    ds_write_b64 v10, v[20:21] offset:1024
    v_mfma_f32_16x16x32_bf16 v[28:31], v[228:231], v[200:203], v[28:31]
    ds_write_b64 v10, v[22:23] offset:1152
    v_mfma_f32_16x16x32_bf16 v[28:31], v[224:227], v[204:207], v[28:31]
    s_waitcnt lgkmcnt(13)
    v_mfma_f32_16x16x32_bf16 v[32:35], v[240:243], v[192:195], v[32:35]
    ds_write_b64 v10, v[24:25] offset:2048
    v_mfma_f32_16x16x32_bf16 v[32:35], v[236:239], v[196:199], v[32:35]
    ds_write_b64 v10, v[26:27] offset:2176
    v_mfma_f32_16x16x32_bf16 v[32:35], v[232:235], v[200:203], v[32:35]
    v_mfma_f32_16x16x32_bf16 v[32:35], v[228:231], v[204:207], v[32:35]
    v_mfma_f32_16x16x32_bf16 v[32:35], v[224:227], v[208:211], v[32:35]
    ds_write_b64 v10, v[28:29] offset:3072
    s_waitcnt lgkmcnt(13)
    v_mfma_f32_16x16x32_bf16 v[36:39], v[244:247], v[192:195], v[36:39]
    ds_write_b64 v10, v[30:31] offset:3200
    v_mfma_f32_16x16x32_bf16 v[36:39], v[240:243], v[196:199], v[36:39]
    v_mfma_f32_16x16x32_bf16 v[36:39], v[236:239], v[200:203], v[36:39]
    v_mfma_f32_16x16x32_bf16 v[36:39], v[232:235], v[204:207], v[36:39]
    v_mfma_f32_16x16x32_bf16 v[36:39], v[228:231], v[208:211], v[36:39]
    ds_write_b64 v10, v[32:33] offset:4096
    v_mfma_f32_16x16x32_bf16 v[36:39], v[224:227], v[212:215], v[36:39]
    ds_read_b32 v7, v12 offset:0
    ds_write_b64 v10, v[34:35] offset:4224
    s_waitcnt lgkmcnt(14)
    v_mfma_f32_16x16x32_bf16 v[40:43], v[248:251], v[192:195], v[40:43]
    v_mfma_f32_16x16x32_bf16 v[40:43], v[244:247], v[196:199], v[40:43]
    v_mfma_f32_16x16x32_bf16 v[40:43], v[240:243], v[200:203], v[40:43]
    v_mfma_f32_16x16x32_bf16 v[40:43], v[236:239], v[204:207], v[40:43]
    v_mfma_f32_16x16x32_bf16 v[40:43], v[232:235], v[208:211], v[40:43]
    ds_write_b64 v10, v[36:37] offset:5120
    v_mfma_f32_16x16x32_bf16 v[40:43], v[228:231], v[212:215], v[40:43]
    s_waitcnt lgkmcnt(2)
    v_readfirstlane_b32 s79, v7
    s_nop 0
    s_cmp_eq_u32 s79, 0
    s_cbranch_scc1 Lkq_27
Lkz_28:
    ds_write_b64 v10, v[38:39] offset:5248
    v_mfma_f32_16x16x32_bf16 v[40:43], v[224:227], v[216:219], v[40:43]
    ds_read_b128 v[100:103], v121 offset:0
    v_mfma_f32_16x16x32_bf16 v[44:47], v[252:255], v[192:195], v[44:47]
    s_cmp_gt_u32 s6, 1
    s_cselect_b64 exec, s[0:1], -1
    ds_read_b128 v[72:75], v124 offset:0
    ds_read_b128 v[76:79], v124 offset:512
    s_mov_b64 exec, -1
    v_mfma_f32_16x16x32_bf16 v[44:47], v[248:251], v[196:199], v[44:47]
    ds_read_b128 v[96:99], v122 offset:12288
    v_mfma_f32_16x16x32_bf16 v[44:47], v[244:247], v[200:203], v[44:47]
    v_mfma_f32_16x16x32_bf16 v[44:47], v[240:243], v[204:207], v[44:47]
    v_mfma_f32_16x16x32_bf16 v[44:47], v[236:239], v[208:211], v[44:47]
    ds_write_b64 v10, v[40:41] offset:6144
    v_mfma_f32_16x16x32_bf16 v[44:47], v[232:235], v[212:215], v[44:47]
    ds_write_b64 v10, v[42:43] offset:6272
    v_mfma_f32_16x16x32_bf16 v[44:47], v[228:231], v[216:219], v[44:47]
    v_mfma_f32_16x16x32_bf16 v[44:47], v[224:227], v[220:223], v[44:47]
    s_setprio 1
    s_waitcnt lgkmcnt(5)
    v_mfma_f32_32x32x16_bf16 v[128:143], v[100:103], v[80:83], 0
    s_nop 4
    ds_write_b64 v10, v[44:45] offset:7168
    ds_write_b64 v10, v[46:47] offset:7296
    s_mov_b64 exec, 1
    ds_add_u32 v126, v127 offset:32
    s_mov_b64 exec, -1
    v_mov_b32 v84, v4
    s_nop 0
    v_exp_f32 v128, v128
    v_exp_f32 v129, v129
    v_exp_f32 v130, v130
    v_exp_f32 v131, v131
    v_cvt_pk_bf16_f32 v88, v128, v129
    v_exp_f32 v132, v132
    s_cmp_gt_u32 s6, 2
    s_cselect_b64 exec, s[0:1], -1
    ds_read_b128 v[64:67], v125 offset:12288
    ds_read_b128 v[68:71], v125 offset:12800
    s_mov_b64 exec, -1
    v_exp_f32 v133, v133
    v_cvt_pk_bf16_f32 v89, v130, v131
    v_exp_f32 v134, v134
    s_waitcnt lgkmcnt(7)
    v_exp_f32 v135, v135
    v_mfma_f32_32x32x16_bf16 v[144:159], v[96:99], v[80:83], 0
    v_cvt_pk_bf16_f32 v90, v132, v133
    v_exp_f32 v136, v136
    v_cvt_pk_bf16_f32 v91, v134, v135
    v_exp_f32 v137, v137
    v_exp_f32 v138, v138
    ds_read_b128 v[100:103], v122 offset:10240
    v_exp_f32 v139, v139
    v_mfma_f32_32x32x16_bf16 v[48:63], v[72:75], v[88:91], v[48:63]
    v_cvt_pk_bf16_f32 v92, v136, v137
    v_exp_f32 v140, v140
    v_exp_f32 v141, v141
    v_cvt_pk_bf16_f32 v93, v138, v139
    v_exp_f32 v142, v142
    v_exp_f32 v143, v143
    v_cvt_pk_bf16_f32 v94, v140, v141
    v_exp_f32 v144, v144
    v_cvt_pk_bf16_f32 v95, v142, v143
    v_exp_f32 v145, v145
    v_exp_f32 v146, v146
    v_mfma_f32_32x32x16_bf16 v[48:63], v[76:79], v[92:95], v[48:63]
    v_exp_f32 v147, v147
    v_cvt_pk_bf16_f32 v88, v144, v145
    v_exp_f32 v148, v148
    s_cmp_gt_u32 s6, 3
    s_cselect_b64 exec, s[0:1], -1
    ds_read_b128 v[72:75], v125 offset:10240
    ds_read_b128 v[76:79], v125 offset:10752
    s_mov_b64 exec, -1
    v_exp_f32 v149, v149
    v_cvt_pk_bf16_f32 v89, v146, v147
    v_exp_f32 v150, v150
    s_waitcnt lgkmcnt(2)
    v_exp_f32 v151, v151
    v_mfma_f32_32x32x16_bf16 v[128:143], v[100:103], v[80:83], 0
    v_cvt_pk_bf16_f32 v90, v148, v149
    v_exp_f32 v152, v152
    v_cvt_pk_bf16_f32 v91, v150, v151
    v_exp_f32 v153, v153
    v_exp_f32 v154, v154
    ds_read_b128 v[96:99], v122 offset:8192
    v_exp_f32 v155, v155
    v_mfma_f32_32x32x16_bf16 v[48:63], v[64:67], v[88:91], v[48:63]
    v_cvt_pk_bf16_f32 v92, v152, v153
    v_exp_f32 v156, v156
    v_exp_f32 v157, v157
    v_cvt_pk_bf16_f32 v93, v154, v155
    v_exp_f32 v158, v158
    v_exp_f32 v159, v159
    v_cvt_pk_bf16_f32 v94, v156, v157
    v_exp_f32 v128, v128
    v_cvt_pk_bf16_f32 v95, v158, v159
    v_exp_f32 v129, v129
    v_exp_f32 v130, v130
    v_mfma_f32_32x32x16_bf16 v[48:63], v[68:71], v[92:95], v[48:63]
    v_exp_f32 v131, v131
    v_cvt_pk_bf16_f32 v88, v128, v129
    v_exp_f32 v132, v132
    s_cmp_gt_u32 s6, 4
    s_cselect_b64 exec, s[0:1], -1
    ds_read_b128 v[64:67], v125 offset:8192
    ds_read_b128 v[68:71], v125 offset:8704
    s_mov_b64 exec, -1
    v_exp_f32 v133, v133
    v_cvt_pk_bf16_f32 v89, v130, v131
    v_exp_f32 v134, v134
    s_waitcnt lgkmcnt(2)
    v_exp_f32 v135, v135
    v_mfma_f32_32x32x16_bf16 v[144:159], v[96:99], v[80:83], 0
    v_cvt_pk_bf16_f32 v90, v132, v133
    v_exp_f32 v136, v136
    v_cvt_pk_bf16_f32 v91, v134, v135
    v_exp_f32 v137, v137
    v_exp_f32 v138, v138
    ds_read_b128 v[100:103], v122 offset:6144
    v_exp_f32 v139, v139
    v_mfma_f32_32x32x16_bf16 v[48:63], v[72:75], v[88:91], v[48:63]
    v_cvt_pk_bf16_f32 v92, v136, v137
    v_exp_f32 v140, v140
    v_exp_f32 v141, v141
    v_cvt_pk_bf16_f32 v93, v138, v139
    v_exp_f32 v142, v142
    v_exp_f32 v143, v143
    v_cvt_pk_bf16_f32 v94, v140, v141
    v_exp_f32 v144, v144
    v_cvt_pk_bf16_f32 v95, v142, v143
    v_exp_f32 v145, v145
    v_exp_f32 v146, v146
    v_mfma_f32_32x32x16_bf16 v[48:63], v[76:79], v[92:95], v[48:63]
    v_exp_f32 v147, v147
    v_cvt_pk_bf16_f32 v88, v144, v145
    v_exp_f32 v148, v148
    s_cmp_gt_u32 s6, 5
    s_cselect_b64 exec, s[0:1], -1
    ds_read_b128 v[72:75], v125 offset:6144
    ds_read_b128 v[76:79], v125 offset:6656
    s_mov_b64 exec, -1
    v_exp_f32 v149, v149
    v_cvt_pk_bf16_f32 v89, v146, v147
    v_exp_f32 v150, v150
    s_waitcnt lgkmcnt(2)
    v_exp_f32 v151, v151
    v_mfma_f32_32x32x16_bf16 v[128:143], v[100:103], v[80:83], 0
    v_cvt_pk_bf16_f32 v90, v148, v149
    v_exp_f32 v152, v152
    v_cvt_pk_bf16_f32 v91, v150, v151
    v_exp_f32 v153, v153
    v_exp_f32 v154, v154
    ds_read_b128 v[96:99], v122 offset:4096
    v_exp_f32 v155, v155
    v_mfma_f32_32x32x16_bf16 v[48:63], v[64:67], v[88:91], v[48:63]
    v_cvt_pk_bf16_f32 v92, v152, v153
    v_exp_f32 v156, v156
    v_exp_f32 v157, v157
    v_cvt_pk_bf16_f32 v93, v154, v155
    v_exp_f32 v158, v158
    v_exp_f32 v159, v159
    v_cvt_pk_bf16_f32 v94, v156, v157
    v_exp_f32 v128, v128
    v_cvt_pk_bf16_f32 v95, v158, v159
    v_exp_f32 v129, v129
    v_exp_f32 v130, v130
    v_mfma_f32_32x32x16_bf16 v[48:63], v[68:71], v[92:95], v[48:63]
    v_exp_f32 v131, v131
    v_cvt_pk_bf16_f32 v88, v128, v129
    v_exp_f32 v132, v132
    s_cmp_gt_u32 s6, 6
    s_cselect_b64 exec, s[0:1], -1
    ds_read_b128 v[64:67], v125 offset:4096
    ds_read_b128 v[68:71], v125 offset:4608
    s_mov_b64 exec, -1
    v_exp_f32 v133, v133
    v_cvt_pk_bf16_f32 v89, v130, v131
    v_exp_f32 v134, v134
    s_waitcnt lgkmcnt(2)
    v_exp_f32 v135, v135
    v_mfma_f32_32x32x16_bf16 v[144:159], v[96:99], v[80:83], 0
    v_cvt_pk_bf16_f32 v90, v132, v133
    v_exp_f32 v136, v136
    v_cvt_pk_bf16_f32 v91, v134, v135
    v_exp_f32 v137, v137
    v_exp_f32 v138, v138
    ds_read_b128 v[100:103], v122 offset:2048
    v_exp_f32 v139, v139
    v_mfma_f32_32x32x16_bf16 v[48:63], v[72:75], v[88:91], v[48:63]
    v_cvt_pk_bf16_f32 v92, v136, v137
    v_exp_f32 v140, v140
    v_exp_f32 v141, v141
    v_cvt_pk_bf16_f32 v93, v138, v139
    v_exp_f32 v142, v142
    v_exp_f32 v143, v143
    v_cvt_pk_bf16_f32 v94, v140, v141
    v_exp_f32 v144, v144
    v_cvt_pk_bf16_f32 v95, v142, v143
    v_exp_f32 v145, v145
    v_exp_f32 v146, v146
    v_mfma_f32_32x32x16_bf16 v[48:63], v[76:79], v[92:95], v[48:63]
    v_exp_f32 v147, v147
    v_cvt_pk_bf16_f32 v88, v144, v145
    v_exp_f32 v148, v148
    s_cmp_gt_u32 s6, 7
    s_cselect_b64 exec, s[0:1], -1
    ds_read_b128 v[72:75], v125 offset:2048
    ds_read_b128 v[76:79], v125 offset:2560
    s_mov_b64 exec, -1
    v_exp_f32 v149, v149
    v_cvt_pk_bf16_f32 v89, v146, v147
    v_exp_f32 v150, v150
    s_waitcnt lgkmcnt(2)
    v_exp_f32 v151, v151
    v_mfma_f32_32x32x16_bf16 v[128:143], v[100:103], v[80:83], 0
    v_cvt_pk_bf16_f32 v90, v148, v149
    v_exp_f32 v152, v152
    v_cvt_pk_bf16_f32 v91, v150, v151
    v_exp_f32 v153, v153
    v_exp_f32 v154, v154
    ds_read_b128 v[96:99], v122 offset:0
    v_exp_f32 v155, v155
    v_mfma_f32_32x32x16_bf16 v[48:63], v[64:67], v[88:91], v[48:63]
    v_cvt_pk_bf16_f32 v92, v152, v153
    v_exp_f32 v156, v156
    v_exp_f32 v157, v157
    v_cvt_pk_bf16_f32 v93, v154, v155
    v_exp_f32 v158, v158
    v_exp_f32 v159, v159
    v_cvt_pk_bf16_f32 v94, v156, v157
    v_exp_f32 v128, v128
    v_cvt_pk_bf16_f32 v95, v158, v159
    v_exp_f32 v129, v129
    v_exp_f32 v130, v130
    v_mfma_f32_32x32x16_bf16 v[48:63], v[68:71], v[92:95], v[48:63]
    v_exp_f32 v131, v131
    v_cvt_pk_bf16_f32 v88, v128, v129
    v_exp_f32 v132, v132
    s_cmp_gt_u32 s6, 8
    s_cselect_b64 exec, s[0:1], -1
    ds_read_b128 v[64:67], v125 offset:0
    ds_read_b128 v[68:71], v125 offset:512
    s_mov_b64 exec, -1
    v_exp_f32 v133, v133
    v_cvt_pk_bf16_f32 v89, v130, v131
    v_exp_f32 v134, v134
    s_waitcnt lgkmcnt(2)
    v_exp_f32 v135, v135
    v_mfma_f32_32x32x16_bf16 v[144:159], v[96:99], v[80:83], v[104:119]
    v_cvt_pk_bf16_f32 v90, v132, v133
    v_exp_f32 v136, v136
    v_cvt_pk_bf16_f32 v91, v134, v135
    v_exp_f32 v137, v137
    v_exp_f32 v138, v138
    v_exp_f32 v139, v139
    v_mfma_f32_32x32x16_bf16 v[48:63], v[72:75], v[88:91], v[48:63]
    v_cvt_pk_bf16_f32 v92, v136, v137
    v_exp_f32 v140, v140
    v_exp_f32 v141, v141
    v_cvt_pk_bf16_f32 v93, v138, v139
    v_exp_f32 v142, v142
    v_exp_f32 v143, v143
    v_cvt_pk_bf16_f32 v94, v140, v141
    v_exp_f32 v144, v144
    v_cvt_pk_bf16_f32 v95, v142, v143
    v_exp_f32 v145, v145
    v_exp_f32 v146, v146
    v_mfma_f32_32x32x16_bf16 v[48:63], v[76:79], v[92:95], v[48:63]
    v_exp_f32 v147, v147
    v_cvt_pk_bf16_f32 v88, v144, v145
    v_exp_f32 v148, v148
    v_exp_f32 v149, v149
    v_cvt_pk_bf16_f32 v89, v146, v147
    v_exp_f32 v150, v150
    v_exp_f32 v151, v151
    v_cvt_pk_bf16_f32 v90, v148, v149
    v_exp_f32 v152, v152
    v_cvt_pk_bf16_f32 v91, v150, v151
    v_exp_f32 v153, v153
    v_exp_f32 v154, v154
    s_waitcnt lgkmcnt(0)
    v_exp_f32 v155, v155
    v_mfma_f32_32x32x16_bf16 v[48:63], v[64:67], v[88:91], v[48:63]
    v_cvt_pk_bf16_f32 v92, v152, v153
    v_exp_f32 v156, v156
    v_exp_f32 v157, v157
    v_cvt_pk_bf16_f32 v93, v154, v155
    v_exp_f32 v158, v158
    v_exp_f32 v159, v159
    v_cvt_pk_bf16_f32 v94, v156, v157
    v_cvt_pk_bf16_f32 v95, v158, v159
    s_nop 1
    v_mfma_f32_32x32x16_bf16 v[48:63], v[68:71], v[92:95], v[48:63]
L_attn_finA:
    s_mov_b32 s78, 0x30800000
    s_mov_b32 s79, 0x4e800000
    s_waitcnt lgkmcnt(0)
    s_nop 8
    v_mul_f32 v85, v84, v56
    v_cmp_nle_f32 vcc, s78, v56
    v_cmp_nge_f32 s[74:75], s79, v56
    v_rcp_f32 v86, v85
    s_or_b64 vcc, vcc, s[74:75]
    s_cbranch_vccnz L_attn_slow
L_attn_okA:
    v_mul_f32 v48, v48, v86
    v_mul_f32 v49, v49, v86
    v_mul_f32 v50, v50, v86
    v_mul_f32 v51, v51, v86
    v_mul_f32 v52, v52, v86
    v_mul_f32 v53, v53, v86
    v_mul_f32 v54, v54, v86
    v_mul_f32 v55, v55, v86
    v_cvt_pk_bf16_f32 v48, v48, v49
    v_cvt_pk_bf16_f32 v49, v50, v51
    v_cvt_pk_bf16_f32 v50, v52, v53
    v_cvt_pk_bf16_f32 v51, v54, v55
    buffer_store_dwordx4 v[48:51], v2, s[56:59], s4 offen sc1
    s_waitcnt vmcnt(0)
    v_mov_b32 v4, s70
    s_mov_b64 exec, 1
    buffer_atomic_swap v4, off, s[56:59], s5 sc1
    s_mov_b64 exec, -1
    s_endpgm
Lur_1:
Lpl_3:
    v_mov_b32 v27, s70
    s_mov_b64 exec, 511
    v_mov_b32 v27, 0
    buffer_atomic_or v27, v25, s[56:59], s8 offen sc0 sc1
    s_mov_b64 exec, -1
    s_waitcnt vmcnt(0)
Lpc_4:
    v_cmp_ne_u32 vcc, s70, v27
    s_nop 0
    s_cbranch_vccz Lpd_5
    s_sleep 1
    s_sub_u32 s73, s73, 8
    s_cmp_gt_i32 s73, 0
    s_cbranch_scc1 Lpl_3
Lpd_5:
    buffer_load_dwordx4 v[128:131], v24, s[56:59], s7 offen sc1
    buffer_load_dwordx4 v[136:139], v24, s[56:59], s7 offen offset:2048 sc1
    s_cmp_eq_u32 s71, 3
    s_cselect_b32 s75, 33554432, s7
    s_lshl_b64 exec, 3, 62
    buffer_load_dword v141, v24, s[56:59], s75 offen offset:2112 sc1
    s_mov_b64 exec, -1
    s_waitcnt vmcnt(0)
    s_branch Lub_2
Lwr_6:
Lpl_8:
    v_mov_b32 v32, s70
    s_mov_b64 exec, 65535
    v_mov_b32 v32, 0
    buffer_atomic_or v32, v38, s[56:59], s23 offen sc0 sc1
    s_mov_b64 exec, -1
    s_waitcnt vmcnt(0)
Lpc_9:
    v_cmp_ne_u32 vcc, s70, v32
    s_nop 0
    s_cbranch_vccz Lpd_10
    s_sleep 1
    s_sub_u32 s73, s73, 8
    s_cmp_gt_i32 s73, 0
    s_cbranch_scc1 Lpl_8
Lpd_10:
    s_branch Lwb_7
Lee_19:
    v_and_b32 v164, 31, v0
    v_lshrrev_b32 v165, 5, v0
    v_lshlrev_b32 v164, 2, v164
    v_lshl_add_u32 v164, v165, 9, v164
    s_mov_b32 s74, 4096
    buffer_load_dword v160, v164, s[56:59], s74 offen offset:0 sc1
    buffer_load_dword v161, v164, s[56:59], s74 offen offset:1024 sc1
    buffer_load_dword v162, v164, s[56:59], s74 offen offset:2048 sc1
    buffer_load_dword v163, v164, s[56:59], s74 offen offset:3072 sc1
    s_branch Leb_20
Ler_23:
    s_mov_b32 s74, 4096
    buffer_load_dword v160, v164, s[56:59], s74 offen offset:0 sc1
    buffer_load_dword v161, v164, s[56:59], s74 offen offset:1024 sc1
    buffer_load_dword v162, v164, s[56:59], s74 offen offset:2048 sc1
    buffer_load_dword v163, v164, s[56:59], s74 offen offset:3072 sc1
Lee_21:
    s_waitcnt vmcnt(0)
    v_xor_b32 v160, s70, v160
    v_xor_b32 v161, s70, v161
    v_xor_b32 v162, s70, v162
    v_xor_b32 v163, s70, v163
    v_or3_b32 v160, v160, v161, v162
    v_or_b32 v160, v160, v163
    v_cmp_ne_u32 vcc, 0, v160
    s_nop 0
    s_cbranch_vccz Lef_24
    s_sub_u32 s73, s73, 8
    s_cmp_gt_i32 s73, 0
    s_cbranch_scc1 Ler_23
Lef_24:
    s_mov_b32 s74, 0
    v_mov_b32 v13, s70
    s_mov_b64 exec, 1
    buffer_atomic_swap v13, off, s[56:59], s74 sc1
    s_mov_b64 exec, -1
    s_branch Leb_22
Lkq_27:
Lsp_29:
    ds_read_b32 v7, v12 offset:0
    s_waitcnt lgkmcnt(0)
    v_readfirstlane_b32 s79, v7
    s_nop 0
    s_cmp_ge_u32 s79, 1
    s_cbranch_scc1 Lsd_30
    s_sleep 1
    s_sub_u32 s73, s73, 1
    s_cmp_gt_i32 s73, 0
    s_cbranch_scc1 Lsp_29
Lsd_30:
    s_branch Lkz_28
L_attn_slow:
    s_cmp_lg_u32 s30, 0
    s_cbranch_scc1 L_sl_ok
    s_mov_b32 s30, 1
    s_mov_b32 s77, 0
    s_mov_b32 s74, 0xff61b1e6
    v_mov_b32 v86, 0xff7fffff
    v_sub_u32 v87, v123, v120
    v_xor_b32 v32, s74, v104
    v_mov_b32 v48, 0
    v_mov_b32 v64, s27
    v_xor_b32 v33, s74, v105
    v_mov_b32 v49, 0
    v_mov_b32 v65, s27
    v_xor_b32 v34, s74, v106
    v_mov_b32 v50, 0
    v_mov_b32 v66, s27
    v_xor_b32 v35, s74, v107
    v_mov_b32 v51, 0
    v_mov_b32 v67, s27
    v_xor_b32 v36, s74, v108
    v_mov_b32 v52, 0
    v_mov_b32 v68, s27
    v_xor_b32 v37, s74, v109
    v_mov_b32 v53, 0
    v_mov_b32 v69, s27
    v_xor_b32 v38, s74, v110
    v_mov_b32 v54, 0
    v_mov_b32 v70, s27
    v_xor_b32 v39, s74, v111
    v_mov_b32 v55, 0
    v_mov_b32 v71, s27
    v_xor_b32 v40, s74, v112
    v_mov_b32 v56, 0
    v_mov_b32 v72, s27
    v_xor_b32 v41, s74, v113
    v_mov_b32 v57, 0
    v_mov_b32 v73, s27
    v_xor_b32 v42, s74, v114
    v_mov_b32 v58, 0
    v_mov_b32 v74, s27
    v_xor_b32 v43, s74, v115
    v_mov_b32 v59, 0
    v_mov_b32 v75, s27
    v_xor_b32 v44, s74, v116
    v_mov_b32 v60, 0
    v_mov_b32 v76, s27
    v_xor_b32 v45, s74, v117
    v_mov_b32 v61, 0
    v_mov_b32 v77, s27
    v_xor_b32 v46, s74, v118
    v_mov_b32 v62, 0
    v_mov_b32 v78, s27
    v_xor_b32 v47, s74, v119
    v_mov_b32 v63, 0
    v_mov_b32 v79, s27
L_sl_pass:
    s_mov_b32 s76, 0
L_sl_tile:
    s_sub_u32 s74, 8, s76
    s_lshl_b32 s74, s74, 11
    v_add_u32 v3, s74, v122
    s_cmp_eq_u32 s76, 1
    s_cselect_b64 vcc, -1, 0
    v_cndmask_b32 v3, v3, v121, vcc
    s_cmp_eq_u32 s76, 0
    s_cselect_b64 vcc, -1, 0
    v_cndmask_b32 v3, v3, v120, vcc
    ds_read_b128 v[96:99], v3
    v_add_u32 v3, v3, v87
    s_mov_b64 exec, s[0:1]
    ds_read_b128 v[64:67], v3
    ds_read_b128 v[68:71], v3 offset:512
    s_mov_b64 exec, -1
    s_waitcnt lgkmcnt(0)
    s_cbranch_scc1 L_sl_lo
    s_cmp_eq_u32 s76, 8
    s_cbranch_scc1 L_sl_up
    v_mfma_f32_32x32x16_bf16 v[16:31], v[96:99], v[80:83], 0
    s_branch L_sl_s
L_sl_lo:
    v_mfma_f32_32x32x16_bf16 v[16:31], v[96:99], v[80:83], v[32:47]
    s_branch L_sl_s
L_sl_up:
    v_mfma_f32_32x32x16_bf16 v[16:31], v[96:99], v[80:83], v[104:119]
L_sl_s:
    s_cmp_lg_u32 s77, 0
    s_cbranch_scc1 L_sl_pv
    s_nop 9
    v_max3_f32 v86, v86, v16, v17
    v_max3_f32 v86, v86, v18, v19
    v_max3_f32 v86, v86, v20, v21
    v_max3_f32 v86, v86, v22, v23
    v_max3_f32 v86, v86, v24, v25
    v_max3_f32 v86, v86, v26, v27
    v_max3_f32 v86, v86, v28, v29
    v_max3_f32 v86, v86, v30, v31
    s_branch L_sl_next
L_sl_pv:
    s_nop 9
    v_sub_f32 v16, v16, v86
    v_sub_f32 v17, v17, v86
    v_sub_f32 v18, v18, v86
    v_sub_f32 v19, v19, v86
    v_sub_f32 v20, v20, v86
    v_sub_f32 v21, v21, v86
    v_sub_f32 v22, v22, v86
    v_sub_f32 v23, v23, v86
    v_sub_f32 v24, v24, v86
    v_sub_f32 v25, v25, v86
    v_sub_f32 v26, v26, v86
    v_sub_f32 v27, v27, v86
    v_sub_f32 v28, v28, v86
    v_sub_f32 v29, v29, v86
    v_sub_f32 v30, v30, v86
    v_sub_f32 v31, v31, v86
    v_exp_f32 v16, v16
    v_exp_f32 v17, v17
    v_exp_f32 v18, v18
    v_exp_f32 v19, v19
    v_exp_f32 v20, v20
    v_exp_f32 v21, v21
    v_exp_f32 v22, v22
    v_exp_f32 v23, v23
    v_exp_f32 v24, v24
    v_exp_f32 v25, v25
    v_exp_f32 v26, v26
    v_exp_f32 v27, v27
    v_exp_f32 v28, v28
    v_exp_f32 v29, v29
    v_exp_f32 v30, v30
    v_exp_f32 v31, v31
    v_cvt_pk_bf16_f32 v88, v16, v17
    v_cvt_pk_bf16_f32 v89, v18, v19
    v_cvt_pk_bf16_f32 v90, v20, v21
    v_cvt_pk_bf16_f32 v91, v22, v23
    v_cvt_pk_bf16_f32 v92, v24, v25
    v_cvt_pk_bf16_f32 v93, v26, v27
    v_cvt_pk_bf16_f32 v94, v28, v29
    v_cvt_pk_bf16_f32 v95, v30, v31
    v_mfma_f32_32x32x16_bf16 v[48:63], v[64:67], v[88:91], v[48:63]
    s_nop 0
    v_mfma_f32_32x32x16_bf16 v[48:63], v[68:71], v[92:95], v[48:63]
L_sl_next:
    s_add_u32 s76, s76, 1
    s_cmp_lt_u32 s76, s6
    s_cbranch_scc1 L_sl_tile
    s_cmp_lg_u32 s77, 0
    s_cbranch_scc1 L_sl_fin
    s_mov_b32 s77, 1
    v_mov_b32 v85, v86
    s_nop 1
    v_permlane32_swap_b32 v85, v86
    v_max_f32 v86, v85, v86
    s_branch L_sl_pass
L_sl_ok:
    s_cmp_eq_u32 s31, 0
    s_cbranch_scc1 L_attn_okA
    s_branch L_attn_okB
L_sl_fin:
    s_cmp_eq_u32 s31, 0
    s_cbranch_scc1 L_attn_finA
    s_branch L_attn_finB
L_codeend:
.section .rodata,"a"
.p2align 6
.amdhsa_kernel gated_mix__sliding_block__ssm_conv_h3__prompt_kernel
  .amdhsa_next_free_vgpr 256
  .amdhsa_next_free_sgpr 102
  .amdhsa_accum_offset 256
  .amdhsa_group_segment_fixed_size 0
  .amdhsa_kernarg_size 104
  .amdhsa_user_sgpr_count 2
  .amdhsa_user_sgpr_kernarg_segment_ptr 1
  .amdhsa_system_sgpr_workgroup_id_x 1
.end_amdhsa_kernel
.p2align 8
.type L_tab,@object
L_tab:
.long 81920,0x26e00,65536,14336,0,0x21200,0,0,90112,0x1c200,98304,98304,98368,0,0,0
.long 84992,0x26f00,71680,69632,18432,0x223e0,1024,2048,94208,0x1d200,0x1a000,0x1a000,0x190c0,0,0,0
.long 86016,0x26e00,73728,47104,32768,0x235c0,2048,4096,0x24a00,0x1e200,0x20280,0x19000,0x1a140,0,0,0
.long 89088,0x26f00,79872,77824,51200,0x247a0,3072,6144,0x25a00,0x1f200,0x22280,0x1b000,0x1b1c0,0,0,0
.long 0,0,0,0,65536,0x26e00,0,0,82944,0x26f00,67584,65536,2048,81920,90112,0
.long 32,64,8256,64,73728,0x26e04,256,256,83968,0x26e00,69632,30720,16384,86016,0x1c200,128
.long 64,8192,0,0,67584,0x26f00,8448,9152,87040,0x26f00,75776,73728,34816,82944,0x24a00,256
.long 96,8256,8256,64,75776,0x26f04,8704,9408,88064,0x26e00,77824,63488,49152,87040,0x1e200,384
.zero 512
.long 0,0,1024,0xffffffc4,16,8,1040,0xffffffc8,32,16,1056,0xffffffcc,48,24,1072,0xffffffd0
.long 64,32,1088,0xffffffd4,80,40,1104,0xffffffd8,96,48,1120,0xffffffdc,112,56,1136,0xffffffe0
.long 128,64,1152,0xffffffe4,144,72,1168,0xffffffe8,160,80,1184,0xffffffec,176,88,1200,0xfffffff0
.long 192,96,1216,0xfffffff4,208,104,1232,0xfffffff8,224,112,1248,0xfffffffc,240,120,1264,0
.long 256,128,1024,0xffffffc8,272,136,1040,0xffffffcc,288,144,1056,0xffffffd0,304,152,1072,0xffffffd4
.long 320,160,1088,0xffffffd8,336,168,1104,0xffffffdc,352,176,1120,0xffffffe0,368,184,1136,0xffffffe4
.long 384,192,1152,0xffffffe8,400,200,1168,0xffffffec,416,208,1184,0xfffffff0,432,216,1200,0xfffffff4
.long 448,224,1216,0xfffffff8,464,232,1232,0xfffffffc,480,240,1248,0,496,248,1264,4
.long 512,0,1280,0xffffffc4,528,8,1296,0xffffffc8,544,16,1312,0xffffffcc,560,24,1328,0xffffffd0
.long 576,32,1344,0xffffffd4,592,40,1360,0xffffffd8,608,48,1376,0xffffffdc,624,56,1392,0xffffffe0
.long 640,64,1408,0xffffffe4,656,72,1424,0xffffffe8,672,80,1440,0xffffffec,688,88,1456,0xfffffff0
.long 704,96,1472,0xfffffff4,720,104,1488,0xfffffff8,736,112,1504,0xfffffffc,752,120,1520,4096
.long 768,128,1280,0xffffffc8,784,136,1296,0xffffffcc,800,144,1312,0xffffffd0,816,152,1328,0xffffffd4
.long 832,160,1344,0xffffffd8,848,168,1360,0xffffffdc,864,176,1376,0xffffffe0,880,184,1392,0xffffffe4
.long 896,192,1408,0xffffffe8,912,200,1424,0xffffffec,928,208,1440,0xfffffff0,944,216,1456,0xfffffff4
.long 960,224,1472,0xfffffff8,976,232,1488,0xfffffffc,992,240,1504,4096,1008,248,1520,4100
.long 98304,0x20200,0,0,98308,0x225c0,16,16,98312,0x20210,64,32,98316,0x225d0,80,48
.long 98320,0x20220,128,1024,98324,0x225e0,144,1040,98328,0x20230,192,1056,98332,0x225f0,208,1072
.long 98336,0x20240,256,2048,98340,0x22600,272,2064,98344,0x20250,320,2080,98348,0x22610,336,2096
.long 98352,0x20260,384,3072,98356,0x22620,400,3088,98360,0x20270,448,3104,98364,0x22630,464,3120
.long 0x19080,0x20280,512,4112,0x19084,0x22640,528,4096,0x19088,0x20290,576,4144,0x1908c,0x22650,592,4128
.long 0x19090,0x202a0,640,5136,0x19094,0x22660,656,5120,0x19098,0x202b0,704,5168,0x1909c,0x22670,720,5152
.long 0x190a0,0x202c0,768,6160,0x190a4,0x22680,784,6144,0x190a8,0x202d0,832,6192,0x190ac,0x22690,848,6176
.long 0x190b0,0x202e0,896,7184,0x190b4,0x226a0,912,7168,0x190b8,0x202f0,960,7216,0x190bc,0x226b0,976,7200
.long 0x1a100,0x20300,1024,8224,0x1a104,0x226c0,1040,8240,0x1a108,0x20310,1088,8192,0x1a10c,0x226d0,1104,8208
.long 0x1a110,0x20320,1152,9248,0x1a114,0x226e0,1168,9264,0x1a118,0x20330,1216,9216,0x1a11c,0x226f0,1232,9232
.long 0x1a120,0x20340,1280,10272,0x1a124,0x22700,1296,10288,0x1a128,0x20350,1344,10240,0x1a12c,0x22710,1360,10256
.long 0x1a130,0x20360,1408,11296,0x1a134,0x22720,1424,11312,0x1a138,0x20370,1472,11264,0x1a13c,0x22730,1488,11280
.long 0x1b180,0x20380,1536,12336,0x1b184,0x22740,1552,12320,0x1b188,0x20390,1600,12304,0x1b18c,0x22750,1616,12288
.long 0x1b190,0x203a0,1664,13360,0x1b194,0x22760,1680,13344,0x1b198,0x203b0,1728,13328,0x1b19c,0x22770,1744,13312
.long 0x1b1a0,0x203c0,1792,14384,0x1b1a4,0x22780,1808,14368,0x1b1a8,0x203d0,1856,14352,0x1b1ac,0x22790,1872,14336
.long 0x1b1b0,0x203e0,1920,15408,0x1b1b4,0x227a0,1936,15392,0x1b1b8,0x203f0,1984,15376,0x1b1bc,0x227b0,2000,15360
.long 81920,0,81920,0,81984,32,81928,16,82048,64,81936,32,82112,96,81944,48
.long 82192,128,81984,4096,82256,160,81992,4112,82320,192,82000,4128,82384,224,82008,4144
.long 82464,256,82048,8192,82528,288,82056,8208,82592,320,82064,8224,82656,352,82072,8240
.long 82736,384,82112,12288,82800,416,82120,12304,82864,448,82128,12320,82928,480,82136,12336
.long 82944,512,81952,16384,83008,544,81960,16400,83072,576,81968,16416,83136,608,81976,16432
.long 83216,640,82016,20480,83280,672,82024,20496,83344,704,82032,20512,83408,736,82040,20528
.long 83488,768,82080,24576,83552,800,82088,24592,83616,832,82096,24608,83680,864,82104,24624
.long 83760,896,82144,28672,83824,928,82152,28688,83888,960,82160,28704,83952,992,82168,28720
.long 81928,1024,82176,32768,81992,1056,82184,32784,82056,1088,82192,32800,82120,1120,82200,32816
.long 82200,1152,82240,36864,82264,1184,82248,36880,82328,1216,82256,36896,82392,1248,82264,36912
.long 82472,1280,82304,40960,82536,1312,82312,40976,82600,1344,82320,40992,82664,1376,82328,41008
.long 82744,1408,82368,45056,82808,1440,82376,45072,82872,1472,82384,45088,82936,1504,82392,45104
.long 82952,1536,82208,49152,83016,1568,82216,49168,83080,1600,82224,49184,83144,1632,82232,49200
.long 83224,1664,82272,53248,83288,1696,82280,53264,83352,1728,82288,53280,83416,1760,82296,53296
.long 83496,1792,82336,57344,83560,1824,82344,57360,83624,1856,82352,57376,83688,1888,82360,57392
.long 83768,1920,82400,61440,83832,1952,82408,61456,83896,1984,82416,61472,83960,2016,82424,61488
.long 0,0,0,0,4,272,32,16,8,544,64,32,12,816,96,48
.long 16,1088,128,64,20,1360,160,80,24,1632,192,96,28,1904,224,112
.long 32,2048,272,1024,36,2320,304,1040,40,2592,336,1056,44,2864,368,1072
.long 48,3136,400,1088,52,3408,432,1104,56,3680,464,1120,60,3952,496,1136
.long 128,4096,544,2048,132,4368,512,2064,136,4640,608,2080,140,4912,576,2096
.long 144,5184,672,2112,148,5456,640,2128,152,5728,736,2144,156,6000,704,2160
.long 160,6144,816,3072,164,6416,784,3088,168,6688,880,3104,172,6960,848,3120
.long 176,7232,944,3136,180,7504,912,3152,184,7776,1008,3168,188,8048,976,3184
.long 0,16,1088,4096,8,256,1120,4112,16,560,1024,4128,24,800,1056,4144
.long 32,1104,1216,4160,40,1344,1248,4176,48,1648,1152,4192,56,1888,1184,4208
.long 4,2064,1360,5120,12,2304,1392,5136,20,2608,1296,5152,28,2848,1328,5168
.long 36,3152,1488,5184,44,3392,1520,5200,52,3696,1424,5216,60,3936,1456,5232
.long 0,4112,1632,6144,8,4352,1600,6160,16,4656,1568,6176,24,4896,1536,6192
.long 32,5200,1760,6208,40,5440,1728,6224,48,5744,1696,6240,56,5984,1664,6256
.long 4,6160,1904,7168,12,6400,1872,7184,20,6704,1840,7200,28,6944,1808,7216
.long 36,7248,2032,7232,44,7488,2000,7248,52,7792,1968,7264,60,8032,1936,7280
.zero 4096
.long 0x20200,0x20220,448,0,0x20620,0x20640,464,128,0x20208,0x20228,480,272,0x20628,0x20648,496,400
.long 0x20280,0x202a0,384,544,0x206a0,0x206c0,400,672,0x20288,0x202a8,416,816,0x206a8,0x206c8,432,944
.long 0x20310,0x20330,16832,1088,0x20730,0x20750,16848,1216,0x20318,0x20338,16864,1360,0x20738,0x20758,16880,1488
.long 0x20390,0x203b0,16768,1632,0x207b0,0x207d0,16784,1760,0x20398,0x203b8,16800,1904,0x207b8,0x207d8,16816,2032
.long 0x20a40,0x20a60,320,4096,0x20e60,0x20e00,336,4224,0x20a48,0x20a68,352,4368,0x20e68,0x20e08,368,4496
.long 0x20ac0,0x20ae0,256,4640,0x20ee0,0x20e80,272,4768,0x20ac8,0x20ae8,288,4912,0x20ee8,0x20e88,304,5040
.long 0x20b50,0x20b70,16704,5184,0x20f70,0x20f10,16720,5312,0x20b58,0x20b78,16736,5456,0x20f78,0x20f18,16752,5584
.long 0x20bd0,0x20bf0,16640,5728,0x20ff0,0x20f90,16656,5856,0x20bd8,0x20bf8,16672,6000,0x20ff8,0x20f98,16688,6128
.long 0x21200,0x21220,192,16,0x21620,0x21640,208,144,0x21208,0x21228,224,256,0x21628,0x21648,240,384
.long 0x21280,0x212a0,128,560,0x216a0,0x216c0,144,688,0x21288,0x212a8,160,800,0x216a8,0x216c8,176,928
.long 0x21310,0x21330,16576,1104,0x21730,0x21750,16592,1232,0x21318,0x21338,16608,1344,0x21738,0x21758,16624,1472
.long 0x21390,0x213b0,16512,1648,0x217b0,0x217d0,16528,1776,0x21398,0x213b8,16544,1888,0x217b8,0x217d8,16560,2016
.long 0x21a40,0x21a60,64,4112,0x21e60,0x21e00,80,4240,0x21a48,0x21a68,96,4352,0x21e68,0x21e08,112,4480
.long 0x21ac0,0x21ae0,0,4656,0x21ee0,0x21e80,16,4784,0x21ac8,0x21ae8,32,4896,0x21ee8,0x21e88,48,5024
.long 0x21b50,0x21b70,16448,5200,0x21f70,0x21f10,16464,5328,0x21b58,0x21b78,16480,5440,0x21f78,0x21f18,16496,5568
.long 0x21bd0,0x21bf0,16384,5744,0x21ff0,0x21f90,16400,5872,0x21bd8,0x21bf8,16416,5984,0x21ff8,0x21f98,16432,6112
.long 0,0x26a00,0,0,8,0x26a00,16,16,16,0x26a00,32,32,24,0x26a00,48,48
.long 128,0x26a00,64,64,136,0x26a00,80,80,144,0x26a00,96,96,152,0x26a00,112,112
.long 320,0x26a00,128,128,328,0x26a00,144,144,336,0x26a00,160,160,344,0x26a00,176,176
.long 448,0x26a00,192,192,456,0x26a00,208,208,464,0x26a00,224,224,472,0x26a00,240,240
.long 32,0x26a00,0x20000,4096,40,0x26a00,0x20010,4112,48,0x26a00,0x20020,4128,56,0x26a00,0x20030,4144
.long 160,0x26a00,0x20040,4160,168,0x26a00,0x20050,4176,176,0x26a00,0x20060,4192,184,0x26a00,0x20070,4208
.long 352,0x26a00,0x20080,4224,360,0x26a00,0x20090,4240,368,0x26a00,0x200a0,4256,376,0x26a00,0x200b0,4272
.long 480,0x26a00,0x200c0,4288,488,0x26a00,0x200d0,4304,496,0x26a00,0x200e0,4320,504,0x26a00,0x200f0,4336
.long 1024,0x26a10,256,256,1032,0x26a10,272,272,1040,0x26a10,288,288,1048,0x26a10,304,304
.long 1152,0x26a10,320,320,1160,0x26a10,336,336,1168,0x26a10,352,352,1176,0x26a10,368,368
.long 1344,0x26a10,384,384,1352,0x26a10,400,400,1360,0x26a10,416,416,1368,0x26a10,432,432
.long 1472,0x26a10,448,448,1480,0x26a10,464,464,1488,0x26a10,480,480,1496,0x26a10,496,496
.long 1056,0x26a10,0x20100,4352,1064,0x26a10,0x20110,4368,1072,0x26a10,0x20120,4384,1080,0x26a10,0x20130,4400
.long 1184,0x26a10,0x20140,4416,1192,0x26a10,0x20150,4432,1200,0x26a10,0x20160,4448,1208,0x26a10,0x20170,4464
.long 1376,0x26a10,0x20180,4480,1384,0x26a10,0x20190,4496,1392,0x26a10,0x201a0,4512,1400,0x26a10,0x201b0,4528
.long 1504,0x26a10,0x201c0,4544,1512,0x26a10,0x201d0,4560,1520,0x26a10,0x201e0,4576,1528,0x26a10,0x201f0,4592
.long 0,0,98304,0x203c0,16,8,0x19080,0x215a0,32,16,98312,0x20380,48,24,0x19088,0x21560
.long 64,32,98320,0x20340,80,40,0x19090,0x21520,96,48,98328,0x20300,112,56,0x19098,0x214e0
.long 128,64,98336,0x202c0,144,72,0x190a0,0x214a0,160,80,98344,0x20280,176,88,0x190a8,0x21460
.long 192,96,98352,0x20240,208,104,0x190b0,0x21420,224,112,98360,0x20200,240,120,0x190b8,0x213e0
.long 256,128,98320,0x203d0,272,136,0x19090,0x215b0,288,144,98328,0x20390,304,152,0x19098,0x21570
.long 320,160,98336,0x20350,336,168,0x190a0,0x21530,352,176,98344,0x20310,368,184,0x190a8,0x214f0
.long 384,192,98352,0x202d0,400,200,0x190b0,0x214b0,416,208,98360,0x20290,432,216,0x190b8,0x21470
.long 448,224,98368,0x20250,464,232,0x190c0,0x21430,480,240,98376,0x20210,496,248,0x190c8,0x213f0
.long 512,0,98336,0x203e0,528,8,0x190a0,0x215c0,544,16,98344,0x203a0,560,24,0x190a8,0x21580
.long 576,32,98352,0x20360,592,40,0x190b0,0x21540,608,48,98360,0x20320,624,56,0x190b8,0x21500
.long 640,64,98368,0x202e0,656,72,0x190c0,0x214c0,672,80,98376,0x202a0,688,88,0x190c8,0x21480
.long 704,96,98384,0x20260,720,104,0x190d0,0x21440,736,112,98392,0x20220,752,120,0x190d8,0x21400
.long 768,128,98352,0x203f0,784,136,0x190b0,0x215d0,800,144,98360,0x203b0,816,152,0x190b8,0x21590
.long 832,160,98368,0x20370,848,168,0x190c0,0x21550,864,176,98376,0x20330,880,184,0x190c8,0x21510
.long 896,192,98384,0x202f0,912,200,0x190d0,0x214d0,928,208,98392,0x202b0,944,216,0x190d8,0x21490
.long 960,224,98400,0x20270,976,232,0x190e0,0x21450,992,240,98408,0x20230,1008,248,0x190e8,0x21410
.long 1024,0,0,0,1040,0,0,0,1056,0,0,0,1072,0,0,0
.long 1088,0,0,0,1104,0,0,0,1120,0,0,0,1136,0,0,0
.long 1152,0,0,0,1168,0,0,0,1184,0,0,0,1200,0,0,0
.long 1216,0,0,0,1232,0,0,65535,1248,0,65535,0,1264,65535,0,0
.long 1024,0,0,0,1040,0,0,0,1056,0,0,0,1072,0,0,0
.long 1088,0,0,0,1104,0,0,0,1120,0,0,0,1136,0,0,0
.long 1152,0,0,0,1168,0,0,65535,1184,0,65535,0,1200,65535,0,0
.long 1216,0,0,0,1232,0,0,0,1248,0,0,0,1264,0,0,0
.long 1280,0,0,0,1296,0,0,0,1312,0,0,0,1328,0,0,0
.long 1344,0,0,0,1360,0,0,65535,1376,0,65535,0,1392,65535,0,0
.long 1408,0,0,0,1424,0,0,0,1440,0,0,0,1456,0,0,0
.long 1472,0,0,0,1488,0,0,0,1504,0,0,0,1520,0,0,0
.long 1280,0,0,0,1296,0,0,65535,1312,0,65535,0,1328,65535,0,0
.long 1344,0,0,0,1360,0,0,0,1376,0,0,0,1392,0,0,0
.long 1408,0,0,0,1424,0,0,0,1440,0,0,0,1456,0,0,0
.long 1472,0,0,0,1488,0,0,0,1504,0,0,0,1520,0,0,0
.long 0,0x24a00,0x27000,0,0,0x24a08,0x27008,0,0,0x24a10,0x27010,0,0,0x24a18,0x27018,0
.long 0,0x24a80,0x27000,0,0,0x24a88,0x27008,0,0,0x24a90,0x27010,0,0,0x24a98,0x27018,0
.long 0,0x24b40,0x27020,0,0,0x24b48,0x27028,0,0,0x24b50,0x27030,0,0,0x24b58,0x27038,0
.long 65535,0x24bc0,0x27020,0,0,0x24bc8,0x27028,0,0,0x24bd0,0x27030,0,0,0x24bd8,0x27038,0
.long 0,0x24a20,0x27000,0,0,0x24a28,0x27008,0,0,0x24a30,0x27010,0,0,0x24a38,0x27018,0
.long 0,0x24aa0,0x27000,0,0,0x24aa8,0x27008,0,0,0x24ab0,0x27010,0,0,0x24ab8,0x27018,0
.long 65535,0x24b60,0x27020,0,0,0x24b68,0x27028,0,0,0x24b70,0x27030,0,0,0x24b78,0x27038,0
.long 0,0x24be0,0x27020,0,0,0x24be8,0x27028,0,0,0x24bf0,0x27030,0,0,0x24bf8,0x27038,0
.long 0,0x24c00,0x27000,0,0,0x24c08,0x27008,0,0,0x24c10,0x27010,0,0,0x24c18,0x27018,0
.long 65535,0x24c80,0x27000,0,0,0x24c88,0x27008,0,0,0x24c90,0x27010,0,0,0x24c98,0x27018,0
.long 0,0x24d40,0x27020,0,0,0x24d48,0x27028,0,0,0x24d50,0x27030,0,0,0x24d58,0x27038,0
.long 0,0x24dc0,0x27020,0,0,0x24dc8,0x27028,0,0,0x24dd0,0x27030,0,0,0x24dd8,0x27038,0
.long 65535,0x24c20,0x27000,0,0,0x24c28,0x27008,0,0,0x24c30,0x27010,0,0,0x24c38,0x27018,0
.long 0,0x24ca0,0x27000,0,0,0x24ca8,0x27008,0,0,0x24cb0,0x27010,0,0,0x24cb8,0x27018,0
.long 0,0x24d60,0x27020,0,0,0x24d68,0x27028,0,0,0x24d70,0x27030,0,0,0x24d78,0x27038,0
.long 0,0x24de0,0x27020,0,0,0x24de8,0x27028,0,0,0x24df0,0x27030,0,0,0x24df8,0x27038,0
.zero 3072
.long 0x902000,24608,1,0x100000,4188,0,4,0x700000,40960,256,0x780000,41984,256,24576,0x900000,12288
.long 0x3fc000,0xb20000,0xfffffff8,5632
.zero 48
.long 0x90a400,24868,2,0x101000,4156,0,8,0x700800,45056,33024,0x780040,41984,33024,24836,0x908400,12288
.long 0x41c000,0xb20800,0xfffffff8,5632
.zero 48
.long 0x902800,24616,1,0x102000,4124,0,4100,0x701000,40964,320,0x7a0000,42240,16640,24704,0x904000,13312
.long 0x43c000,0xb28400,0xfffffff8,5696
.zero 48
.long 0x90ac00,24876,2,0x103000,4096,0,4104,0x701800,45060,33088,0x7a0040,42240,49408,24964,0x90c400,13312
.long 0x45c000,0xb28c00,0xfffffff8,5696
.zero 48
.long 0x903000,24624,1,0x140000,4700,0x40000,0x40004,0x740000,41472,384,0x7c0000,42496,384,24576,0x900000,14336
.long 0x47c000,0xb30000,0xfffffff8,5120
.zero 48
.long 0x90b400,24884,2,0x141000,4668,0x40000,0x40008,0x740800,45568,33152,0x7c0040,42496,33152,24836,0x908400,14336
.long 0x49c000,0xb30800,0xfffffff8,5120
.zero 48
.long 0x903800,24632,1,0x142000,4636,0x40000,0x41004,0x741000,41476,448,0x7e0000,42752,16768,24704,0x904000,15360
.long 0x4bc000,0xb38400,0xfffffff8,5184
.zero 48
.long 0x90bc00,24892,2,0x143000,4608,0x40000,0x41008,0x741800,45572,33216,0x7e0040,42752,49536,24964,0x90c400,15360
.long 0x4dc000,0xb38c00,0xfffffff8,5184
.zero 48
.long 0x982000,28704,9,0x180000,5212,0x80000,0x80004,0x780000,41984,0x80100,0x780400,41984,0x80100,28672,0x980000,12288
.long 0x404000,0xb20000,8,5632
.zero 48
.long 0x98a400,28964,9,0x181000,5180,0x80000,0x80008,0x780800,46080,0x88100,0x780440,41984,0x88100,28932,0x988400,12288
.long 0x424000,0xb20800,8,5632
.zero 48
.long 0x982800,28712,9,0x182000,5148,0x80000,0x81004,0x781000,41988,0x80140,0x7a0400,42240,0x84100,28800,0x984000,13312
.long 0x444000,0xb28400,8,5696
.zero 48
.long 0x98ac00,28972,9,0x183000,5120,0x80000,0x81008,0x781800,46084,0x88140,0x7a0440,42240,0x8c100,29060,0x98c400,13312
.long 0x464000,0xb28c00,8,5696
.zero 48
.long 0x983000,28720,9,0x1c0000,5724,0xc0000,0xc0004,0x7c0000,42496,0x80180,0x7c0400,42496,0x80180,28672,0x980000,14336
.long 0x484000,0xb30000,8,5120
.zero 48
.long 0x98b400,28980,9,0x1c1000,5692,0xc0000,0xc0008,0x7c0800,46592,0x88180,0x7c0440,42496,0x88180,28932,0x988400,14336
.long 0x4a4000,0xb30800,8,5120
.zero 48
.long 0x983800,28728,9,0x1c2000,5660,0xc0000,0xc1004,0x7c1000,42500,0x801c0,0x7e0400,42752,0x84180,28800,0x984000,15360
.long 0x4c4000,0xb38400,8,5184
.zero 48
.long 0x98bc00,28988,9,0x1c3000,5632,0xc0000,0xc1008,0x7c1800,46596,0x881c0,0x7e0440,42752,0x8c180,29060,0x98c400,15360
.long 0x4e4000,0xb38c00,8,5184
.zero 48
.long 0xa02000,32800,9,0x200000,6236,0x100000,0x100004,0x800000,43008,0x100100,0x780800,46080,0x100100,32768,0xa00000,12288
.long 0x40c000,0xb20000,24,5632
.zero 48
.long 0xa0a400,33060,9,0x201000,6204,0x100000,0x100008,0x800800,47104,0x108100,0x780840,46080,0x108100,33028,0xa08400,12288
.long 0x42c000,0xb20800,24,5632
.zero 48
.long 0xa02800,32808,9,0x202000,6172,0x100000,0x101004,0x801000,43012,0x100140,0x7a0800,46336,0x104100,32896,0xa04000,13312
.long 0x44c000,0xb28400,24,5696
.zero 48
.long 0xa0ac00,33068,9,0x203000,6144,0x100000,0x101008,0x801800,47108,0x108140,0x7a0840,46336,0x10c100,33156,0xa0c400,13312
.long 0x46c000,0xb28c00,24,5696
.zero 48
.long 0xa03000,32816,9,0x240000,6748,0x140000,0x140004,0x840000,43520,0x100180,0x7c0800,46592,0x100180,32768,0xa00000,14336
.long 0x48c000,0xb30000,24,5120
.zero 48
.long 0xa0b400,33076,9,0x241000,6716,0x140000,0x140008,0x840800,47616,0x108180,0x7c0840,46592,0x108180,33028,0xa08400,14336
.long 0x4ac000,0xb30800,24,5120
.zero 48
.long 0xa03800,32824,9,0x242000,6684,0x140000,0x141004,0x841000,43524,0x1001c0,0x7e0800,46848,0x104180,32896,0xa04000,15360
.long 0x4cc000,0xb38400,24,5184
.zero 48
.long 0xa0bc00,33084,9,0x243000,6656,0x140000,0x141008,0x841800,47620,0x1081c0,0x7e0840,46848,0x10c180,33156,0xa0c400,15360
.long 0x4ec000,0xb38c00,24,5184
.zero 48
.long 0xa82000,36896,9,0x280000,7260,0x180000,0x180004,0x880000,44032,0x180100,0x780c00,46080,0x180100,36864,0xa80000,12288
.long 0x414000,0xb20000,40,5632
.zero 48
.long 0xa8a400,37156,9,0x281000,7228,0x180000,0x180008,0x880800,48128,0x188100,0x780c40,46080,0x188100,37124,0xa88400,12288
.long 0x434000,0xb20800,40,5632
.zero 48
.long 0xa82800,36904,9,0x282000,7196,0x180000,0x181004,0x881000,44036,0x180140,0x7a0c00,46336,0x184100,36992,0xa84000,13312
.long 0x454000,0xb28400,40,5696
.zero 48
.long 0xa8ac00,37164,9,0x283000,7168,0x180000,0x181008,0x881800,48132,0x188140,0x7a0c40,46336,0x18c100,37252,0xa8c400,13312
.long 0x474000,0xb28c00,40,5696
.zero 48
.long 0xa83000,36912,9,0x2c0000,7772,0x1c0000,0x1c0004,0x8c0000,44544,0x180180,0x7c0c00,46592,0x180180,36864,0xa80000,14336
.long 0x494000,0xb30000,40,5120
.zero 48
.long 0xa8b400,37172,9,0x2c1000,7740,0x1c0000,0x1c0008,0x8c0800,48640,0x188180,0x7c0c40,46592,0x188180,37124,0xa88400,14336
.long 0x4b4000,0xb30800,40,5120
.zero 48
.long 0xa83800,36920,9,0x2c2000,7708,0x1c0000,0x1c1004,0x8c1000,44548,0x1801c0,0x7e0c00,46848,0x184180,36992,0xa84000,15360
.long 0x4d4000,0xb38400,40,5184
.zero 48
.long 0xa8bc00,37180,9,0x2c3000,7680,0x1c0000,0x1c1008,0x8c1800,48644,0x1881c0,0x7e0c40,46848,0x18c180,37252,0xa8c400,15360
.long 0x4f4000,0xb38c00,40,5184
.zero 48
.long 0x912000,25120,3,0x100020,4188,8192,8196,0x702000,40968,65792,0x780080,50176,65792,25088,0x910000,12288
.long 0x3fd000,0xb20000,0xfffffffa,5632
.zero 48
.long 0x91a400,25380,4,0x101020,4156,8192,8200,0x702800,45064,98560,0x7800c0,50176,98560,25348,0x918400,12288
.long 0x41d000,0xb20800,0xfffffffa,5632
.zero 48
.long 0x912800,25128,3,0x102020,4124,8192,12292,0x703000,40972,65856,0x7a0080,50432,82176,25216,0x914000,13312
.long 0x43d000,0xb28400,0xfffffffa,5696
.zero 48
.long 0x91ac00,25388,4,0x103020,4096,8192,12296,0x703800,45068,98624,0x7a00c0,50432,0x1c100,25476,0x91c400,13312
.long 0x45d000,0xb28c00,0xfffffffa,5696
.zero 48
.long 0x913000,25136,3,0x140020,4700,0x42000,0x42004,0x742000,41480,65920,0x7c0080,50688,65920,25088,0x910000,14336
.long 0x47d000,0xb30000,0xfffffffa,5120
.zero 48
.long 0x91b400,25396,4,0x141020,4668,0x42000,0x42008,0x742800,45576,98688,0x7c00c0,50688,98688,25348,0x918400,14336
.long 0x49d000,0xb30800,0xfffffffa,5120
.zero 48
.long 0x913800,25144,3,0x142020,4636,0x42000,0x43004,0x743000,41484,65984,0x7e0080,50944,82304,25216,0x914000,15360
.long 0x4bd000,0xb38400,0xfffffffa,5184
.zero 48
.long 0x91bc00,25404,4,0x143020,4608,0x42000,0x43008,0x743800,45580,98752,0x7e00c0,50944,0x1c180,25476,0x91c400,15360
.long 0x4dd000,0xb38c00,0xfffffffa,5184
.zero 48
.long 0x992000,29216,9,0x180020,5212,0x82000,0x82004,0x782000,41992,0x90100,0x780480,50176,0x90100,29184,0x990000,12288
.long 0x405000,0xb20000,10,5632
.zero 48
.long 0x99a400,29476,9,0x181020,5180,0x82000,0x82008,0x782800,46088,0x98100,0x7804c0,50176,0x98100,29444,0x998400,12288
.long 0x425000,0xb20800,10,5632
.zero 48
.long 0x992800,29224,9,0x182020,5148,0x82000,0x83004,0x783000,41996,0x90140,0x7a0480,50432,0x94100,29312,0x994000,13312
.long 0x445000,0xb28400,10,5696
.zero 48
.long 0x99ac00,29484,9,0x183020,5120,0x82000,0x83008,0x783800,46092,0x98140,0x7a04c0,50432,0x9c100,29572,0x99c400,13312
.long 0x465000,0xb28c00,10,5696
.zero 48
.long 0x993000,29232,9,0x1c0020,5724,0xc2000,0xc2004,0x7c2000,42504,0x90180,0x7c0480,50688,0x90180,29184,0x990000,14336
.long 0x485000,0xb30000,10,5120
.zero 48
.long 0x99b400,29492,9,0x1c1020,5692,0xc2000,0xc2008,0x7c2800,46600,0x98180,0x7c04c0,50688,0x98180,29444,0x998400,14336
.long 0x4a5000,0xb30800,10,5120
.zero 48
.long 0x993800,29240,9,0x1c2020,5660,0xc2000,0xc3004,0x7c3000,42508,0x901c0,0x7e0480,50944,0x94180,29312,0x994000,15360
.long 0x4c5000,0xb38400,10,5184
.zero 48
.long 0x99bc00,29500,9,0x1c3020,5632,0xc2000,0xc3008,0x7c3800,46604,0x981c0,0x7e04c0,50944,0x9c180,29572,0x99c400,15360
.long 0x4e5000,0xb38c00,10,5184
.zero 48
.long 0xa12000,33312,9,0x200020,6236,0x102000,0x102004,0x802000,43016,0x110100,0x780880,54272,0x110100,33280,0xa10000,12288
.long 0x40d000,0xb20000,26,5632
.zero 48
.long 0xa1a400,33572,9,0x201020,6204,0x102000,0x102008,0x802800,47112,0x118100,0x7808c0,54272,0x118100,33540,0xa18400,12288
.long 0x42d000,0xb20800,26,5632
.zero 48
.long 0xa12800,33320,9,0x202020,6172,0x102000,0x103004,0x803000,43020,0x110140,0x7a0880,54528,0x114100,33408,0xa14000,13312
.long 0x44d000,0xb28400,26,5696
.zero 48
.long 0xa1ac00,33580,9,0x203020,6144,0x102000,0x103008,0x803800,47116,0x118140,0x7a08c0,54528,0x11c100,33668,0xa1c400,13312
.long 0x46d000,0xb28c00,26,5696
.zero 48
.long 0xa13000,33328,9,0x240020,6748,0x142000,0x142004,0x842000,43528,0x110180,0x7c0880,54784,0x110180,33280,0xa10000,14336
.long 0x48d000,0xb30000,26,5120
.zero 48
.long 0xa1b400,33588,9,0x241020,6716,0x142000,0x142008,0x842800,47624,0x118180,0x7c08c0,54784,0x118180,33540,0xa18400,14336
.long 0x4ad000,0xb30800,26,5120
.zero 48
.long 0xa13800,33336,9,0x242020,6684,0x142000,0x143004,0x843000,43532,0x1101c0,0x7e0880,55040,0x114180,33408,0xa14000,15360
.long 0x4cd000,0xb38400,26,5184
.zero 48
.long 0xa1bc00,33596,9,0x243020,6656,0x142000,0x143008,0x843800,47628,0x1181c0,0x7e08c0,55040,0x11c180,33668,0xa1c400,15360
.long 0x4ed000,0xb38c00,26,5184
.zero 48
.long 0xa92000,37408,9,0x280020,7260,0x182000,0x182004,0x882000,44040,0x190100,0x780c80,54272,0x190100,37376,0xa90000,12288
.long 0x415000,0xb20000,42,5632
.zero 48
.long 0xa9a400,37668,9,0x281020,7228,0x182000,0x182008,0x882800,48136,0x198100,0x780cc0,54272,0x198100,37636,0xa98400,12288
.long 0x435000,0xb20800,42,5632
.zero 48
.long 0xa92800,37416,9,0x282020,7196,0x182000,0x183004,0x883000,44044,0x190140,0x7a0c80,54528,0x194100,37504,0xa94000,13312
.long 0x455000,0xb28400,42,5696
.zero 48
.long 0xa9ac00,37676,9,0x283020,7168,0x182000,0x183008,0x883800,48140,0x198140,0x7a0cc0,54528,0x19c100,37764,0xa9c400,13312
.long 0x475000,0xb28c00,42,5696
.zero 48
.long 0xa93000,37424,9,0x2c0020,7772,0x1c2000,0x1c2004,0x8c2000,44552,0x190180,0x7c0c80,54784,0x190180,37376,0xa90000,14336
.long 0x495000,0xb30000,42,5120
.zero 48
.long 0xa9b400,37684,9,0x2c1020,7740,0x1c2000,0x1c2008,0x8c2800,48648,0x198180,0x7c0cc0,54784,0x198180,37636,0xa98400,14336
.long 0x4b5000,0xb30800,42,5120
.zero 48
.long 0xa93800,37432,9,0x2c2020,7708,0x1c2000,0x1c3004,0x8c3000,44556,0x1901c0,0x7e0c80,55040,0x194180,37504,0xa94000,15360
.long 0x4d5000,0xb38400,42,5184
.zero 48
.long 0xa9bc00,37692,9,0x2c3020,7680,0x1c2000,0x1c3008,0x8c3800,48652,0x1981c0,0x7e0cc0,55040,0x19c180,37764,0xa9c400,15360
.long 0x4f5000,0xb38c00,42,5184
.zero 48
.long 0x922000,25632,5,0x104000,4188,16384,16388,0x704000,40976,0x20100,0x780100,58368,0x20100,25600,0x920000,12288
.long 0x3fe000,0xb20000,0xfffffffc,5632
.zero 48
.long 0x92a400,25892,6,0x105000,4156,16384,16392,0x704800,45072,0x28100,0x780140,58368,0x28100,25860,0x928400,12288
.long 0x41e000,0xb20800,0xfffffffc,5632
.zero 48
.long 0x922800,25640,5,0x106000,4124,16384,20484,0x705000,40980,0x20140,0x7a0100,58624,0x24100,25728,0x924000,13312
.long 0x43e000,0xb28400,0xfffffffc,5696
.zero 48
.long 0x92ac00,25900,6,0x107000,4096,16384,20488,0x705800,45076,0x28140,0x7a0140,58624,0x2c100,25988,0x92c400,13312
.long 0x45e000,0xb28c00,0xfffffffc,5696
.zero 48
.long 0x923000,25648,5,0x144000,4700,0x44000,0x44004,0x744000,41488,0x20180,0x7c0100,58880,0x20180,25600,0x920000,14336
.long 0x47e000,0xb30000,0xfffffffc,5120
.zero 48
.long 0x92b400,25908,6,0x145000,4668,0x44000,0x44008,0x744800,45584,0x28180,0x7c0140,58880,0x28180,25860,0x928400,14336
.long 0x49e000,0xb30800,0xfffffffc,5120
.zero 48
.long 0x923800,25656,5,0x146000,4636,0x44000,0x45004,0x745000,41492,0x201c0,0x7e0100,59136,0x24180,25728,0x924000,15360
.long 0x4be000,0xb38400,0xfffffffc,5184
.zero 48
.long 0x92bc00,25916,6,0x147000,4608,0x44000,0x45008,0x745800,45588,0x281c0,0x7e0140,59136,0x2c180,25988,0x92c400,15360
.long 0x4de000,0xb38c00,0xfffffffc,5184
.zero 48
.long 0x9a2000,29728,9,0x184000,5212,0x84000,0x84004,0x784000,42000,0xa0100,0x780500,58368,0xa0100,29696,0x9a0000,12288
.long 0x406000,0xb20000,12,5632
.zero 48
.long 0x9aa400,29988,9,0x185000,5180,0x84000,0x84008,0x784800,46096,0xa8100,0x780540,58368,0xa8100,29956,0x9a8400,12288
.long 0x426000,0xb20800,12,5632
.zero 48
.long 0x9a2800,29736,9,0x186000,5148,0x84000,0x85004,0x785000,42004,0xa0140,0x7a0500,58624,0xa4100,29824,0x9a4000,13312
.long 0x446000,0xb28400,12,5696
.zero 48
.long 0x9aac00,29996,9,0x187000,5120,0x84000,0x85008,0x785800,46100,0xa8140,0x7a0540,58624,0xac100,30084,0x9ac400,13312
.long 0x466000,0xb28c00,12,5696
.zero 48
.long 0x9a3000,29744,9,0x1c4000,5724,0xc4000,0xc4004,0x7c4000,42512,0xa0180,0x7c0500,58880,0xa0180,29696,0x9a0000,14336
.long 0x486000,0xb30000,12,5120
.zero 48
.long 0x9ab400,30004,9,0x1c5000,5692,0xc4000,0xc4008,0x7c4800,46608,0xa8180,0x7c0540,58880,0xa8180,29956,0x9a8400,14336
.long 0x4a6000,0xb30800,12,5120
.zero 48
.long 0x9a3800,29752,9,0x1c6000,5660,0xc4000,0xc5004,0x7c5000,42516,0xa01c0,0x7e0500,59136,0xa4180,29824,0x9a4000,15360
.long 0x4c6000,0xb38400,12,5184
.zero 48
.long 0x9abc00,30012,9,0x1c7000,5632,0xc4000,0xc5008,0x7c5800,46612,0xa81c0,0x7e0540,59136,0xac180,30084,0x9ac400,15360
.long 0x4e6000,0xb38c00,12,5184
.zero 48
.long 0xa22000,33824,9,0x204000,6236,0x104000,0x104004,0x804000,43024,0x120100,0x780900,62464,0x120100,33792,0xa20000,12288
.long 0x40e000,0xb20000,28,5632
.zero 48
.long 0xa2a400,34084,9,0x205000,6204,0x104000,0x104008,0x804800,47120,0x128100,0x780940,62464,0x128100,34052,0xa28400,12288
.long 0x42e000,0xb20800,28,5632
.zero 48
.long 0xa22800,33832,9,0x206000,6172,0x104000,0x105004,0x805000,43028,0x120140,0x7a0900,62720,0x124100,33920,0xa24000,13312
.long 0x44e000,0xb28400,28,5696
.zero 48
.long 0xa2ac00,34092,9,0x207000,6144,0x104000,0x105008,0x805800,47124,0x128140,0x7a0940,62720,0x12c100,34180,0xa2c400,13312
.long 0x46e000,0xb28c00,28,5696
.zero 48
.long 0xa23000,33840,9,0x244000,6748,0x144000,0x144004,0x844000,43536,0x120180,0x7c0900,62976,0x120180,33792,0xa20000,14336
.long 0x48e000,0xb30000,28,5120
.zero 48
.long 0xa2b400,34100,9,0x245000,6716,0x144000,0x144008,0x844800,47632,0x128180,0x7c0940,62976,0x128180,34052,0xa28400,14336
.long 0x4ae000,0xb30800,28,5120
.zero 48
.long 0xa23800,33848,9,0x246000,6684,0x144000,0x145004,0x845000,43540,0x1201c0,0x7e0900,63232,0x124180,33920,0xa24000,15360
.long 0x4ce000,0xb38400,28,5184
.zero 48
.long 0xa2bc00,34108,9,0x247000,6656,0x144000,0x145008,0x845800,47636,0x1281c0,0x7e0940,63232,0x12c180,34180,0xa2c400,15360
.long 0x4ee000,0xb38c00,28,5184
.zero 48
.long 0xaa2000,37920,9,0x284000,7260,0x184000,0x184004,0x884000,44048,0x1a0100,0x780d00,62464,0x1a0100,37888,0xaa0000,12288
.long 0x416000,0xb20000,44,5632
.zero 48
.long 0xaaa400,38180,9,0x285000,7228,0x184000,0x184008,0x884800,48144,0x1a8100,0x780d40,62464,0x1a8100,38148,0xaa8400,12288
.long 0x436000,0xb20800,44,5632
.zero 48
.long 0xaa2800,37928,9,0x286000,7196,0x184000,0x185004,0x885000,44052,0x1a0140,0x7a0d00,62720,0x1a4100,38016,0xaa4000,13312
.long 0x456000,0xb28400,44,5696
.zero 48
.long 0xaaac00,38188,9,0x287000,7168,0x184000,0x185008,0x885800,48148,0x1a8140,0x7a0d40,62720,0x1ac100,38276,0xaac400,13312
.long 0x476000,0xb28c00,44,5696
.zero 48
.long 0xaa3000,37936,9,0x2c4000,7772,0x1c4000,0x1c4004,0x8c4000,44560,0x1a0180,0x7c0d00,62976,0x1a0180,37888,0xaa0000,14336
.long 0x496000,0xb30000,44,5120
.zero 48
.long 0xaab400,38196,9,0x2c5000,7740,0x1c4000,0x1c4008,0x8c4800,48656,0x1a8180,0x7c0d40,62976,0x1a8180,38148,0xaa8400,14336
.long 0x4b6000,0xb30800,44,5120
.zero 48
.long 0xaa3800,37944,9,0x2c6000,7708,0x1c4000,0x1c5004,0x8c5000,44564,0x1a01c0,0x7e0d00,63232,0x1a4180,38016,0xaa4000,15360
.long 0x4d6000,0xb38400,44,5184
.zero 48
.long 0xaabc00,38204,9,0x2c7000,7680,0x1c4000,0x1c5008,0x8c5800,48660,0x1a81c0,0x7e0d40,63232,0x1ac180,38276,0xaac400,15360
.long 0x4f6000,0xb38c00,44,5184
.zero 48
.long 0x932000,26144,7,0x104020,4188,24576,24580,0x706000,40984,0x30100,0x780180,66560,0x30100,26112,0x930000,12288
.long 0x3ff000,0xb20000,0xfffffffe,5632
.zero 48
.long 0x93a400,26404,8,0x105020,4156,24576,24584,0x706800,45080,0x38100,0x7801c0,66560,0x38100,26372,0x938400,12288
.long 0x41f000,0xb20800,0xfffffffe,5632
.zero 48
.long 0x932800,26152,7,0x106020,4124,24576,28676,0x707000,40988,0x30140,0x7a0180,66816,0x34100,26240,0x934000,13312
.long 0x43f000,0xb28400,0xfffffffe,5696
.zero 48
.long 0x93ac00,26412,8,0x107020,4096,24576,28680,0x707800,45084,0x38140,0x7a01c0,66816,0x3c100,26500,0x93c400,13312
.long 0x45f000,0xb28c00,0xfffffffe,5696
.zero 48
.long 0x933000,26160,7,0x144020,4700,0x46000,0x46004,0x746000,41496,0x30180,0x7c0180,67072,0x30180,26112,0x930000,14336
.long 0x47f000,0xb30000,0xfffffffe,5120
.zero 48
.long 0x93b400,26420,8,0x145020,4668,0x46000,0x46008,0x746800,45592,0x38180,0x7c01c0,67072,0x38180,26372,0x938400,14336
.long 0x49f000,0xb30800,0xfffffffe,5120
.zero 48
.long 0x933800,26168,7,0x146020,4636,0x46000,0x47004,0x747000,41500,0x301c0,0x7e0180,67328,0x34180,26240,0x934000,15360
.long 0x4bf000,0xb38400,0xfffffffe,5184
.zero 48
.long 0x93bc00,26428,8,0x147020,4608,0x46000,0x47008,0x747800,45596,0x381c0,0x7e01c0,67328,0x3c180,26500,0x93c400,15360
.long 0x4df000,0xb38c00,0xfffffffe,5184
.zero 48
.long 0x9b2000,30240,9,0x184020,5212,0x86000,0x86004,0x786000,42008,0xb0100,0x780580,66560,0xb0100,30208,0x9b0000,12288
.long 0x407000,0xb20000,14,5632
.zero 48
.long 0x9ba400,30500,9,0x185020,5180,0x86000,0x86008,0x786800,46104,0xb8100,0x7805c0,66560,0xb8100,30468,0x9b8400,12288
.long 0x427000,0xb20800,14,5632
.zero 48
.long 0x9b2800,30248,9,0x186020,5148,0x86000,0x87004,0x787000,42012,0xb0140,0x7a0580,66816,0xb4100,30336,0x9b4000,13312
.long 0x447000,0xb28400,14,5696
.zero 48
.long 0x9bac00,30508,9,0x187020,5120,0x86000,0x87008,0x787800,46108,0xb8140,0x7a05c0,66816,0xbc100,30596,0x9bc400,13312
.long 0x467000,0xb28c00,14,5696
.zero 48
.long 0x9b3000,30256,9,0x1c4020,5724,0xc6000,0xc6004,0x7c6000,42520,0xb0180,0x7c0580,67072,0xb0180,30208,0x9b0000,14336
.long 0x487000,0xb30000,14,5120
.zero 48
.long 0x9bb400,30516,9,0x1c5020,5692,0xc6000,0xc6008,0x7c6800,46616,0xb8180,0x7c05c0,67072,0xb8180,30468,0x9b8400,14336
.long 0x4a7000,0xb30800,14,5120
.zero 48
.long 0x9b3800,30264,9,0x1c6020,5660,0xc6000,0xc7004,0x7c7000,42524,0xb01c0,0x7e0580,67328,0xb4180,30336,0x9b4000,15360
.long 0x4c7000,0xb38400,14,5184
.zero 48
.long 0x9bbc00,30524,9,0x1c7020,5632,0xc6000,0xc7008,0x7c7800,46620,0xb81c0,0x7e05c0,67328,0xbc180,30596,0x9bc400,15360
.long 0x4e7000,0xb38c00,14,5184
.zero 48
.long 0xa32000,34336,9,0x204020,6236,0x106000,0x106004,0x806000,43032,0x130100,0x780980,70656,0x130100,34304,0xa30000,12288
.long 0x40f000,0xb20000,30,5632
.zero 48
.long 0xa3a400,34596,9,0x205020,6204,0x106000,0x106008,0x806800,47128,0x138100,0x7809c0,70656,0x138100,34564,0xa38400,12288
.long 0x42f000,0xb20800,30,5632
.zero 48
.long 0xa32800,34344,9,0x206020,6172,0x106000,0x107004,0x807000,43036,0x130140,0x7a0980,70912,0x134100,34432,0xa34000,13312
.long 0x44f000,0xb28400,30,5696
.zero 48
.long 0xa3ac00,34604,9,0x207020,6144,0x106000,0x107008,0x807800,47132,0x138140,0x7a09c0,70912,0x13c100,34692,0xa3c400,13312
.long 0x46f000,0xb28c00,30,5696
.zero 48
.long 0xa33000,34352,9,0x244020,6748,0x146000,0x146004,0x846000,43544,0x130180,0x7c0980,71168,0x130180,34304,0xa30000,14336
.long 0x48f000,0xb30000,30,5120
.zero 48
.long 0xa3b400,34612,9,0x245020,6716,0x146000,0x146008,0x846800,47640,0x138180,0x7c09c0,71168,0x138180,34564,0xa38400,14336
.long 0x4af000,0xb30800,30,5120
.zero 48
.long 0xa33800,34360,9,0x246020,6684,0x146000,0x147004,0x847000,43548,0x1301c0,0x7e0980,71424,0x134180,34432,0xa34000,15360
.long 0x4cf000,0xb38400,30,5184
.zero 48
.long 0xa3bc00,34620,9,0x247020,6656,0x146000,0x147008,0x847800,47644,0x1381c0,0x7e09c0,71424,0x13c180,34692,0xa3c400,15360
.long 0x4ef000,0xb38c00,30,5184
.zero 48
.long 0xab2000,38432,9,0x284020,7260,0x186000,0x186004,0x886000,44056,0x1b0100,0x780d80,70656,0x1b0100,38400,0xab0000,12288
.long 0x417000,0xb20000,46,5632
.zero 48
.long 0xaba400,38692,9,0x285020,7228,0x186000,0x186008,0x886800,48152,0x1b8100,0x780dc0,70656,0x1b8100,38660,0xab8400,12288
.long 0x437000,0xb20800,46,5632
.zero 48
.long 0xab2800,38440,9,0x286020,7196,0x186000,0x187004,0x887000,44060,0x1b0140,0x7a0d80,70912,0x1b4100,38528,0xab4000,13312
.long 0x457000,0xb28400,46,5696
.zero 48
.long 0xabac00,38700,9,0x287020,7168,0x186000,0x187008,0x887800,48156,0x1b8140,0x7a0dc0,70912,0x1bc100,38788,0xabc400,13312
.long 0x477000,0xb28c00,46,5696
.zero 48
.long 0xab3000,38448,9,0x2c4020,7772,0x1c6000,0x1c6004,0x8c6000,44568,0x1b0180,0x7c0d80,71168,0x1b0180,38400,0xab0000,14336
.long 0x497000,0xb30000,46,5120
.zero 48
.long 0xabb400,38708,9,0x2c5020,7740,0x1c6000,0x1c6008,0x8c6800,48664,0x1b8180,0x7c0dc0,71168,0x1b8180,38660,0xab8400,14336
.long 0x4b7000,0xb30800,46,5120
.zero 48
.long 0xab3800,38456,9,0x2c6020,7708,0x1c6000,0x1c7004,0x8c7000,44572,0x1b01c0,0x7e0d80,71424,0x1b4180,38528,0xab4000,15360
.long 0x4d7000,0xb38400,46,5184
.zero 48
.long 0xabbc00,38716,9,0x2c7020,7680,0x1c6000,0x1c7008,0x8c7800,48668,0x1b81c0,0x7e0dc0,71424,0x1bc180,38788,0xabc400,15360
.long 0x4f7000,0xb38c00,46,5184
.zero 48
.long 0x942000,26656,9,0x108000,4188,32768,32772,0x708000,40992,0x40100,0x780200,41984,0x40100,26624,0x940000,12288
.long 0x400000,0xb20000,0,5632
.zero 48
.long 0x94a400,26916,9,0x109000,4156,32768,32776,0x708800,45088,0x48100,0x780240,41984,0x48100,26884,0x948400,12288
.long 0x420000,0xb20800,0,5632
.zero 48
.long 0x942800,26664,9,0x10a000,4124,32768,36868,0x709000,40996,0x40140,0x7a0200,42240,0x44100,26752,0x944000,13312
.long 0x440000,0xb28400,0,5696
.zero 48
.long 0x94ac00,26924,9,0x10b000,4096,32768,36872,0x709800,45092,0x48140,0x7a0240,42240,0x4c100,27012,0x94c400,13312
.long 0x460000,0xb28c00,0,5696
.zero 48
.long 0x943000,26672,9,0x148000,4700,0x48000,0x48004,0x748000,41504,0x40180,0x7c0200,42496,0x40180,26624,0x940000,14336
.long 0x480000,0xb30000,0,5120
.zero 48
.long 0x94b400,26932,9,0x149000,4668,0x48000,0x48008,0x748800,45600,0x48180,0x7c0240,42496,0x48180,26884,0x948400,14336
.long 0x4a0000,0xb30800,0,5120
.zero 48
.long 0x943800,26680,9,0x14a000,4636,0x48000,0x49004,0x749000,41508,0x401c0,0x7e0200,42752,0x44180,26752,0x944000,15360
.long 0x4c0000,0xb38400,0,5184
.zero 48
.long 0x94bc00,26940,9,0x14b000,4608,0x48000,0x49008,0x749800,45604,0x481c0,0x7e0240,42752,0x4c180,27012,0x94c400,15360
.long 0x4e0000,0xb38c00,0,5184
.zero 48
.long 0x9c2000,30752,9,0x188000,5212,0x88000,0x88004,0x788000,42016,0xc0100,0x780600,41984,0xc0100,30720,0x9c0000,12288
.long 0x408000,0xb20000,16,5632
.zero 48
.long 0x9ca400,31012,9,0x189000,5180,0x88000,0x88008,0x788800,46112,0xc8100,0x780640,41984,0xc8100,30980,0x9c8400,12288
.long 0x428000,0xb20800,16,5632
.zero 48
.long 0x9c2800,30760,9,0x18a000,5148,0x88000,0x89004,0x789000,42020,0xc0140,0x7a0600,42240,0xc4100,30848,0x9c4000,13312
.long 0x448000,0xb28400,16,5696
.zero 48
.long 0x9cac00,31020,9,0x18b000,5120,0x88000,0x89008,0x789800,46116,0xc8140,0x7a0640,42240,0xcc100,31108,0x9cc400,13312
.long 0x468000,0xb28c00,16,5696
.zero 48
.long 0x9c3000,30768,9,0x1c8000,5724,0xc8000,0xc8004,0x7c8000,42528,0xc0180,0x7c0600,42496,0xc0180,30720,0x9c0000,14336
.long 0x488000,0xb30000,16,5120
.zero 48
.long 0x9cb400,31028,9,0x1c9000,5692,0xc8000,0xc8008,0x7c8800,46624,0xc8180,0x7c0640,42496,0xc8180,30980,0x9c8400,14336
.long 0x4a8000,0xb30800,16,5120
.zero 48
.long 0x9c3800,30776,9,0x1ca000,5660,0xc8000,0xc9004,0x7c9000,42532,0xc01c0,0x7e0600,42752,0xc4180,30848,0x9c4000,15360
.long 0x4c8000,0xb38400,16,5184
.zero 48
.long 0x9cbc00,31036,9,0x1cb000,5632,0xc8000,0xc9008,0x7c9800,46628,0xc81c0,0x7e0640,42752,0xcc180,31108,0x9cc400,15360
.long 0x4e8000,0xb38c00,16,5184
.zero 48
.long 0xa42000,34848,9,0x208000,6236,0x108000,0x108004,0x808000,43040,0x140100,0x780a00,46080,0x140100,34816,0xa40000,12288
.long 0x410000,0xb20000,32,5632
.zero 48
.long 0xa4a400,35108,9,0x209000,6204,0x108000,0x108008,0x808800,47136,0x148100,0x780a40,46080,0x148100,35076,0xa48400,12288
.long 0x430000,0xb20800,32,5632
.zero 48
.long 0xa42800,34856,9,0x20a000,6172,0x108000,0x109004,0x809000,43044,0x140140,0x7a0a00,46336,0x144100,34944,0xa44000,13312
.long 0x450000,0xb28400,32,5696
.zero 48
.long 0xa4ac00,35116,9,0x20b000,6144,0x108000,0x109008,0x809800,47140,0x148140,0x7a0a40,46336,0x14c100,35204,0xa4c400,13312
.long 0x470000,0xb28c00,32,5696
.zero 48
.long 0xa43000,34864,9,0x248000,6748,0x148000,0x148004,0x848000,43552,0x140180,0x7c0a00,46592,0x140180,34816,0xa40000,14336
.long 0x490000,0xb30000,32,5120
.zero 48
.long 0xa4b400,35124,9,0x249000,6716,0x148000,0x148008,0x848800,47648,0x148180,0x7c0a40,46592,0x148180,35076,0xa48400,14336
.long 0x4b0000,0xb30800,32,5120
.zero 48
.long 0xa43800,34872,9,0x24a000,6684,0x148000,0x149004,0x849000,43556,0x1401c0,0x7e0a00,46848,0x144180,34944,0xa44000,15360
.long 0x4d0000,0xb38400,32,5184
.zero 48
.long 0xa4bc00,35132,9,0x24b000,6656,0x148000,0x149008,0x849800,47652,0x1481c0,0x7e0a40,46848,0x14c180,35204,0xa4c400,15360
.long 0x4f0000,0xb38c00,32,5184
.zero 48
.long 0xac2000,38944,9,0x288000,7260,0x188000,0x188004,0x888000,44064,0x1c0100,0x780e00,46080,0x1c0100,38912,0xac0000,12288
.long 0x418000,0xb20000,48,5632
.zero 48
.long 0xaca400,39204,9,0x289000,7228,0x188000,0x188008,0x888800,48160,0x1c8100,0x780e40,46080,0x1c8100,39172,0xac8400,12288
.long 0x438000,0xb20800,48,5632
.zero 48
.long 0xac2800,38952,9,0x28a000,7196,0x188000,0x189004,0x889000,44068,0x1c0140,0x7a0e00,46336,0x1c4100,39040,0xac4000,13312
.long 0x458000,0xb28400,48,5696
.zero 48
.long 0xacac00,39212,9,0x28b000,7168,0x188000,0x189008,0x889800,48164,0x1c8140,0x7a0e40,46336,0x1cc100,39300,0xacc400,13312
.long 0x478000,0xb28c00,48,5696
.zero 48
.long 0xac3000,38960,9,0x2c8000,7772,0x1c8000,0x1c8004,0x8c8000,44576,0x1c0180,0x7c0e00,46592,0x1c0180,38912,0xac0000,14336
.long 0x498000,0xb30000,48,5120
.zero 48
.long 0xacb400,39220,9,0x2c9000,7740,0x1c8000,0x1c8008,0x8c8800,48672,0x1c8180,0x7c0e40,46592,0x1c8180,39172,0xac8400,14336
.long 0x4b8000,0xb30800,48,5120
.zero 48
.long 0xac3800,38968,9,0x2ca000,7708,0x1c8000,0x1c9004,0x8c9000,44580,0x1c01c0,0x7e0e00,46848,0x1c4180,39040,0xac4000,15360
.long 0x4d8000,0xb38400,48,5184
.zero 48
.long 0xacbc00,39228,9,0x2cb000,7680,0x1c8000,0x1c9008,0x8c9800,48676,0x1c81c0,0x7e0e40,46848,0x1cc180,39300,0xacc400,15360
.long 0x4f8000,0xb38c00,48,5184
.zero 48
.long 0x952000,27168,9,0x108020,4188,40960,40964,0x70a000,41000,0x50100,0x780280,50176,0x50100,27136,0x950000,12288
.long 0x401000,0xb20000,2,5632
.zero 48
.long 0x95a400,27428,9,0x109020,4156,40960,40968,0x70a800,45096,0x58100,0x7802c0,50176,0x58100,27396,0x958400,12288
.long 0x421000,0xb20800,2,5632
.zero 48
.long 0x952800,27176,9,0x10a020,4124,40960,45060,0x70b000,41004,0x50140,0x7a0280,50432,0x54100,27264,0x954000,13312
.long 0x441000,0xb28400,2,5696
.zero 48
.long 0x95ac00,27436,9,0x10b020,4096,40960,45064,0x70b800,45100,0x58140,0x7a02c0,50432,0x5c100,27524,0x95c400,13312
.long 0x461000,0xb28c00,2,5696
.zero 48
.long 0x953000,27184,9,0x148020,4700,0x4a000,0x4a004,0x74a000,41512,0x50180,0x7c0280,50688,0x50180,27136,0x950000,14336
.long 0x481000,0xb30000,2,5120
.zero 48
.long 0x95b400,27444,9,0x149020,4668,0x4a000,0x4a008,0x74a800,45608,0x58180,0x7c02c0,50688,0x58180,27396,0x958400,14336
.long 0x4a1000,0xb30800,2,5120
.zero 48
.long 0x953800,27192,9,0x14a020,4636,0x4a000,0x4b004,0x74b000,41516,0x501c0,0x7e0280,50944,0x54180,27264,0x954000,15360
.long 0x4c1000,0xb38400,2,5184
.zero 48
.long 0x95bc00,27452,9,0x14b020,4608,0x4a000,0x4b008,0x74b800,45612,0x581c0,0x7e02c0,50944,0x5c180,27524,0x95c400,15360
.long 0x4e1000,0xb38c00,2,5184
.zero 48
.long 0x9d2000,31264,9,0x188020,5212,0x8a000,0x8a004,0x78a000,42024,0xd0100,0x780680,50176,0xd0100,31232,0x9d0000,12288
.long 0x409000,0xb20000,18,5632
.zero 48
.long 0x9da400,31524,9,0x189020,5180,0x8a000,0x8a008,0x78a800,46120,0xd8100,0x7806c0,50176,0xd8100,31492,0x9d8400,12288
.long 0x429000,0xb20800,18,5632
.zero 48
.long 0x9d2800,31272,9,0x18a020,5148,0x8a000,0x8b004,0x78b000,42028,0xd0140,0x7a0680,50432,0xd4100,31360,0x9d4000,13312
.long 0x449000,0xb28400,18,5696
.zero 48
.long 0x9dac00,31532,9,0x18b020,5120,0x8a000,0x8b008,0x78b800,46124,0xd8140,0x7a06c0,50432,0xdc100,31620,0x9dc400,13312
.long 0x469000,0xb28c00,18,5696
.zero 48
.long 0x9d3000,31280,9,0x1c8020,5724,0xca000,0xca004,0x7ca000,42536,0xd0180,0x7c0680,50688,0xd0180,31232,0x9d0000,14336
.long 0x489000,0xb30000,18,5120
.zero 48
.long 0x9db400,31540,9,0x1c9020,5692,0xca000,0xca008,0x7ca800,46632,0xd8180,0x7c06c0,50688,0xd8180,31492,0x9d8400,14336
.long 0x4a9000,0xb30800,18,5120
.zero 48
.long 0x9d3800,31288,9,0x1ca020,5660,0xca000,0xcb004,0x7cb000,42540,0xd01c0,0x7e0680,50944,0xd4180,31360,0x9d4000,15360
.long 0x4c9000,0xb38400,18,5184
.zero 48
.long 0x9dbc00,31548,9,0x1cb020,5632,0xca000,0xcb008,0x7cb800,46636,0xd81c0,0x7e06c0,50944,0xdc180,31620,0x9dc400,15360
.long 0x4e9000,0xb38c00,18,5184
.zero 48
.long 0xa52000,35360,9,0x208020,6236,0x10a000,0x10a004,0x80a000,43048,0x150100,0x780a80,54272,0x150100,35328,0xa50000,12288
.long 0x411000,0xb20000,34,5632
.zero 48
.long 0xa5a400,35620,9,0x209020,6204,0x10a000,0x10a008,0x80a800,47144,0x158100,0x780ac0,54272,0x158100,35588,0xa58400,12288
.long 0x431000,0xb20800,34,5632
.zero 48
.long 0xa52800,35368,9,0x20a020,6172,0x10a000,0x10b004,0x80b000,43052,0x150140,0x7a0a80,54528,0x154100,35456,0xa54000,13312
.long 0x451000,0xb28400,34,5696
.zero 48
.long 0xa5ac00,35628,9,0x20b020,6144,0x10a000,0x10b008,0x80b800,47148,0x158140,0x7a0ac0,54528,0x15c100,35716,0xa5c400,13312
.long 0x471000,0xb28c00,34,5696
.zero 48
.long 0xa53000,35376,9,0x248020,6748,0x14a000,0x14a004,0x84a000,43560,0x150180,0x7c0a80,54784,0x150180,35328,0xa50000,14336
.long 0x491000,0xb30000,34,5120
.zero 48
.long 0xa5b400,35636,9,0x249020,6716,0x14a000,0x14a008,0x84a800,47656,0x158180,0x7c0ac0,54784,0x158180,35588,0xa58400,14336
.long 0x4b1000,0xb30800,34,5120
.zero 48
.long 0xa53800,35384,9,0x24a020,6684,0x14a000,0x14b004,0x84b000,43564,0x1501c0,0x7e0a80,55040,0x154180,35456,0xa54000,15360
.long 0x4d1000,0xb38400,34,5184
.zero 48
.long 0xa5bc00,35644,9,0x24b020,6656,0x14a000,0x14b008,0x84b800,47660,0x1581c0,0x7e0ac0,55040,0x15c180,35716,0xa5c400,15360
.long 0x4f1000,0xb38c00,34,5184
.zero 48
.long 0xad2000,39456,9,0x288020,7260,0x18a000,0x18a004,0x88a000,44072,0x1d0100,0x780e80,54272,0x1d0100,39424,0xad0000,12288
.long 0x419000,0xb20000,50,5632
.zero 48
.long 0xada400,39716,9,0x289020,7228,0x18a000,0x18a008,0x88a800,48168,0x1d8100,0x780ec0,54272,0x1d8100,39684,0xad8400,12288
.long 0x439000,0xb20800,50,5632
.zero 48
.long 0xad2800,39464,9,0x28a020,7196,0x18a000,0x18b004,0x88b000,44076,0x1d0140,0x7a0e80,54528,0x1d4100,39552,0xad4000,13312
.long 0x459000,0xb28400,50,5696
.zero 48
.long 0xadac00,39724,9,0x28b020,7168,0x18a000,0x18b008,0x88b800,48172,0x1d8140,0x7a0ec0,54528,0x1dc100,39812,0xadc400,13312
.long 0x479000,0xb28c00,50,5696
.zero 48
.long 0xad3000,39472,9,0x2c8020,7772,0x1ca000,0x1ca004,0x8ca000,44584,0x1d0180,0x7c0e80,54784,0x1d0180,39424,0xad0000,14336
.long 0x499000,0xb30000,50,5120
.zero 48
.long 0xadb400,39732,9,0x2c9020,7740,0x1ca000,0x1ca008,0x8ca800,48680,0x1d8180,0x7c0ec0,54784,0x1d8180,39684,0xad8400,14336
.long 0x4b9000,0xb30800,50,5120
.zero 48
.long 0xad3800,39480,9,0x2ca020,7708,0x1ca000,0x1cb004,0x8cb000,44588,0x1d01c0,0x7e0e80,55040,0x1d4180,39552,0xad4000,15360
.long 0x4d9000,0xb38400,50,5184
.zero 48
.long 0xadbc00,39740,9,0x2cb020,7680,0x1ca000,0x1cb008,0x8cb800,48684,0x1d81c0,0x7e0ec0,55040,0x1dc180,39812,0xadc400,15360
.long 0x4f9000,0xb38c00,50,5184
.zero 48
.long 0x962000,27680,9,0x10c000,4188,49152,49156,0x70c000,41008,0x60100,0x780300,58368,0x60100,27648,0x960000,12288
.long 0x402000,0xb20000,4,5632
.zero 48
.long 0x96a400,27940,9,0x10d000,4156,49152,49160,0x70c800,45104,0x68100,0x780340,58368,0x68100,27908,0x968400,12288
.long 0x422000,0xb20800,4,5632
.zero 48
.long 0x962800,27688,9,0x10e000,4124,49152,53252,0x70d000,41012,0x60140,0x7a0300,58624,0x64100,27776,0x964000,13312
.long 0x442000,0xb28400,4,5696
.zero 48
.long 0x96ac00,27948,9,0x10f000,4096,49152,53256,0x70d800,45108,0x68140,0x7a0340,58624,0x6c100,28036,0x96c400,13312
.long 0x462000,0xb28c00,4,5696
.zero 48
.long 0x963000,27696,9,0x14c000,4700,0x4c000,0x4c004,0x74c000,41520,0x60180,0x7c0300,58880,0x60180,27648,0x960000,14336
.long 0x482000,0xb30000,4,5120
.zero 48
.long 0x96b400,27956,9,0x14d000,4668,0x4c000,0x4c008,0x74c800,45616,0x68180,0x7c0340,58880,0x68180,27908,0x968400,14336
.long 0x4a2000,0xb30800,4,5120
.zero 48
.long 0x963800,27704,9,0x14e000,4636,0x4c000,0x4d004,0x74d000,41524,0x601c0,0x7e0300,59136,0x64180,27776,0x964000,15360
.long 0x4c2000,0xb38400,4,5184
.zero 48
.long 0x96bc00,27964,9,0x14f000,4608,0x4c000,0x4d008,0x74d800,45620,0x681c0,0x7e0340,59136,0x6c180,28036,0x96c400,15360
.long 0x4e2000,0xb38c00,4,5184
.zero 48
.long 0x9e2000,31776,9,0x18c000,5212,0x8c000,0x8c004,0x78c000,42032,0xe0100,0x780700,58368,0xe0100,31744,0x9e0000,12288
.long 0x40a000,0xb20000,20,5632
.zero 48
.long 0x9ea400,32036,9,0x18d000,5180,0x8c000,0x8c008,0x78c800,46128,0xe8100,0x780740,58368,0xe8100,32004,0x9e8400,12288
.long 0x42a000,0xb20800,20,5632
.zero 48
.long 0x9e2800,31784,9,0x18e000,5148,0x8c000,0x8d004,0x78d000,42036,0xe0140,0x7a0700,58624,0xe4100,31872,0x9e4000,13312
.long 0x44a000,0xb28400,20,5696
.zero 48
.long 0x9eac00,32044,9,0x18f000,5120,0x8c000,0x8d008,0x78d800,46132,0xe8140,0x7a0740,58624,0xec100,32132,0x9ec400,13312
.long 0x46a000,0xb28c00,20,5696
.zero 48
.long 0x9e3000,31792,9,0x1cc000,5724,0xcc000,0xcc004,0x7cc000,42544,0xe0180,0x7c0700,58880,0xe0180,31744,0x9e0000,14336
.long 0x48a000,0xb30000,20,5120
.zero 48
.long 0x9eb400,32052,9,0x1cd000,5692,0xcc000,0xcc008,0x7cc800,46640,0xe8180,0x7c0740,58880,0xe8180,32004,0x9e8400,14336
.long 0x4aa000,0xb30800,20,5120
.zero 48
.long 0x9e3800,31800,9,0x1ce000,5660,0xcc000,0xcd004,0x7cd000,42548,0xe01c0,0x7e0700,59136,0xe4180,31872,0x9e4000,15360
.long 0x4ca000,0xb38400,20,5184
.zero 48
.long 0x9ebc00,32060,9,0x1cf000,5632,0xcc000,0xcd008,0x7cd800,46644,0xe81c0,0x7e0740,59136,0xec180,32132,0x9ec400,15360
.long 0x4ea000,0xb38c00,20,5184
.zero 48
.long 0xa62000,35872,9,0x20c000,6236,0x10c000,0x10c004,0x80c000,43056,0x160100,0x780b00,62464,0x160100,35840,0xa60000,12288
.long 0x412000,0xb20000,36,5632
.zero 48
.long 0xa6a400,36132,9,0x20d000,6204,0x10c000,0x10c008,0x80c800,47152,0x168100,0x780b40,62464,0x168100,36100,0xa68400,12288
.long 0x432000,0xb20800,36,5632
.zero 48
.long 0xa62800,35880,9,0x20e000,6172,0x10c000,0x10d004,0x80d000,43060,0x160140,0x7a0b00,62720,0x164100,35968,0xa64000,13312
.long 0x452000,0xb28400,36,5696
.zero 48
.long 0xa6ac00,36140,9,0x20f000,6144,0x10c000,0x10d008,0x80d800,47156,0x168140,0x7a0b40,62720,0x16c100,36228,0xa6c400,13312
.long 0x472000,0xb28c00,36,5696
.zero 48
.long 0xa63000,35888,9,0x24c000,6748,0x14c000,0x14c004,0x84c000,43568,0x160180,0x7c0b00,62976,0x160180,35840,0xa60000,14336
.long 0x492000,0xb30000,36,5120
.zero 48
.long 0xa6b400,36148,9,0x24d000,6716,0x14c000,0x14c008,0x84c800,47664,0x168180,0x7c0b40,62976,0x168180,36100,0xa68400,14336
.long 0x4b2000,0xb30800,36,5120
.zero 48
.long 0xa63800,35896,9,0x24e000,6684,0x14c000,0x14d004,0x84d000,43572,0x1601c0,0x7e0b00,63232,0x164180,35968,0xa64000,15360
.long 0x4d2000,0xb38400,36,5184
.zero 48
.long 0xa6bc00,36156,9,0x24f000,6656,0x14c000,0x14d008,0x84d800,47668,0x1681c0,0x7e0b40,63232,0x16c180,36228,0xa6c400,15360
.long 0x4f2000,0xb38c00,36,5184
.zero 48
.long 0xae2000,39968,9,0x28c000,7260,0x18c000,0x18c004,0x88c000,44080,0x1e0100,0x780f00,62464,0x1e0100,39936,0xae0000,12288
.long 0x41a000,0xb20000,52,5632
.zero 48
.long 0xaea400,40228,9,0x28d000,7228,0x18c000,0x18c008,0x88c800,48176,0x1e8100,0x780f40,62464,0x1e8100,40196,0xae8400,12288
.long 0x43a000,0xb20800,52,5632
.zero 48
.long 0xae2800,39976,9,0x28e000,7196,0x18c000,0x18d004,0x88d000,44084,0x1e0140,0x7a0f00,62720,0x1e4100,40064,0xae4000,13312
.long 0x45a000,0xb28400,52,5696
.zero 48
.long 0xaeac00,40236,9,0x28f000,7168,0x18c000,0x18d008,0x88d800,48180,0x1e8140,0x7a0f40,62720,0x1ec100,40324,0xaec400,13312
.long 0x47a000,0xb28c00,52,5696
.zero 48
.long 0xae3000,39984,9,0x2cc000,7772,0x1cc000,0x1cc004,0x8cc000,44592,0x1e0180,0x7c0f00,62976,0x1e0180,39936,0xae0000,14336
.long 0x49a000,0xb30000,52,5120
.zero 48
.long 0xaeb400,40244,9,0x2cd000,7740,0x1cc000,0x1cc008,0x8cc800,48688,0x1e8180,0x7c0f40,62976,0x1e8180,40196,0xae8400,14336
.long 0x4ba000,0xb30800,52,5120
.zero 48
.long 0xae3800,39992,9,0x2ce000,7708,0x1cc000,0x1cd004,0x8cd000,44596,0x1e01c0,0x7e0f00,63232,0x1e4180,40064,0xae4000,15360
.long 0x4da000,0xb38400,52,5184
.zero 48
.long 0xaebc00,40252,9,0x2cf000,7680,0x1cc000,0x1cd008,0x8cd800,48692,0x1e81c0,0x7e0f40,63232,0x1ec180,40324,0xaec400,15360
.long 0x4fa000,0xb38c00,52,5184
.zero 48
.long 0x972000,28192,9,0x10c020,4188,57344,57348,0x70e000,41016,0x70100,0x780380,66560,0x70100,28160,0x970000,12288
.long 0x403000,0xb20000,6,5632
.zero 48
.long 0x97a400,28452,9,0x10d020,4156,57344,57352,0x70e800,45112,0x78100,0x7803c0,66560,0x78100,28420,0x978400,12288
.long 0x423000,0xb20800,6,5632
.zero 48
.long 0x972800,28200,9,0x10e020,4124,57344,61444,0x70f000,41020,0x70140,0x7a0380,66816,0x74100,28288,0x974000,13312
.long 0x443000,0xb28400,6,5696
.zero 48
.long 0x97ac00,28460,9,0x10f020,4096,57344,61448,0x70f800,45116,0x78140,0x7a03c0,66816,0x7c100,28548,0x97c400,13312
.long 0x463000,0xb28c00,6,5696
.zero 48
.long 0x973000,28208,9,0x14c020,4700,0x4e000,0x4e004,0x74e000,41528,0x70180,0x7c0380,67072,0x70180,28160,0x970000,14336
.long 0x483000,0xb30000,6,5120
.zero 48
.long 0x97b400,28468,9,0x14d020,4668,0x4e000,0x4e008,0x74e800,45624,0x78180,0x7c03c0,67072,0x78180,28420,0x978400,14336
.long 0x4a3000,0xb30800,6,5120
.zero 48
.long 0x973800,28216,9,0x14e020,4636,0x4e000,0x4f004,0x74f000,41532,0x701c0,0x7e0380,67328,0x74180,28288,0x974000,15360
.long 0x4c3000,0xb38400,6,5184
.zero 48
.long 0x97bc00,28476,9,0x14f020,4608,0x4e000,0x4f008,0x74f800,45628,0x781c0,0x7e03c0,67328,0x7c180,28548,0x97c400,15360
.long 0x4e3000,0xb38c00,6,5184
.zero 48
.long 0x9f2000,32288,9,0x18c020,5212,0x8e000,0x8e004,0x78e000,42040,0xf0100,0x780780,66560,0xf0100,32256,0x9f0000,12288
.long 0x40b000,0xb20000,22,5632
.zero 48
.long 0x9fa400,32548,9,0x18d020,5180,0x8e000,0x8e008,0x78e800,46136,0xf8100,0x7807c0,66560,0xf8100,32516,0x9f8400,12288
.long 0x42b000,0xb20800,22,5632
.zero 48
.long 0x9f2800,32296,9,0x18e020,5148,0x8e000,0x8f004,0x78f000,42044,0xf0140,0x7a0780,66816,0xf4100,32384,0x9f4000,13312
.long 0x44b000,0xb28400,22,5696
.zero 48
.long 0x9fac00,32556,9,0x18f020,5120,0x8e000,0x8f008,0x78f800,46140,0xf8140,0x7a07c0,66816,0xfc100,32644,0x9fc400,13312
.long 0x46b000,0xb28c00,22,5696
.zero 48
.long 0x9f3000,32304,9,0x1cc020,5724,0xce000,0xce004,0x7ce000,42552,0xf0180,0x7c0780,67072,0xf0180,32256,0x9f0000,14336
.long 0x48b000,0xb30000,22,5120
.zero 48
.long 0x9fb400,32564,9,0x1cd020,5692,0xce000,0xce008,0x7ce800,46648,0xf8180,0x7c07c0,67072,0xf8180,32516,0x9f8400,14336
.long 0x4ab000,0xb30800,22,5120
.zero 48
.long 0x9f3800,32312,9,0x1ce020,5660,0xce000,0xcf004,0x7cf000,42556,0xf01c0,0x7e0780,67328,0xf4180,32384,0x9f4000,15360
.long 0x4cb000,0xb38400,22,5184
.zero 48
.long 0x9fbc00,32572,9,0x1cf020,5632,0xce000,0xcf008,0x7cf800,46652,0xf81c0,0x7e07c0,67328,0xfc180,32644,0x9fc400,15360
.long 0x4eb000,0xb38c00,22,5184
.zero 48
.long 0xa72000,36384,9,0x20c020,6236,0x10e000,0x10e004,0x80e000,43064,0x170100,0x780b80,70656,0x170100,36352,0xa70000,12288
.long 0x413000,0xb20000,38,5632
.zero 48
.long 0xa7a400,36644,9,0x20d020,6204,0x10e000,0x10e008,0x80e800,47160,0x178100,0x780bc0,70656,0x178100,36612,0xa78400,12288
.long 0x433000,0xb20800,38,5632
.zero 48
.long 0xa72800,36392,9,0x20e020,6172,0x10e000,0x10f004,0x80f000,43068,0x170140,0x7a0b80,70912,0x174100,36480,0xa74000,13312
.long 0x453000,0xb28400,38,5696
.zero 48
.long 0xa7ac00,36652,9,0x20f020,6144,0x10e000,0x10f008,0x80f800,47164,0x178140,0x7a0bc0,70912,0x17c100,36740,0xa7c400,13312
.long 0x473000,0xb28c00,38,5696
.zero 48
.long 0xa73000,36400,9,0x24c020,6748,0x14e000,0x14e004,0x84e000,43576,0x170180,0x7c0b80,71168,0x170180,36352,0xa70000,14336
.long 0x493000,0xb30000,38,5120
.zero 48
.long 0xa7b400,36660,9,0x24d020,6716,0x14e000,0x14e008,0x84e800,47672,0x178180,0x7c0bc0,71168,0x178180,36612,0xa78400,14336
.long 0x4b3000,0xb30800,38,5120
.zero 48
.long 0xa73800,36408,9,0x24e020,6684,0x14e000,0x14f004,0x84f000,43580,0x1701c0,0x7e0b80,71424,0x174180,36480,0xa74000,15360
.long 0x4d3000,0xb38400,38,5184
.zero 48
.long 0xa7bc00,36668,9,0x24f020,6656,0x14e000,0x14f008,0x84f800,47676,0x1781c0,0x7e0bc0,71424,0x17c180,36740,0xa7c400,15360
.long 0x4f3000,0xb38c00,38,5184
.zero 48
.long 0xaf2000,40480,9,0x28c020,7260,0x18e000,0x18e004,0x88e000,44088,0x1f0100,0x780f80,70656,0x1f0100,40448,0xaf0000,12288
.long 0x41b000,0xb20000,54,5632
.zero 48
.long 0xafa400,40740,9,0x28d020,7228,0x18e000,0x18e008,0x88e800,48184,0x1f8100,0x780fc0,70656,0x1f8100,40708,0xaf8400,12288
.long 0x43b000,0xb20800,54,5632
.zero 48
.long 0xaf2800,40488,9,0x28e020,7196,0x18e000,0x18f004,0x88f000,44092,0x1f0140,0x7a0f80,70912,0x1f4100,40576,0xaf4000,13312
.long 0x45b000,0xb28400,54,5696
.zero 48
.long 0xafac00,40748,9,0x28f020,7168,0x18e000,0x18f008,0x88f800,48188,0x1f8140,0x7a0fc0,70912,0x1fc100,40836,0xafc400,13312
.long 0x47b000,0xb28c00,54,5696
.zero 48
.long 0xaf3000,40496,9,0x2cc020,7772,0x1ce000,0x1ce004,0x8ce000,44600,0x1f0180,0x7c0f80,71168,0x1f0180,40448,0xaf0000,14336
.long 0x49b000,0xb30000,54,5120
.zero 48
.long 0xafb400,40756,9,0x2cd020,7740,0x1ce000,0x1ce008,0x8ce800,48696,0x1f8180,0x7c0fc0,71168,0x1f8180,40708,0xaf8400,14336
.long 0x4bb000,0xb30800,54,5120
.zero 48
.long 0xaf3800,40504,9,0x2ce020,7708,0x1ce000,0x1cf004,0x8cf000,44604,0x1f01c0,0x7e0f80,71424,0x1f4180,40576,0xaf4000,15360
.long 0x4db000,0xb38400,54,5184
.zero 48
.long 0xafbc00,40764,9,0x2cf020,7680,0x1ce000,0x1cf008,0x8cf800,48700,0x1f81c0,0x7e0fc0,71424,0x1fc180,40836,0xafc400,15360
.long 0x4fb000,0xb38c00,54,5184
.zero 48
.long 0x900000,24576,1,0x110000,4316,65536,65540,0x710000,41088,0,0x700000,40960,0,24576,0x900000,8192
.long 0x2fc000,0xb00000,0xfffffff8,4608
.zero 48
.long 0x908400,24836,2,0x111000,4284,65536,65544,0x710800,45184,32768,0x700040,40960,32768,24836,0x908400,8192
.long 0x31c000,0xb00800,0xfffffff8,4608
.zero 48
.long 0x900800,24584,1,0x112000,4252,65536,69636,0x711000,41092,64,0x720000,41216,16384,24704,0x904000,9216
.long 0x33c000,0xb08400,0xfffffff8,4672
.zero 48
.long 0x908c00,24844,2,0x113000,4224,65536,69640,0x711800,45188,32832,0x720040,41216,49152,24964,0x90c400,9216
.long 0x35c000,0xb08c00,0xfffffff8,4672
.zero 48
.long 0x901000,24592,1,0x150000,4828,0x50000,0x50004,0x750000,41600,128,0x740000,41472,128,24576,0x900000,10240
.long 0x37c000,0xb10000,0xfffffff8,4096
.zero 48
.long 0x909400,24852,2,0x151000,4796,0x50000,0x50008,0x750800,45696,32896,0x740040,41472,32896,24836,0x908400,10240
.long 0x39c000,0xb10800,0xfffffff8,4096
.zero 48
.long 0x901800,24600,1,0x152000,4764,0x50000,0x51004,0x751000,41604,192,0x760000,41728,16512,24704,0x904000,11264
.long 0x3bc000,0xb18400,0xfffffff8,4160
.zero 48
.long 0x909c00,24860,2,0x153000,4736,0x50000,0x51008,0x751800,45700,32960,0x760040,41728,49280,24964,0x90c400,11264
.long 0x3dc000,0xb18c00,0xfffffff8,4160
.zero 48
.long 0x980000,28672,9,0x190000,5340,0x90000,0x90004,0x790000,42112,0x80000,0x700400,40960,0x80000,28672,0x980000,8192
.long 0x304000,0xb00000,8,4608
.zero 48
.long 0x988400,28932,9,0x191000,5308,0x90000,0x90008,0x790800,46208,0x88000,0x700440,40960,0x88000,28932,0x988400,8192
.long 0x324000,0xb00800,8,4608
.zero 48
.long 0x980800,28680,9,0x192000,5276,0x90000,0x91004,0x791000,42116,0x80040,0x720400,41216,0x84000,28800,0x984000,9216
.long 0x344000,0xb08400,8,4672
.zero 48
.long 0x988c00,28940,9,0x193000,5248,0x90000,0x91008,0x791800,46212,0x88040,0x720440,41216,0x8c000,29060,0x98c400,9216
.long 0x364000,0xb08c00,8,4672
.zero 48
.long 0x981000,28688,9,0x1d0000,5852,0xd0000,0xd0004,0x7d0000,42624,0x80080,0x740400,41472,0x80080,28672,0x980000,10240
.long 0x384000,0xb10000,8,4096
.zero 48
.long 0x989400,28948,9,0x1d1000,5820,0xd0000,0xd0008,0x7d0800,46720,0x88080,0x740440,41472,0x88080,28932,0x988400,10240
.long 0x3a4000,0xb10800,8,4096
.zero 48
.long 0x981800,28696,9,0x1d2000,5788,0xd0000,0xd1004,0x7d1000,42628,0x800c0,0x760400,41728,0x84080,28800,0x984000,11264
.long 0x3c4000,0xb18400,8,4160
.zero 48
.long 0x989c00,28956,9,0x1d3000,5760,0xd0000,0xd1008,0x7d1800,46724,0x880c0,0x760440,41728,0x8c080,29060,0x98c400,11264
.long 0x3e4000,0xb18c00,8,4160
.zero 48
.long 0xa00000,32768,9,0x210000,6364,0x110000,0x110004,0x810000,43136,0x100000,0x700800,45056,0x100000,32768,0xa00000,8192
.long 0x30c000,0xb00000,24,4608
.zero 48
.long 0xa08400,33028,9,0x211000,6332,0x110000,0x110008,0x810800,47232,0x108000,0x700840,45056,0x108000,33028,0xa08400,8192
.long 0x32c000,0xb00800,24,4608
.zero 48
.long 0xa00800,32776,9,0x212000,6300,0x110000,0x111004,0x811000,43140,0x100040,0x720800,45312,0x104000,32896,0xa04000,9216
.long 0x34c000,0xb08400,24,4672
.zero 48
.long 0xa08c00,33036,9,0x213000,6272,0x110000,0x111008,0x811800,47236,0x108040,0x720840,45312,0x10c000,33156,0xa0c400,9216
.long 0x36c000,0xb08c00,24,4672
.zero 48
.long 0xa01000,32784,9,0x250000,6876,0x150000,0x150004,0x850000,43648,0x100080,0x740800,45568,0x100080,32768,0xa00000,10240
.long 0x38c000,0xb10000,24,4096
.zero 48
.long 0xa09400,33044,9,0x251000,6844,0x150000,0x150008,0x850800,47744,0x108080,0x740840,45568,0x108080,33028,0xa08400,10240
.long 0x3ac000,0xb10800,24,4096
.zero 48
.long 0xa01800,32792,9,0x252000,6812,0x150000,0x151004,0x851000,43652,0x1000c0,0x760800,45824,0x104080,32896,0xa04000,11264
.long 0x3cc000,0xb18400,24,4160
.zero 48
.long 0xa09c00,33052,9,0x253000,6784,0x150000,0x151008,0x851800,47748,0x1080c0,0x760840,45824,0x10c080,33156,0xa0c400,11264
.long 0x3ec000,0xb18c00,24,4160
.zero 48
.long 0xa80000,36864,9,0x290000,7388,0x190000,0x190004,0x890000,44160,0x180000,0x700c00,45056,0x180000,36864,0xa80000,8192
.long 0x314000,0xb00000,40,4608
.zero 48
.long 0xa88400,37124,9,0x291000,7356,0x190000,0x190008,0x890800,48256,0x188000,0x700c40,45056,0x188000,37124,0xa88400,8192
.long 0x334000,0xb00800,40,4608
.zero 48
.long 0xa80800,36872,9,0x292000,7324,0x190000,0x191004,0x891000,44164,0x180040,0x720c00,45312,0x184000,36992,0xa84000,9216
.long 0x354000,0xb08400,40,4672
.zero 48
.long 0xa88c00,37132,9,0x293000,7296,0x190000,0x191008,0x891800,48260,0x188040,0x720c40,45312,0x18c000,37252,0xa8c400,9216
.long 0x374000,0xb08c00,40,4672
.zero 48
.long 0xa81000,36880,9,0x2d0000,7900,0x1d0000,0x1d0004,0x8d0000,44672,0x180080,0x740c00,45568,0x180080,36864,0xa80000,10240
.long 0x394000,0xb10000,40,4096
.zero 48
.long 0xa89400,37140,9,0x2d1000,7868,0x1d0000,0x1d0008,0x8d0800,48768,0x188080,0x740c40,45568,0x188080,37124,0xa88400,10240
.long 0x3b4000,0xb10800,40,4096
.zero 48
.long 0xa81800,36888,9,0x2d2000,7836,0x1d0000,0x1d1004,0x8d1000,44676,0x1800c0,0x760c00,45824,0x184080,36992,0xa84000,11264
.long 0x3d4000,0xb18400,40,4160
.zero 48
.long 0xa89c00,37148,9,0x2d3000,7808,0x1d0000,0x1d1008,0x8d1800,48772,0x1880c0,0x760c40,45824,0x18c080,37252,0xa8c400,11264
.long 0x3f4000,0xb18c00,40,4160
.zero 48
.long 0x910000,25088,3,0x110020,4316,73728,73732,0x712000,41096,65536,0x700080,49152,65536,25088,0x910000,8192
.long 0x2fd000,0xb00000,0xfffffffa,4608
.zero 48
.long 0x918400,25348,4,0x111020,4284,73728,73736,0x712800,45192,98304,0x7000c0,49152,98304,25348,0x918400,8192
.long 0x31d000,0xb00800,0xfffffffa,4608
.zero 48
.long 0x910800,25096,3,0x112020,4252,73728,77828,0x713000,41100,65600,0x720080,49408,81920,25216,0x914000,9216
.long 0x33d000,0xb08400,0xfffffffa,4672
.zero 48
.long 0x918c00,25356,4,0x113020,4224,73728,77832,0x713800,45196,98368,0x7200c0,49408,0x1c000,25476,0x91c400,9216
.long 0x35d000,0xb08c00,0xfffffffa,4672
.zero 48
.long 0x911000,25104,3,0x150020,4828,0x52000,0x52004,0x752000,41608,65664,0x740080,49664,65664,25088,0x910000,10240
.long 0x37d000,0xb10000,0xfffffffa,4096
.zero 48
.long 0x919400,25364,4,0x151020,4796,0x52000,0x52008,0x752800,45704,98432,0x7400c0,49664,98432,25348,0x918400,10240
.long 0x39d000,0xb10800,0xfffffffa,4096
.zero 48
.long 0x911800,25112,3,0x152020,4764,0x52000,0x53004,0x753000,41612,65728,0x760080,49920,82048,25216,0x914000,11264
.long 0x3bd000,0xb18400,0xfffffffa,4160
.zero 48
.long 0x919c00,25372,4,0x153020,4736,0x52000,0x53008,0x753800,45708,98496,0x7600c0,49920,0x1c080,25476,0x91c400,11264
.long 0x3dd000,0xb18c00,0xfffffffa,4160
.zero 48
.long 0x990000,29184,9,0x190020,5340,0x92000,0x92004,0x792000,42120,0x90000,0x700480,49152,0x90000,29184,0x990000,8192
.long 0x305000,0xb00000,10,4608
.zero 48
.long 0x998400,29444,9,0x191020,5308,0x92000,0x92008,0x792800,46216,0x98000,0x7004c0,49152,0x98000,29444,0x998400,8192
.long 0x325000,0xb00800,10,4608
.zero 48
.long 0x990800,29192,9,0x192020,5276,0x92000,0x93004,0x793000,42124,0x90040,0x720480,49408,0x94000,29312,0x994000,9216
.long 0x345000,0xb08400,10,4672
.zero 48
.long 0x998c00,29452,9,0x193020,5248,0x92000,0x93008,0x793800,46220,0x98040,0x7204c0,49408,0x9c000,29572,0x99c400,9216
.long 0x365000,0xb08c00,10,4672
.zero 48
.long 0x991000,29200,9,0x1d0020,5852,0xd2000,0xd2004,0x7d2000,42632,0x90080,0x740480,49664,0x90080,29184,0x990000,10240
.long 0x385000,0xb10000,10,4096
.zero 48
.long 0x999400,29460,9,0x1d1020,5820,0xd2000,0xd2008,0x7d2800,46728,0x98080,0x7404c0,49664,0x98080,29444,0x998400,10240
.long 0x3a5000,0xb10800,10,4096
.zero 48
.long 0x991800,29208,9,0x1d2020,5788,0xd2000,0xd3004,0x7d3000,42636,0x900c0,0x760480,49920,0x94080,29312,0x994000,11264
.long 0x3c5000,0xb18400,10,4160
.zero 48
.long 0x999c00,29468,9,0x1d3020,5760,0xd2000,0xd3008,0x7d3800,46732,0x980c0,0x7604c0,49920,0x9c080,29572,0x99c400,11264
.long 0x3e5000,0xb18c00,10,4160
.zero 48
.long 0xa10000,33280,9,0x210020,6364,0x112000,0x112004,0x812000,43144,0x110000,0x700880,53248,0x110000,33280,0xa10000,8192
.long 0x30d000,0xb00000,26,4608
.zero 48
.long 0xa18400,33540,9,0x211020,6332,0x112000,0x112008,0x812800,47240,0x118000,0x7008c0,53248,0x118000,33540,0xa18400,8192
.long 0x32d000,0xb00800,26,4608
.zero 48
.long 0xa10800,33288,9,0x212020,6300,0x112000,0x113004,0x813000,43148,0x110040,0x720880,53504,0x114000,33408,0xa14000,9216
.long 0x34d000,0xb08400,26,4672
.zero 48
.long 0xa18c00,33548,9,0x213020,6272,0x112000,0x113008,0x813800,47244,0x118040,0x7208c0,53504,0x11c000,33668,0xa1c400,9216
.long 0x36d000,0xb08c00,26,4672
.zero 48
.long 0xa11000,33296,9,0x250020,6876,0x152000,0x152004,0x852000,43656,0x110080,0x740880,53760,0x110080,33280,0xa10000,10240
.long 0x38d000,0xb10000,26,4096
.zero 48
.long 0xa19400,33556,9,0x251020,6844,0x152000,0x152008,0x852800,47752,0x118080,0x7408c0,53760,0x118080,33540,0xa18400,10240
.long 0x3ad000,0xb10800,26,4096
.zero 48
.long 0xa11800,33304,9,0x252020,6812,0x152000,0x153004,0x853000,43660,0x1100c0,0x760880,54016,0x114080,33408,0xa14000,11264
.long 0x3cd000,0xb18400,26,4160
.zero 48
.long 0xa19c00,33564,9,0x253020,6784,0x152000,0x153008,0x853800,47756,0x1180c0,0x7608c0,54016,0x11c080,33668,0xa1c400,11264
.long 0x3ed000,0xb18c00,26,4160
.zero 48
.long 0xa90000,37376,9,0x290020,7388,0x192000,0x192004,0x892000,44168,0x190000,0x700c80,53248,0x190000,37376,0xa90000,8192
.long 0x315000,0xb00000,42,4608
.zero 48
.long 0xa98400,37636,9,0x291020,7356,0x192000,0x192008,0x892800,48264,0x198000,0x700cc0,53248,0x198000,37636,0xa98400,8192
.long 0x335000,0xb00800,42,4608
.zero 48
.long 0xa90800,37384,9,0x292020,7324,0x192000,0x193004,0x893000,44172,0x190040,0x720c80,53504,0x194000,37504,0xa94000,9216
.long 0x355000,0xb08400,42,4672
.zero 48
.long 0xa98c00,37644,9,0x293020,7296,0x192000,0x193008,0x893800,48268,0x198040,0x720cc0,53504,0x19c000,37764,0xa9c400,9216
.long 0x375000,0xb08c00,42,4672
.zero 48
.long 0xa91000,37392,9,0x2d0020,7900,0x1d2000,0x1d2004,0x8d2000,44680,0x190080,0x740c80,53760,0x190080,37376,0xa90000,10240
.long 0x395000,0xb10000,42,4096
.zero 48
.long 0xa99400,37652,9,0x2d1020,7868,0x1d2000,0x1d2008,0x8d2800,48776,0x198080,0x740cc0,53760,0x198080,37636,0xa98400,10240
.long 0x3b5000,0xb10800,42,4096
.zero 48
.long 0xa91800,37400,9,0x2d2020,7836,0x1d2000,0x1d3004,0x8d3000,44684,0x1900c0,0x760c80,54016,0x194080,37504,0xa94000,11264
.long 0x3d5000,0xb18400,42,4160
.zero 48
.long 0xa99c00,37660,9,0x2d3020,7808,0x1d2000,0x1d3008,0x8d3800,48780,0x1980c0,0x760cc0,54016,0x19c080,37764,0xa9c400,11264
.long 0x3f5000,0xb18c00,42,4160
.zero 48
.long 0x920000,25600,5,0x114000,4316,81920,81924,0x714000,41104,0x20000,0x700100,57344,0x20000,25600,0x920000,8192
.long 0x2fe000,0xb00000,0xfffffffc,4608
.zero 48
.long 0x928400,25860,6,0x115000,4284,81920,81928,0x714800,45200,0x28000,0x700140,57344,0x28000,25860,0x928400,8192
.long 0x31e000,0xb00800,0xfffffffc,4608
.zero 48
.long 0x920800,25608,5,0x116000,4252,81920,86020,0x715000,41108,0x20040,0x720100,57600,0x24000,25728,0x924000,9216
.long 0x33e000,0xb08400,0xfffffffc,4672
.zero 48
.long 0x928c00,25868,6,0x117000,4224,81920,86024,0x715800,45204,0x28040,0x720140,57600,0x2c000,25988,0x92c400,9216
.long 0x35e000,0xb08c00,0xfffffffc,4672
.zero 48
.long 0x921000,25616,5,0x154000,4828,0x54000,0x54004,0x754000,41616,0x20080,0x740100,57856,0x20080,25600,0x920000,10240
.long 0x37e000,0xb10000,0xfffffffc,4096
.zero 48
.long 0x929400,25876,6,0x155000,4796,0x54000,0x54008,0x754800,45712,0x28080,0x740140,57856,0x28080,25860,0x928400,10240
.long 0x39e000,0xb10800,0xfffffffc,4096
.zero 48
.long 0x921800,25624,5,0x156000,4764,0x54000,0x55004,0x755000,41620,0x200c0,0x760100,58112,0x24080,25728,0x924000,11264
.long 0x3be000,0xb18400,0xfffffffc,4160
.zero 48
.long 0x929c00,25884,6,0x157000,4736,0x54000,0x55008,0x755800,45716,0x280c0,0x760140,58112,0x2c080,25988,0x92c400,11264
.long 0x3de000,0xb18c00,0xfffffffc,4160
.zero 48
.long 0x9a0000,29696,9,0x194000,5340,0x94000,0x94004,0x794000,42128,0xa0000,0x700500,57344,0xa0000,29696,0x9a0000,8192
.long 0x306000,0xb00000,12,4608
.zero 48
.long 0x9a8400,29956,9,0x195000,5308,0x94000,0x94008,0x794800,46224,0xa8000,0x700540,57344,0xa8000,29956,0x9a8400,8192
.long 0x326000,0xb00800,12,4608
.zero 48
.long 0x9a0800,29704,9,0x196000,5276,0x94000,0x95004,0x795000,42132,0xa0040,0x720500,57600,0xa4000,29824,0x9a4000,9216
.long 0x346000,0xb08400,12,4672
.zero 48
.long 0x9a8c00,29964,9,0x197000,5248,0x94000,0x95008,0x795800,46228,0xa8040,0x720540,57600,0xac000,30084,0x9ac400,9216
.long 0x366000,0xb08c00,12,4672
.zero 48
.long 0x9a1000,29712,9,0x1d4000,5852,0xd4000,0xd4004,0x7d4000,42640,0xa0080,0x740500,57856,0xa0080,29696,0x9a0000,10240
.long 0x386000,0xb10000,12,4096
.zero 48
.long 0x9a9400,29972,9,0x1d5000,5820,0xd4000,0xd4008,0x7d4800,46736,0xa8080,0x740540,57856,0xa8080,29956,0x9a8400,10240
.long 0x3a6000,0xb10800,12,4096
.zero 48
.long 0x9a1800,29720,9,0x1d6000,5788,0xd4000,0xd5004,0x7d5000,42644,0xa00c0,0x760500,58112,0xa4080,29824,0x9a4000,11264
.long 0x3c6000,0xb18400,12,4160
.zero 48
.long 0x9a9c00,29980,9,0x1d7000,5760,0xd4000,0xd5008,0x7d5800,46740,0xa80c0,0x760540,58112,0xac080,30084,0x9ac400,11264
.long 0x3e6000,0xb18c00,12,4160
.zero 48
.long 0xa20000,33792,9,0x214000,6364,0x114000,0x114004,0x814000,43152,0x120000,0x700900,61440,0x120000,33792,0xa20000,8192
.long 0x30e000,0xb00000,28,4608
.zero 48
.long 0xa28400,34052,9,0x215000,6332,0x114000,0x114008,0x814800,47248,0x128000,0x700940,61440,0x128000,34052,0xa28400,8192
.long 0x32e000,0xb00800,28,4608
.zero 48
.long 0xa20800,33800,9,0x216000,6300,0x114000,0x115004,0x815000,43156,0x120040,0x720900,61696,0x124000,33920,0xa24000,9216
.long 0x34e000,0xb08400,28,4672
.zero 48
.long 0xa28c00,34060,9,0x217000,6272,0x114000,0x115008,0x815800,47252,0x128040,0x720940,61696,0x12c000,34180,0xa2c400,9216
.long 0x36e000,0xb08c00,28,4672
.zero 48
.long 0xa21000,33808,9,0x254000,6876,0x154000,0x154004,0x854000,43664,0x120080,0x740900,61952,0x120080,33792,0xa20000,10240
.long 0x38e000,0xb10000,28,4096
.zero 48
.long 0xa29400,34068,9,0x255000,6844,0x154000,0x154008,0x854800,47760,0x128080,0x740940,61952,0x128080,34052,0xa28400,10240
.long 0x3ae000,0xb10800,28,4096
.zero 48
.long 0xa21800,33816,9,0x256000,6812,0x154000,0x155004,0x855000,43668,0x1200c0,0x760900,62208,0x124080,33920,0xa24000,11264
.long 0x3ce000,0xb18400,28,4160
.zero 48
.long 0xa29c00,34076,9,0x257000,6784,0x154000,0x155008,0x855800,47764,0x1280c0,0x760940,62208,0x12c080,34180,0xa2c400,11264
.long 0x3ee000,0xb18c00,28,4160
.zero 48
.long 0xaa0000,37888,9,0x294000,7388,0x194000,0x194004,0x894000,44176,0x1a0000,0x700d00,61440,0x1a0000,37888,0xaa0000,8192
.long 0x316000,0xb00000,44,4608
.zero 48
.long 0xaa8400,38148,9,0x295000,7356,0x194000,0x194008,0x894800,48272,0x1a8000,0x700d40,61440,0x1a8000,38148,0xaa8400,8192
.long 0x336000,0xb00800,44,4608
.zero 48
.long 0xaa0800,37896,9,0x296000,7324,0x194000,0x195004,0x895000,44180,0x1a0040,0x720d00,61696,0x1a4000,38016,0xaa4000,9216
.long 0x356000,0xb08400,44,4672
.zero 48
.long 0xaa8c00,38156,9,0x297000,7296,0x194000,0x195008,0x895800,48276,0x1a8040,0x720d40,61696,0x1ac000,38276,0xaac400,9216
.long 0x376000,0xb08c00,44,4672
.zero 48
.long 0xaa1000,37904,9,0x2d4000,7900,0x1d4000,0x1d4004,0x8d4000,44688,0x1a0080,0x740d00,61952,0x1a0080,37888,0xaa0000,10240
.long 0x396000,0xb10000,44,4096
.zero 48
.long 0xaa9400,38164,9,0x2d5000,7868,0x1d4000,0x1d4008,0x8d4800,48784,0x1a8080,0x740d40,61952,0x1a8080,38148,0xaa8400,10240
.long 0x3b6000,0xb10800,44,4096
.zero 48
.long 0xaa1800,37912,9,0x2d6000,7836,0x1d4000,0x1d5004,0x8d5000,44692,0x1a00c0,0x760d00,62208,0x1a4080,38016,0xaa4000,11264
.long 0x3d6000,0xb18400,44,4160
.zero 48
.long 0xaa9c00,38172,9,0x2d7000,7808,0x1d4000,0x1d5008,0x8d5800,48788,0x1a80c0,0x760d40,62208,0x1ac080,38276,0xaac400,11264
.long 0x3f6000,0xb18c00,44,4160
.zero 48
.long 0x930000,26112,7,0x114020,4316,90112,90116,0x716000,41112,0x30000,0x700180,65536,0x30000,26112,0x930000,8192
.long 0x2ff000,0xb00000,0xfffffffe,4608
.zero 48
.long 0x938400,26372,8,0x115020,4284,90112,90120,0x716800,45208,0x38000,0x7001c0,65536,0x38000,26372,0x938400,8192
.long 0x31f000,0xb00800,0xfffffffe,4608
.zero 48
.long 0x930800,26120,7,0x116020,4252,90112,94212,0x717000,41116,0x30040,0x720180,65792,0x34000,26240,0x934000,9216
.long 0x33f000,0xb08400,0xfffffffe,4672
.zero 48
.long 0x938c00,26380,8,0x117020,4224,90112,94216,0x717800,45212,0x38040,0x7201c0,65792,0x3c000,26500,0x93c400,9216
.long 0x35f000,0xb08c00,0xfffffffe,4672
.zero 48
.long 0x931000,26128,7,0x154020,4828,0x56000,0x56004,0x756000,41624,0x30080,0x740180,66048,0x30080,26112,0x930000,10240
.long 0x37f000,0xb10000,0xfffffffe,4096
.zero 48
.long 0x939400,26388,8,0x155020,4796,0x56000,0x56008,0x756800,45720,0x38080,0x7401c0,66048,0x38080,26372,0x938400,10240
.long 0x39f000,0xb10800,0xfffffffe,4096
.zero 48
.long 0x931800,26136,7,0x156020,4764,0x56000,0x57004,0x757000,41628,0x300c0,0x760180,66304,0x34080,26240,0x934000,11264
.long 0x3bf000,0xb18400,0xfffffffe,4160
.zero 48
.long 0x939c00,26396,8,0x157020,4736,0x56000,0x57008,0x757800,45724,0x380c0,0x7601c0,66304,0x3c080,26500,0x93c400,11264
.long 0x3df000,0xb18c00,0xfffffffe,4160
.zero 48
.long 0x9b0000,30208,9,0x194020,5340,0x96000,0x96004,0x796000,42136,0xb0000,0x700580,65536,0xb0000,30208,0x9b0000,8192
.long 0x307000,0xb00000,14,4608
.zero 48
.long 0x9b8400,30468,9,0x195020,5308,0x96000,0x96008,0x796800,46232,0xb8000,0x7005c0,65536,0xb8000,30468,0x9b8400,8192
.long 0x327000,0xb00800,14,4608
.zero 48
.long 0x9b0800,30216,9,0x196020,5276,0x96000,0x97004,0x797000,42140,0xb0040,0x720580,65792,0xb4000,30336,0x9b4000,9216
.long 0x347000,0xb08400,14,4672
.zero 48
.long 0x9b8c00,30476,9,0x197020,5248,0x96000,0x97008,0x797800,46236,0xb8040,0x7205c0,65792,0xbc000,30596,0x9bc400,9216
.long 0x367000,0xb08c00,14,4672
.zero 48
.long 0x9b1000,30224,9,0x1d4020,5852,0xd6000,0xd6004,0x7d6000,42648,0xb0080,0x740580,66048,0xb0080,30208,0x9b0000,10240
.long 0x387000,0xb10000,14,4096
.zero 48
.long 0x9b9400,30484,9,0x1d5020,5820,0xd6000,0xd6008,0x7d6800,46744,0xb8080,0x7405c0,66048,0xb8080,30468,0x9b8400,10240
.long 0x3a7000,0xb10800,14,4096
.zero 48
.long 0x9b1800,30232,9,0x1d6020,5788,0xd6000,0xd7004,0x7d7000,42652,0xb00c0,0x760580,66304,0xb4080,30336,0x9b4000,11264
.long 0x3c7000,0xb18400,14,4160
.zero 48
.long 0x9b9c00,30492,9,0x1d7020,5760,0xd6000,0xd7008,0x7d7800,46748,0xb80c0,0x7605c0,66304,0xbc080,30596,0x9bc400,11264
.long 0x3e7000,0xb18c00,14,4160
.zero 48
.long 0xa30000,34304,9,0x214020,6364,0x116000,0x116004,0x816000,43160,0x130000,0x700980,69632,0x130000,34304,0xa30000,8192
.long 0x30f000,0xb00000,30,4608
.zero 48
.long 0xa38400,34564,9,0x215020,6332,0x116000,0x116008,0x816800,47256,0x138000,0x7009c0,69632,0x138000,34564,0xa38400,8192
.long 0x32f000,0xb00800,30,4608
.zero 48
.long 0xa30800,34312,9,0x216020,6300,0x116000,0x117004,0x817000,43164,0x130040,0x720980,69888,0x134000,34432,0xa34000,9216
.long 0x34f000,0xb08400,30,4672
.zero 48
.long 0xa38c00,34572,9,0x217020,6272,0x116000,0x117008,0x817800,47260,0x138040,0x7209c0,69888,0x13c000,34692,0xa3c400,9216
.long 0x36f000,0xb08c00,30,4672
.zero 48
.long 0xa31000,34320,9,0x254020,6876,0x156000,0x156004,0x856000,43672,0x130080,0x740980,70144,0x130080,34304,0xa30000,10240
.long 0x38f000,0xb10000,30,4096
.zero 48
.long 0xa39400,34580,9,0x255020,6844,0x156000,0x156008,0x856800,47768,0x138080,0x7409c0,70144,0x138080,34564,0xa38400,10240
.long 0x3af000,0xb10800,30,4096
.zero 48
.long 0xa31800,34328,9,0x256020,6812,0x156000,0x157004,0x857000,43676,0x1300c0,0x760980,70400,0x134080,34432,0xa34000,11264
.long 0x3cf000,0xb18400,30,4160
.zero 48
.long 0xa39c00,34588,9,0x257020,6784,0x156000,0x157008,0x857800,47772,0x1380c0,0x7609c0,70400,0x13c080,34692,0xa3c400,11264
.long 0x3ef000,0xb18c00,30,4160
.zero 48
.long 0xab0000,38400,9,0x294020,7388,0x196000,0x196004,0x896000,44184,0x1b0000,0x700d80,69632,0x1b0000,38400,0xab0000,8192
.long 0x317000,0xb00000,46,4608
.zero 48
.long 0xab8400,38660,9,0x295020,7356,0x196000,0x196008,0x896800,48280,0x1b8000,0x700dc0,69632,0x1b8000,38660,0xab8400,8192
.long 0x337000,0xb00800,46,4608
.zero 48
.long 0xab0800,38408,9,0x296020,7324,0x196000,0x197004,0x897000,44188,0x1b0040,0x720d80,69888,0x1b4000,38528,0xab4000,9216
.long 0x357000,0xb08400,46,4672
.zero 48
.long 0xab8c00,38668,9,0x297020,7296,0x196000,0x197008,0x897800,48284,0x1b8040,0x720dc0,69888,0x1bc000,38788,0xabc400,9216
.long 0x377000,0xb08c00,46,4672
.zero 48
.long 0xab1000,38416,9,0x2d4020,7900,0x1d6000,0x1d6004,0x8d6000,44696,0x1b0080,0x740d80,70144,0x1b0080,38400,0xab0000,10240
.long 0x397000,0xb10000,46,4096
.zero 48
.long 0xab9400,38676,9,0x2d5020,7868,0x1d6000,0x1d6008,0x8d6800,48792,0x1b8080,0x740dc0,70144,0x1b8080,38660,0xab8400,10240
.long 0x3b7000,0xb10800,46,4096
.zero 48
.long 0xab1800,38424,9,0x2d6020,7836,0x1d6000,0x1d7004,0x8d7000,44700,0x1b00c0,0x760d80,70400,0x1b4080,38528,0xab4000,11264
.long 0x3d7000,0xb18400,46,4160
.zero 48
.long 0xab9c00,38684,9,0x2d7020,7808,0x1d6000,0x1d7008,0x8d7800,48796,0x1b80c0,0x760dc0,70400,0x1bc080,38788,0xabc400,11264
.long 0x3f7000,0xb18c00,46,4160
.zero 48
.long 0x940000,26624,9,0x118000,4316,98304,98308,0x718000,41120,0x40000,0x700200,40960,0x40000,26624,0x940000,8192
.long 0x300000,0xb00000,0,4608
.zero 48
.long 0x948400,26884,9,0x119000,4284,98304,98312,0x718800,45216,0x48000,0x700240,40960,0x48000,26884,0x948400,8192
.long 0x320000,0xb00800,0,4608
.zero 48
.long 0x940800,26632,9,0x11a000,4252,98304,0x19004,0x719000,41124,0x40040,0x720200,41216,0x44000,26752,0x944000,9216
.long 0x340000,0xb08400,0,4672
.zero 48
.long 0x948c00,26892,9,0x11b000,4224,98304,0x19008,0x719800,45220,0x48040,0x720240,41216,0x4c000,27012,0x94c400,9216
.long 0x360000,0xb08c00,0,4672
.zero 48
.long 0x941000,26640,9,0x158000,4828,0x58000,0x58004,0x758000,41632,0x40080,0x740200,41472,0x40080,26624,0x940000,10240
.long 0x380000,0xb10000,0,4096
.zero 48
.long 0x949400,26900,9,0x159000,4796,0x58000,0x58008,0x758800,45728,0x48080,0x740240,41472,0x48080,26884,0x948400,10240
.long 0x3a0000,0xb10800,0,4096
.zero 48
.long 0x941800,26648,9,0x15a000,4764,0x58000,0x59004,0x759000,41636,0x400c0,0x760200,41728,0x44080,26752,0x944000,11264
.long 0x3c0000,0xb18400,0,4160
.zero 48
.long 0x949c00,26908,9,0x15b000,4736,0x58000,0x59008,0x759800,45732,0x480c0,0x760240,41728,0x4c080,27012,0x94c400,11264
.long 0x3e0000,0xb18c00,0,4160
.zero 48
.long 0x9c0000,30720,9,0x198000,5340,0x98000,0x98004,0x798000,42144,0xc0000,0x700600,40960,0xc0000,30720,0x9c0000,8192
.long 0x308000,0xb00000,16,4608
.zero 48
.long 0x9c8400,30980,9,0x199000,5308,0x98000,0x98008,0x798800,46240,0xc8000,0x700640,40960,0xc8000,30980,0x9c8400,8192
.long 0x328000,0xb00800,16,4608
.zero 48
.long 0x9c0800,30728,9,0x19a000,5276,0x98000,0x99004,0x799000,42148,0xc0040,0x720600,41216,0xc4000,30848,0x9c4000,9216
.long 0x348000,0xb08400,16,4672
.zero 48
.long 0x9c8c00,30988,9,0x19b000,5248,0x98000,0x99008,0x799800,46244,0xc8040,0x720640,41216,0xcc000,31108,0x9cc400,9216
.long 0x368000,0xb08c00,16,4672
.zero 48
.long 0x9c1000,30736,9,0x1d8000,5852,0xd8000,0xd8004,0x7d8000,42656,0xc0080,0x740600,41472,0xc0080,30720,0x9c0000,10240
.long 0x388000,0xb10000,16,4096
.zero 48
.long 0x9c9400,30996,9,0x1d9000,5820,0xd8000,0xd8008,0x7d8800,46752,0xc8080,0x740640,41472,0xc8080,30980,0x9c8400,10240
.long 0x3a8000,0xb10800,16,4096
.zero 48
.long 0x9c1800,30744,9,0x1da000,5788,0xd8000,0xd9004,0x7d9000,42660,0xc00c0,0x760600,41728,0xc4080,30848,0x9c4000,11264
.long 0x3c8000,0xb18400,16,4160
.zero 48
.long 0x9c9c00,31004,9,0x1db000,5760,0xd8000,0xd9008,0x7d9800,46756,0xc80c0,0x760640,41728,0xcc080,31108,0x9cc400,11264
.long 0x3e8000,0xb18c00,16,4160
.zero 48
.long 0xa40000,34816,9,0x218000,6364,0x118000,0x118004,0x818000,43168,0x140000,0x700a00,45056,0x140000,34816,0xa40000,8192
.long 0x310000,0xb00000,32,4608
.zero 48
.long 0xa48400,35076,9,0x219000,6332,0x118000,0x118008,0x818800,47264,0x148000,0x700a40,45056,0x148000,35076,0xa48400,8192
.long 0x330000,0xb00800,32,4608
.zero 48
.long 0xa40800,34824,9,0x21a000,6300,0x118000,0x119004,0x819000,43172,0x140040,0x720a00,45312,0x144000,34944,0xa44000,9216
.long 0x350000,0xb08400,32,4672
.zero 48
.long 0xa48c00,35084,9,0x21b000,6272,0x118000,0x119008,0x819800,47268,0x148040,0x720a40,45312,0x14c000,35204,0xa4c400,9216
.long 0x370000,0xb08c00,32,4672
.zero 48
.long 0xa41000,34832,9,0x258000,6876,0x158000,0x158004,0x858000,43680,0x140080,0x740a00,45568,0x140080,34816,0xa40000,10240
.long 0x390000,0xb10000,32,4096
.zero 48
.long 0xa49400,35092,9,0x259000,6844,0x158000,0x158008,0x858800,47776,0x148080,0x740a40,45568,0x148080,35076,0xa48400,10240
.long 0x3b0000,0xb10800,32,4096
.zero 48
.long 0xa41800,34840,9,0x25a000,6812,0x158000,0x159004,0x859000,43684,0x1400c0,0x760a00,45824,0x144080,34944,0xa44000,11264
.long 0x3d0000,0xb18400,32,4160
.zero 48
.long 0xa49c00,35100,9,0x25b000,6784,0x158000,0x159008,0x859800,47780,0x1480c0,0x760a40,45824,0x14c080,35204,0xa4c400,11264
.long 0x3f0000,0xb18c00,32,4160
.zero 48
.long 0xac0000,38912,9,0x298000,7388,0x198000,0x198004,0x898000,44192,0x1c0000,0x700e00,45056,0x1c0000,38912,0xac0000,8192
.long 0x318000,0xb00000,48,4608
.zero 48
.long 0xac8400,39172,9,0x299000,7356,0x198000,0x198008,0x898800,48288,0x1c8000,0x700e40,45056,0x1c8000,39172,0xac8400,8192
.long 0x338000,0xb00800,48,4608
.zero 48
.long 0xac0800,38920,9,0x29a000,7324,0x198000,0x199004,0x899000,44196,0x1c0040,0x720e00,45312,0x1c4000,39040,0xac4000,9216
.long 0x358000,0xb08400,48,4672
.zero 48
.long 0xac8c00,39180,9,0x29b000,7296,0x198000,0x199008,0x899800,48292,0x1c8040,0x720e40,45312,0x1cc000,39300,0xacc400,9216
.long 0x378000,0xb08c00,48,4672
.zero 48
.long 0xac1000,38928,9,0x2d8000,7900,0x1d8000,0x1d8004,0x8d8000,44704,0x1c0080,0x740e00,45568,0x1c0080,38912,0xac0000,10240
.long 0x398000,0xb10000,48,4096
.zero 48
.long 0xac9400,39188,9,0x2d9000,7868,0x1d8000,0x1d8008,0x8d8800,48800,0x1c8080,0x740e40,45568,0x1c8080,39172,0xac8400,10240
.long 0x3b8000,0xb10800,48,4096
.zero 48
.long 0xac1800,38936,9,0x2da000,7836,0x1d8000,0x1d9004,0x8d9000,44708,0x1c00c0,0x760e00,45824,0x1c4080,39040,0xac4000,11264
.long 0x3d8000,0xb18400,48,4160
.zero 48
.long 0xac9c00,39196,9,0x2db000,7808,0x1d8000,0x1d9008,0x8d9800,48804,0x1c80c0,0x760e40,45824,0x1cc080,39300,0xacc400,11264
.long 0x3f8000,0xb18c00,48,4160
.zero 48
.long 0x950000,27136,9,0x118020,4316,0x1a000,0x1a004,0x71a000,41128,0x50000,0x700280,49152,0x50000,27136,0x950000,8192
.long 0x301000,0xb00000,2,4608
.zero 48
.long 0x958400,27396,9,0x119020,4284,0x1a000,0x1a008,0x71a800,45224,0x58000,0x7002c0,49152,0x58000,27396,0x958400,8192
.long 0x321000,0xb00800,2,4608
.zero 48
.long 0x950800,27144,9,0x11a020,4252,0x1a000,0x1b004,0x71b000,41132,0x50040,0x720280,49408,0x54000,27264,0x954000,9216
.long 0x341000,0xb08400,2,4672
.zero 48
.long 0x958c00,27404,9,0x11b020,4224,0x1a000,0x1b008,0x71b800,45228,0x58040,0x7202c0,49408,0x5c000,27524,0x95c400,9216
.long 0x361000,0xb08c00,2,4672
.zero 48
.long 0x951000,27152,9,0x158020,4828,0x5a000,0x5a004,0x75a000,41640,0x50080,0x740280,49664,0x50080,27136,0x950000,10240
.long 0x381000,0xb10000,2,4096
.zero 48
.long 0x959400,27412,9,0x159020,4796,0x5a000,0x5a008,0x75a800,45736,0x58080,0x7402c0,49664,0x58080,27396,0x958400,10240
.long 0x3a1000,0xb10800,2,4096
.zero 48
.long 0x951800,27160,9,0x15a020,4764,0x5a000,0x5b004,0x75b000,41644,0x500c0,0x760280,49920,0x54080,27264,0x954000,11264
.long 0x3c1000,0xb18400,2,4160
.zero 48
.long 0x959c00,27420,9,0x15b020,4736,0x5a000,0x5b008,0x75b800,45740,0x580c0,0x7602c0,49920,0x5c080,27524,0x95c400,11264
.long 0x3e1000,0xb18c00,2,4160
.zero 48
.long 0x9d0000,31232,9,0x198020,5340,0x9a000,0x9a004,0x79a000,42152,0xd0000,0x700680,49152,0xd0000,31232,0x9d0000,8192
.long 0x309000,0xb00000,18,4608
.zero 48
.long 0x9d8400,31492,9,0x199020,5308,0x9a000,0x9a008,0x79a800,46248,0xd8000,0x7006c0,49152,0xd8000,31492,0x9d8400,8192
.long 0x329000,0xb00800,18,4608
.zero 48
.long 0x9d0800,31240,9,0x19a020,5276,0x9a000,0x9b004,0x79b000,42156,0xd0040,0x720680,49408,0xd4000,31360,0x9d4000,9216
.long 0x349000,0xb08400,18,4672
.zero 48
.long 0x9d8c00,31500,9,0x19b020,5248,0x9a000,0x9b008,0x79b800,46252,0xd8040,0x7206c0,49408,0xdc000,31620,0x9dc400,9216
.long 0x369000,0xb08c00,18,4672
.zero 48
.long 0x9d1000,31248,9,0x1d8020,5852,0xda000,0xda004,0x7da000,42664,0xd0080,0x740680,49664,0xd0080,31232,0x9d0000,10240
.long 0x389000,0xb10000,18,4096
.zero 48
.long 0x9d9400,31508,9,0x1d9020,5820,0xda000,0xda008,0x7da800,46760,0xd8080,0x7406c0,49664,0xd8080,31492,0x9d8400,10240
.long 0x3a9000,0xb10800,18,4096
.zero 48
.long 0x9d1800,31256,9,0x1da020,5788,0xda000,0xdb004,0x7db000,42668,0xd00c0,0x760680,49920,0xd4080,31360,0x9d4000,11264
.long 0x3c9000,0xb18400,18,4160
.zero 48
.long 0x9d9c00,31516,9,0x1db020,5760,0xda000,0xdb008,0x7db800,46764,0xd80c0,0x7606c0,49920,0xdc080,31620,0x9dc400,11264
.long 0x3e9000,0xb18c00,18,4160
.zero 48
.long 0xa50000,35328,9,0x218020,6364,0x11a000,0x11a004,0x81a000,43176,0x150000,0x700a80,53248,0x150000,35328,0xa50000,8192
.long 0x311000,0xb00000,34,4608
.zero 48
.long 0xa58400,35588,9,0x219020,6332,0x11a000,0x11a008,0x81a800,47272,0x158000,0x700ac0,53248,0x158000,35588,0xa58400,8192
.long 0x331000,0xb00800,34,4608
.zero 48
.long 0xa50800,35336,9,0x21a020,6300,0x11a000,0x11b004,0x81b000,43180,0x150040,0x720a80,53504,0x154000,35456,0xa54000,9216
.long 0x351000,0xb08400,34,4672
.zero 48
.long 0xa58c00,35596,9,0x21b020,6272,0x11a000,0x11b008,0x81b800,47276,0x158040,0x720ac0,53504,0x15c000,35716,0xa5c400,9216
.long 0x371000,0xb08c00,34,4672
.zero 48
.long 0xa51000,35344,9,0x258020,6876,0x15a000,0x15a004,0x85a000,43688,0x150080,0x740a80,53760,0x150080,35328,0xa50000,10240
.long 0x391000,0xb10000,34,4096
.zero 48
.long 0xa59400,35604,9,0x259020,6844,0x15a000,0x15a008,0x85a800,47784,0x158080,0x740ac0,53760,0x158080,35588,0xa58400,10240
.long 0x3b1000,0xb10800,34,4096
.zero 48
.long 0xa51800,35352,9,0x25a020,6812,0x15a000,0x15b004,0x85b000,43692,0x1500c0,0x760a80,54016,0x154080,35456,0xa54000,11264
.long 0x3d1000,0xb18400,34,4160
.zero 48
.long 0xa59c00,35612,9,0x25b020,6784,0x15a000,0x15b008,0x85b800,47788,0x1580c0,0x760ac0,54016,0x15c080,35716,0xa5c400,11264
.long 0x3f1000,0xb18c00,34,4160
.zero 48
.long 0xad0000,39424,9,0x298020,7388,0x19a000,0x19a004,0x89a000,44200,0x1d0000,0x700e80,53248,0x1d0000,39424,0xad0000,8192
.long 0x319000,0xb00000,50,4608
.zero 48
.long 0xad8400,39684,9,0x299020,7356,0x19a000,0x19a008,0x89a800,48296,0x1d8000,0x700ec0,53248,0x1d8000,39684,0xad8400,8192
.long 0x339000,0xb00800,50,4608
.zero 48
.long 0xad0800,39432,9,0x29a020,7324,0x19a000,0x19b004,0x89b000,44204,0x1d0040,0x720e80,53504,0x1d4000,39552,0xad4000,9216
.long 0x359000,0xb08400,50,4672
.zero 48
.long 0xad8c00,39692,9,0x29b020,7296,0x19a000,0x19b008,0x89b800,48300,0x1d8040,0x720ec0,53504,0x1dc000,39812,0xadc400,9216
.long 0x379000,0xb08c00,50,4672
.zero 48
.long 0xad1000,39440,9,0x2d8020,7900,0x1da000,0x1da004,0x8da000,44712,0x1d0080,0x740e80,53760,0x1d0080,39424,0xad0000,10240
.long 0x399000,0xb10000,50,4096
.zero 48
.long 0xad9400,39700,9,0x2d9020,7868,0x1da000,0x1da008,0x8da800,48808,0x1d8080,0x740ec0,53760,0x1d8080,39684,0xad8400,10240
.long 0x3b9000,0xb10800,50,4096
.zero 48
.long 0xad1800,39448,9,0x2da020,7836,0x1da000,0x1db004,0x8db000,44716,0x1d00c0,0x760e80,54016,0x1d4080,39552,0xad4000,11264
.long 0x3d9000,0xb18400,50,4160
.zero 48
.long 0xad9c00,39708,9,0x2db020,7808,0x1da000,0x1db008,0x8db800,48812,0x1d80c0,0x760ec0,54016,0x1dc080,39812,0xadc400,11264
.long 0x3f9000,0xb18c00,50,4160
.zero 48
.long 0x960000,27648,9,0x11c000,4316,0x1c000,0x1c004,0x71c000,41136,0x60000,0x700300,57344,0x60000,27648,0x960000,8192
.long 0x302000,0xb00000,4,4608
.zero 48
.long 0x968400,27908,9,0x11d000,4284,0x1c000,0x1c008,0x71c800,45232,0x68000,0x700340,57344,0x68000,27908,0x968400,8192
.long 0x322000,0xb00800,4,4608
.zero 48
.long 0x960800,27656,9,0x11e000,4252,0x1c000,0x1d004,0x71d000,41140,0x60040,0x720300,57600,0x64000,27776,0x964000,9216
.long 0x342000,0xb08400,4,4672
.zero 48
.long 0x968c00,27916,9,0x11f000,4224,0x1c000,0x1d008,0x71d800,45236,0x68040,0x720340,57600,0x6c000,28036,0x96c400,9216
.long 0x362000,0xb08c00,4,4672
.zero 48
.long 0x961000,27664,9,0x15c000,4828,0x5c000,0x5c004,0x75c000,41648,0x60080,0x740300,57856,0x60080,27648,0x960000,10240
.long 0x382000,0xb10000,4,4096
.zero 48
.long 0x969400,27924,9,0x15d000,4796,0x5c000,0x5c008,0x75c800,45744,0x68080,0x740340,57856,0x68080,27908,0x968400,10240
.long 0x3a2000,0xb10800,4,4096
.zero 48
.long 0x961800,27672,9,0x15e000,4764,0x5c000,0x5d004,0x75d000,41652,0x600c0,0x760300,58112,0x64080,27776,0x964000,11264
.long 0x3c2000,0xb18400,4,4160
.zero 48
.long 0x969c00,27932,9,0x15f000,4736,0x5c000,0x5d008,0x75d800,45748,0x680c0,0x760340,58112,0x6c080,28036,0x96c400,11264
.long 0x3e2000,0xb18c00,4,4160
.zero 48
.long 0x9e0000,31744,9,0x19c000,5340,0x9c000,0x9c004,0x79c000,42160,0xe0000,0x700700,57344,0xe0000,31744,0x9e0000,8192
.long 0x30a000,0xb00000,20,4608
.zero 48
.long 0x9e8400,32004,9,0x19d000,5308,0x9c000,0x9c008,0x79c800,46256,0xe8000,0x700740,57344,0xe8000,32004,0x9e8400,8192
.long 0x32a000,0xb00800,20,4608
.zero 48
.long 0x9e0800,31752,9,0x19e000,5276,0x9c000,0x9d004,0x79d000,42164,0xe0040,0x720700,57600,0xe4000,31872,0x9e4000,9216
.long 0x34a000,0xb08400,20,4672
.zero 48
.long 0x9e8c00,32012,9,0x19f000,5248,0x9c000,0x9d008,0x79d800,46260,0xe8040,0x720740,57600,0xec000,32132,0x9ec400,9216
.long 0x36a000,0xb08c00,20,4672
.zero 48
.long 0x9e1000,31760,9,0x1dc000,5852,0xdc000,0xdc004,0x7dc000,42672,0xe0080,0x740700,57856,0xe0080,31744,0x9e0000,10240
.long 0x38a000,0xb10000,20,4096
.zero 48
.long 0x9e9400,32020,9,0x1dd000,5820,0xdc000,0xdc008,0x7dc800,46768,0xe8080,0x740740,57856,0xe8080,32004,0x9e8400,10240
.long 0x3aa000,0xb10800,20,4096
.zero 48
.long 0x9e1800,31768,9,0x1de000,5788,0xdc000,0xdd004,0x7dd000,42676,0xe00c0,0x760700,58112,0xe4080,31872,0x9e4000,11264
.long 0x3ca000,0xb18400,20,4160
.zero 48
.long 0x9e9c00,32028,9,0x1df000,5760,0xdc000,0xdd008,0x7dd800,46772,0xe80c0,0x760740,58112,0xec080,32132,0x9ec400,11264
.long 0x3ea000,0xb18c00,20,4160
.zero 48
.long 0xa60000,35840,9,0x21c000,6364,0x11c000,0x11c004,0x81c000,43184,0x160000,0x700b00,61440,0x160000,35840,0xa60000,8192
.long 0x312000,0xb00000,36,4608
.zero 48
.long 0xa68400,36100,9,0x21d000,6332,0x11c000,0x11c008,0x81c800,47280,0x168000,0x700b40,61440,0x168000,36100,0xa68400,8192
.long 0x332000,0xb00800,36,4608
.zero 48
.long 0xa60800,35848,9,0x21e000,6300,0x11c000,0x11d004,0x81d000,43188,0x160040,0x720b00,61696,0x164000,35968,0xa64000,9216
.long 0x352000,0xb08400,36,4672
.zero 48
.long 0xa68c00,36108,9,0x21f000,6272,0x11c000,0x11d008,0x81d800,47284,0x168040,0x720b40,61696,0x16c000,36228,0xa6c400,9216
.long 0x372000,0xb08c00,36,4672
.zero 48
.long 0xa61000,35856,9,0x25c000,6876,0x15c000,0x15c004,0x85c000,43696,0x160080,0x740b00,61952,0x160080,35840,0xa60000,10240
.long 0x392000,0xb10000,36,4096
.zero 48
.long 0xa69400,36116,9,0x25d000,6844,0x15c000,0x15c008,0x85c800,47792,0x168080,0x740b40,61952,0x168080,36100,0xa68400,10240
.long 0x3b2000,0xb10800,36,4096
.zero 48
.long 0xa61800,35864,9,0x25e000,6812,0x15c000,0x15d004,0x85d000,43700,0x1600c0,0x760b00,62208,0x164080,35968,0xa64000,11264
.long 0x3d2000,0xb18400,36,4160
.zero 48
.long 0xa69c00,36124,9,0x25f000,6784,0x15c000,0x15d008,0x85d800,47796,0x1680c0,0x760b40,62208,0x16c080,36228,0xa6c400,11264
.long 0x3f2000,0xb18c00,36,4160
.zero 48
.long 0xae0000,39936,9,0x29c000,7388,0x19c000,0x19c004,0x89c000,44208,0x1e0000,0x700f00,61440,0x1e0000,39936,0xae0000,8192
.long 0x31a000,0xb00000,52,4608
.zero 48
.long 0xae8400,40196,9,0x29d000,7356,0x19c000,0x19c008,0x89c800,48304,0x1e8000,0x700f40,61440,0x1e8000,40196,0xae8400,8192
.long 0x33a000,0xb00800,52,4608
.zero 48
.long 0xae0800,39944,9,0x29e000,7324,0x19c000,0x19d004,0x89d000,44212,0x1e0040,0x720f00,61696,0x1e4000,40064,0xae4000,9216
.long 0x35a000,0xb08400,52,4672
.zero 48
.long 0xae8c00,40204,9,0x29f000,7296,0x19c000,0x19d008,0x89d800,48308,0x1e8040,0x720f40,61696,0x1ec000,40324,0xaec400,9216
.long 0x37a000,0xb08c00,52,4672
.zero 48
.long 0xae1000,39952,9,0x2dc000,7900,0x1dc000,0x1dc004,0x8dc000,44720,0x1e0080,0x740f00,61952,0x1e0080,39936,0xae0000,10240
.long 0x39a000,0xb10000,52,4096
.zero 48
.long 0xae9400,40212,9,0x2dd000,7868,0x1dc000,0x1dc008,0x8dc800,48816,0x1e8080,0x740f40,61952,0x1e8080,40196,0xae8400,10240
.long 0x3ba000,0xb10800,52,4096
.zero 48
.long 0xae1800,39960,9,0x2de000,7836,0x1dc000,0x1dd004,0x8dd000,44724,0x1e00c0,0x760f00,62208,0x1e4080,40064,0xae4000,11264
.long 0x3da000,0xb18400,52,4160
.zero 48
.long 0xae9c00,40220,9,0x2df000,7808,0x1dc000,0x1dd008,0x8dd800,48820,0x1e80c0,0x760f40,62208,0x1ec080,40324,0xaec400,11264
.long 0x3fa000,0xb18c00,52,4160
.zero 48
.long 0x970000,28160,9,0x11c020,4316,0x1e000,0x1e004,0x71e000,41144,0x70000,0x700380,65536,0x70000,28160,0x970000,8192
.long 0x303000,0xb00000,6,4608
.zero 48
.long 0x978400,28420,9,0x11d020,4284,0x1e000,0x1e008,0x71e800,45240,0x78000,0x7003c0,65536,0x78000,28420,0x978400,8192
.long 0x323000,0xb00800,6,4608
.zero 48
.long 0x970800,28168,9,0x11e020,4252,0x1e000,0x1f004,0x71f000,41148,0x70040,0x720380,65792,0x74000,28288,0x974000,9216
.long 0x343000,0xb08400,6,4672
.zero 48
.long 0x978c00,28428,9,0x11f020,4224,0x1e000,0x1f008,0x71f800,45244,0x78040,0x7203c0,65792,0x7c000,28548,0x97c400,9216
.long 0x363000,0xb08c00,6,4672
.zero 48
.long 0x971000,28176,9,0x15c020,4828,0x5e000,0x5e004,0x75e000,41656,0x70080,0x740380,66048,0x70080,28160,0x970000,10240
.long 0x383000,0xb10000,6,4096
.zero 48
.long 0x979400,28436,9,0x15d020,4796,0x5e000,0x5e008,0x75e800,45752,0x78080,0x7403c0,66048,0x78080,28420,0x978400,10240
.long 0x3a3000,0xb10800,6,4096
.zero 48
.long 0x971800,28184,9,0x15e020,4764,0x5e000,0x5f004,0x75f000,41660,0x700c0,0x760380,66304,0x74080,28288,0x974000,11264
.long 0x3c3000,0xb18400,6,4160
.zero 48
.long 0x979c00,28444,9,0x15f020,4736,0x5e000,0x5f008,0x75f800,45756,0x780c0,0x7603c0,66304,0x7c080,28548,0x97c400,11264
.long 0x3e3000,0xb18c00,6,4160
.zero 48
.long 0x9f0000,32256,9,0x19c020,5340,0x9e000,0x9e004,0x79e000,42168,0xf0000,0x700780,65536,0xf0000,32256,0x9f0000,8192
.long 0x30b000,0xb00000,22,4608
.zero 48
.long 0x9f8400,32516,9,0x19d020,5308,0x9e000,0x9e008,0x79e800,46264,0xf8000,0x7007c0,65536,0xf8000,32516,0x9f8400,8192
.long 0x32b000,0xb00800,22,4608
.zero 48
.long 0x9f0800,32264,9,0x19e020,5276,0x9e000,0x9f004,0x79f000,42172,0xf0040,0x720780,65792,0xf4000,32384,0x9f4000,9216
.long 0x34b000,0xb08400,22,4672
.zero 48
.long 0x9f8c00,32524,9,0x19f020,5248,0x9e000,0x9f008,0x79f800,46268,0xf8040,0x7207c0,65792,0xfc000,32644,0x9fc400,9216
.long 0x36b000,0xb08c00,22,4672
.zero 48
.long 0x9f1000,32272,9,0x1dc020,5852,0xde000,0xde004,0x7de000,42680,0xf0080,0x740780,66048,0xf0080,32256,0x9f0000,10240
.long 0x38b000,0xb10000,22,4096
.zero 48
.long 0x9f9400,32532,9,0x1dd020,5820,0xde000,0xde008,0x7de800,46776,0xf8080,0x7407c0,66048,0xf8080,32516,0x9f8400,10240
.long 0x3ab000,0xb10800,22,4096
.zero 48
.long 0x9f1800,32280,9,0x1de020,5788,0xde000,0xdf004,0x7df000,42684,0xf00c0,0x760780,66304,0xf4080,32384,0x9f4000,11264
.long 0x3cb000,0xb18400,22,4160
.zero 48
.long 0x9f9c00,32540,9,0x1df020,5760,0xde000,0xdf008,0x7df800,46780,0xf80c0,0x7607c0,66304,0xfc080,32644,0x9fc400,11264
.long 0x3eb000,0xb18c00,22,4160
.zero 48
.long 0xa70000,36352,9,0x21c020,6364,0x11e000,0x11e004,0x81e000,43192,0x170000,0x700b80,69632,0x170000,36352,0xa70000,8192
.long 0x313000,0xb00000,38,4608
.zero 48
.long 0xa78400,36612,9,0x21d020,6332,0x11e000,0x11e008,0x81e800,47288,0x178000,0x700bc0,69632,0x178000,36612,0xa78400,8192
.long 0x333000,0xb00800,38,4608
.zero 48
.long 0xa70800,36360,9,0x21e020,6300,0x11e000,0x11f004,0x81f000,43196,0x170040,0x720b80,69888,0x174000,36480,0xa74000,9216
.long 0x353000,0xb08400,38,4672
.zero 48
.long 0xa78c00,36620,9,0x21f020,6272,0x11e000,0x11f008,0x81f800,47292,0x178040,0x720bc0,69888,0x17c000,36740,0xa7c400,9216
.long 0x373000,0xb08c00,38,4672
.zero 48
.long 0xa71000,36368,9,0x25c020,6876,0x15e000,0x15e004,0x85e000,43704,0x170080,0x740b80,70144,0x170080,36352,0xa70000,10240
.long 0x393000,0xb10000,38,4096
.zero 48
.long 0xa79400,36628,9,0x25d020,6844,0x15e000,0x15e008,0x85e800,47800,0x178080,0x740bc0,70144,0x178080,36612,0xa78400,10240
.long 0x3b3000,0xb10800,38,4096
.zero 48
.long 0xa71800,36376,9,0x25e020,6812,0x15e000,0x15f004,0x85f000,43708,0x1700c0,0x760b80,70400,0x174080,36480,0xa74000,11264
.long 0x3d3000,0xb18400,38,4160
.zero 48
.long 0xa79c00,36636,9,0x25f020,6784,0x15e000,0x15f008,0x85f800,47804,0x1780c0,0x760bc0,70400,0x17c080,36740,0xa7c400,11264
.long 0x3f3000,0xb18c00,38,4160
.zero 48
.long 0xaf0000,40448,9,0x29c020,7388,0x19e000,0x19e004,0x89e000,44216,0x1f0000,0x700f80,69632,0x1f0000,40448,0xaf0000,8192
.long 0x31b000,0xb00000,54,4608
.zero 48
.long 0xaf8400,40708,9,0x29d020,7356,0x19e000,0x19e008,0x89e800,48312,0x1f8000,0x700fc0,69632,0x1f8000,40708,0xaf8400,8192
.long 0x33b000,0xb00800,54,4608
.zero 48
.long 0xaf0800,40456,9,0x29e020,7324,0x19e000,0x19f004,0x89f000,44220,0x1f0040,0x720f80,69888,0x1f4000,40576,0xaf4000,9216
.long 0x35b000,0xb08400,54,4672
.zero 48
.long 0xaf8c00,40716,9,0x29f020,7296,0x19e000,0x19f008,0x89f800,48316,0x1f8040,0x720fc0,69888,0x1fc000,40836,0xafc400,9216
.long 0x37b000,0xb08c00,54,4672
.zero 48
.long 0xaf1000,40464,9,0x2dc020,7900,0x1de000,0x1de004,0x8de000,44728,0x1f0080,0x740f80,70144,0x1f0080,40448,0xaf0000,10240
.long 0x39b000,0xb10000,54,4096
.zero 48
.long 0xaf9400,40724,9,0x2dd020,7868,0x1de000,0x1de008,0x8de800,48824,0x1f8080,0x740fc0,70144,0x1f8080,40708,0xaf8400,10240
.long 0x3bb000,0xb10800,54,4096
.zero 48
.long 0xaf1800,40472,9,0x2de020,7836,0x1de000,0x1df004,0x8df000,44732,0x1f00c0,0x760f80,70400,0x1f4080,40576,0xaf4000,11264
.long 0x3db000,0xb18400,54,4160
.zero 48
.long 0xaf9c00,40732,9,0x2df020,7808,0x1de000,0x1df008,0x8df800,48828,0x1f80c0,0x760fc0,70400,0x1fc080,40836,0xafc400,11264
.long 0x3fb000,0xb18c00,54,4160
.zero 48
.long 0x906000,24736,1,0x120000,4444,0x20000,0x20004,0x720000,41216,768,0x880000,44032,768,24576,0x900000,20480
.long 0x5fc000,0xb60000,0xfffffff8,7680
.zero 48
.long 0x90e400,24996,2,0x121000,4412,0x20000,0x20008,0x720800,45312,33536,0x880040,44032,33536,24836,0x908400,20480
.long 0x61c000,0xb60800,0xfffffff8,7680
.zero 48
.long 0x906800,24744,1,0x122000,4380,0x20000,0x21004,0x721000,41220,832,0x8a0000,44288,17152,24704,0x904000,21504
.long 0x63c000,0xb68400,0xfffffff8,7744
.zero 48
.long 0x90ec00,25004,2,0x123000,4352,0x20000,0x21008,0x721800,45316,33600,0x8a0040,44288,49920,24964,0x90c400,21504
.long 0x65c000,0xb68c00,0xfffffff8,7744
.zero 48
.long 0x907000,24752,1,0x160000,4956,0x60000,0x60004,0x760000,41728,896,0x8c0000,44544,896,24576,0x900000,22528
.long 0x67c000,0xb70000,0xfffffff8,7168
.zero 48
.long 0x90f400,25012,2,0x161000,4924,0x60000,0x60008,0x760800,45824,33664,0x8c0040,44544,33664,24836,0x908400,22528
.long 0x69c000,0xb70800,0xfffffff8,7168
.zero 48
.long 0x907800,24760,1,0x162000,4892,0x60000,0x61004,0x761000,41732,960,0x8e0000,44800,17280,24704,0x904000,23552
.long 0x6bc000,0xb78400,0xfffffff8,7232
.zero 48
.long 0x90fc00,25020,2,0x163000,4864,0x60000,0x61008,0x761800,45828,33728,0x8e0040,44800,50048,24964,0x90c400,23552
.long 0x6dc000,0xb78c00,0xfffffff8,7232
.zero 48
.long 0x986000,28832,9,0x1a0000,5468,0xa0000,0xa0004,0x7a0000,42240,0x80300,0x880400,44032,0x80300,28672,0x980000,20480
.long 0x604000,0xb60000,8,7680
.zero 48
.long 0x98e400,29092,9,0x1a1000,5436,0xa0000,0xa0008,0x7a0800,46336,0x88300,0x880440,44032,0x88300,28932,0x988400,20480
.long 0x624000,0xb60800,8,7680
.zero 48
.long 0x986800,28840,9,0x1a2000,5404,0xa0000,0xa1004,0x7a1000,42244,0x80340,0x8a0400,44288,0x84300,28800,0x984000,21504
.long 0x644000,0xb68400,8,7744
.zero 48
.long 0x98ec00,29100,9,0x1a3000,5376,0xa0000,0xa1008,0x7a1800,46340,0x88340,0x8a0440,44288,0x8c300,29060,0x98c400,21504
.long 0x664000,0xb68c00,8,7744
.zero 48
.long 0x987000,28848,9,0x1e0000,5980,0xe0000,0xe0004,0x7e0000,42752,0x80380,0x8c0400,44544,0x80380,28672,0x980000,22528
.long 0x684000,0xb70000,8,7168
.zero 48
.long 0x98f400,29108,9,0x1e1000,5948,0xe0000,0xe0008,0x7e0800,46848,0x88380,0x8c0440,44544,0x88380,28932,0x988400,22528
.long 0x6a4000,0xb70800,8,7168
.zero 48
.long 0x987800,28856,9,0x1e2000,5916,0xe0000,0xe1004,0x7e1000,42756,0x803c0,0x8e0400,44800,0x84380,28800,0x984000,23552
.long 0x6c4000,0xb78400,8,7232
.zero 48
.long 0x98fc00,29116,9,0x1e3000,5888,0xe0000,0xe1008,0x7e1800,46852,0x883c0,0x8e0440,44800,0x8c380,29060,0x98c400,23552
.long 0x6e4000,0xb78c00,8,7232
.zero 48
.long 0xa06000,32928,9,0x220000,6492,0x120000,0x120004,0x820000,43264,0x100300,0x880800,48128,0x100300,32768,0xa00000,20480
.long 0x60c000,0xb60000,24,7680
.zero 48
.long 0xa0e400,33188,9,0x221000,6460,0x120000,0x120008,0x820800,47360,0x108300,0x880840,48128,0x108300,33028,0xa08400,20480
.long 0x62c000,0xb60800,24,7680
.zero 48
.long 0xa06800,32936,9,0x222000,6428,0x120000,0x121004,0x821000,43268,0x100340,0x8a0800,48384,0x104300,32896,0xa04000,21504
.long 0x64c000,0xb68400,24,7744
.zero 48
.long 0xa0ec00,33196,9,0x223000,6400,0x120000,0x121008,0x821800,47364,0x108340,0x8a0840,48384,0x10c300,33156,0xa0c400,21504
.long 0x66c000,0xb68c00,24,7744
.zero 48
.long 0xa07000,32944,9,0x260000,7004,0x160000,0x160004,0x860000,43776,0x100380,0x8c0800,48640,0x100380,32768,0xa00000,22528
.long 0x68c000,0xb70000,24,7168
.zero 48
.long 0xa0f400,33204,9,0x261000,6972,0x160000,0x160008,0x860800,47872,0x108380,0x8c0840,48640,0x108380,33028,0xa08400,22528
.long 0x6ac000,0xb70800,24,7168
.zero 48
.long 0xa07800,32952,9,0x262000,6940,0x160000,0x161004,0x861000,43780,0x1003c0,0x8e0800,48896,0x104380,32896,0xa04000,23552
.long 0x6cc000,0xb78400,24,7232
.zero 48
.long 0xa0fc00,33212,9,0x263000,6912,0x160000,0x161008,0x861800,47876,0x1083c0,0x8e0840,48896,0x10c380,33156,0xa0c400,23552
.long 0x6ec000,0xb78c00,24,7232
.zero 48
.long 0xa86000,37024,9,0x2a0000,7516,0x1a0000,0x1a0004,0x8a0000,44288,0x180300,0x880c00,48128,0x180300,36864,0xa80000,20480
.long 0x614000,0xb60000,40,7680
.zero 48
.long 0xa8e400,37284,9,0x2a1000,7484,0x1a0000,0x1a0008,0x8a0800,48384,0x188300,0x880c40,48128,0x188300,37124,0xa88400,20480
.long 0x634000,0xb60800,40,7680
.zero 48
.long 0xa86800,37032,9,0x2a2000,7452,0x1a0000,0x1a1004,0x8a1000,44292,0x180340,0x8a0c00,48384,0x184300,36992,0xa84000,21504
.long 0x654000,0xb68400,40,7744
.zero 48
.long 0xa8ec00,37292,9,0x2a3000,7424,0x1a0000,0x1a1008,0x8a1800,48388,0x188340,0x8a0c40,48384,0x18c300,37252,0xa8c400,21504
.long 0x674000,0xb68c00,40,7744
.zero 48
.long 0xa87000,37040,9,0x2e0000,8028,0x1e0000,0x1e0004,0x8e0000,44800,0x180380,0x8c0c00,48640,0x180380,36864,0xa80000,22528
.long 0x694000,0xb70000,40,7168
.zero 48
.long 0xa8f400,37300,9,0x2e1000,7996,0x1e0000,0x1e0008,0x8e0800,48896,0x188380,0x8c0c40,48640,0x188380,37124,0xa88400,22528
.long 0x6b4000,0xb70800,40,7168
.zero 48
.long 0xa87800,37048,9,0x2e2000,7964,0x1e0000,0x1e1004,0x8e1000,44804,0x1803c0,0x8e0c00,48896,0x184380,36992,0xa84000,23552
.long 0x6d4000,0xb78400,40,7232
.zero 48
.long 0xa8fc00,37308,9,0x2e3000,7936,0x1e0000,0x1e1008,0x8e1800,48900,0x1883c0,0x8e0c40,48896,0x18c380,37252,0xa8c400,23552
.long 0x6f4000,0xb78c00,40,7232
.zero 48
.long 0x916000,25248,3,0x120020,4444,0x22000,0x22004,0x722000,41224,66304,0x880080,52224,66304,25088,0x910000,20480
.long 0x5fd000,0xb60000,0xfffffffa,7680
.zero 48
.long 0x91e400,25508,4,0x121020,4412,0x22000,0x22008,0x722800,45320,99072,0x8800c0,52224,99072,25348,0x918400,20480
.long 0x61d000,0xb60800,0xfffffffa,7680
.zero 48
.long 0x916800,25256,3,0x122020,4380,0x22000,0x23004,0x723000,41228,66368,0x8a0080,52480,82688,25216,0x914000,21504
.long 0x63d000,0xb68400,0xfffffffa,7744
.zero 48
.long 0x91ec00,25516,4,0x123020,4352,0x22000,0x23008,0x723800,45324,99136,0x8a00c0,52480,0x1c300,25476,0x91c400,21504
.long 0x65d000,0xb68c00,0xfffffffa,7744
.zero 48
.long 0x917000,25264,3,0x160020,4956,0x62000,0x62004,0x762000,41736,66432,0x8c0080,52736,66432,25088,0x910000,22528
.long 0x67d000,0xb70000,0xfffffffa,7168
.zero 48
.long 0x91f400,25524,4,0x161020,4924,0x62000,0x62008,0x762800,45832,99200,0x8c00c0,52736,99200,25348,0x918400,22528
.long 0x69d000,0xb70800,0xfffffffa,7168
.zero 48
.long 0x917800,25272,3,0x162020,4892,0x62000,0x63004,0x763000,41740,66496,0x8e0080,52992,82816,25216,0x914000,23552
.long 0x6bd000,0xb78400,0xfffffffa,7232
.zero 48
.long 0x91fc00,25532,4,0x163020,4864,0x62000,0x63008,0x763800,45836,99264,0x8e00c0,52992,0x1c380,25476,0x91c400,23552
.long 0x6dd000,0xb78c00,0xfffffffa,7232
.zero 48
.long 0x996000,29344,9,0x1a0020,5468,0xa2000,0xa2004,0x7a2000,42248,0x90300,0x880480,52224,0x90300,29184,0x990000,20480
.long 0x605000,0xb60000,10,7680
.zero 48
.long 0x99e400,29604,9,0x1a1020,5436,0xa2000,0xa2008,0x7a2800,46344,0x98300,0x8804c0,52224,0x98300,29444,0x998400,20480
.long 0x625000,0xb60800,10,7680
.zero 48
.long 0x996800,29352,9,0x1a2020,5404,0xa2000,0xa3004,0x7a3000,42252,0x90340,0x8a0480,52480,0x94300,29312,0x994000,21504
.long 0x645000,0xb68400,10,7744
.zero 48
.long 0x99ec00,29612,9,0x1a3020,5376,0xa2000,0xa3008,0x7a3800,46348,0x98340,0x8a04c0,52480,0x9c300,29572,0x99c400,21504
.long 0x665000,0xb68c00,10,7744
.zero 48
.long 0x997000,29360,9,0x1e0020,5980,0xe2000,0xe2004,0x7e2000,42760,0x90380,0x8c0480,52736,0x90380,29184,0x990000,22528
.long 0x685000,0xb70000,10,7168
.zero 48
.long 0x99f400,29620,9,0x1e1020,5948,0xe2000,0xe2008,0x7e2800,46856,0x98380,0x8c04c0,52736,0x98380,29444,0x998400,22528
.long 0x6a5000,0xb70800,10,7168
.zero 48
.long 0x997800,29368,9,0x1e2020,5916,0xe2000,0xe3004,0x7e3000,42764,0x903c0,0x8e0480,52992,0x94380,29312,0x994000,23552
.long 0x6c5000,0xb78400,10,7232
.zero 48
.long 0x99fc00,29628,9,0x1e3020,5888,0xe2000,0xe3008,0x7e3800,46860,0x983c0,0x8e04c0,52992,0x9c380,29572,0x99c400,23552
.long 0x6e5000,0xb78c00,10,7232
.zero 48
.long 0xa16000,33440,9,0x220020,6492,0x122000,0x122004,0x822000,43272,0x110300,0x880880,56320,0x110300,33280,0xa10000,20480
.long 0x60d000,0xb60000,26,7680
.zero 48
.long 0xa1e400,33700,9,0x221020,6460,0x122000,0x122008,0x822800,47368,0x118300,0x8808c0,56320,0x118300,33540,0xa18400,20480
.long 0x62d000,0xb60800,26,7680
.zero 48
.long 0xa16800,33448,9,0x222020,6428,0x122000,0x123004,0x823000,43276,0x110340,0x8a0880,56576,0x114300,33408,0xa14000,21504
.long 0x64d000,0xb68400,26,7744
.zero 48
.long 0xa1ec00,33708,9,0x223020,6400,0x122000,0x123008,0x823800,47372,0x118340,0x8a08c0,56576,0x11c300,33668,0xa1c400,21504
.long 0x66d000,0xb68c00,26,7744
.zero 48
.long 0xa17000,33456,9,0x260020,7004,0x162000,0x162004,0x862000,43784,0x110380,0x8c0880,56832,0x110380,33280,0xa10000,22528
.long 0x68d000,0xb70000,26,7168
.zero 48
.long 0xa1f400,33716,9,0x261020,6972,0x162000,0x162008,0x862800,47880,0x118380,0x8c08c0,56832,0x118380,33540,0xa18400,22528
.long 0x6ad000,0xb70800,26,7168
.zero 48
.long 0xa17800,33464,9,0x262020,6940,0x162000,0x163004,0x863000,43788,0x1103c0,0x8e0880,57088,0x114380,33408,0xa14000,23552
.long 0x6cd000,0xb78400,26,7232
.zero 48
.long 0xa1fc00,33724,9,0x263020,6912,0x162000,0x163008,0x863800,47884,0x1183c0,0x8e08c0,57088,0x11c380,33668,0xa1c400,23552
.long 0x6ed000,0xb78c00,26,7232
.zero 48
.long 0xa96000,37536,9,0x2a0020,7516,0x1a2000,0x1a2004,0x8a2000,44296,0x190300,0x880c80,56320,0x190300,37376,0xa90000,20480
.long 0x615000,0xb60000,42,7680
.zero 48
.long 0xa9e400,37796,9,0x2a1020,7484,0x1a2000,0x1a2008,0x8a2800,48392,0x198300,0x880cc0,56320,0x198300,37636,0xa98400,20480
.long 0x635000,0xb60800,42,7680
.zero 48
.long 0xa96800,37544,9,0x2a2020,7452,0x1a2000,0x1a3004,0x8a3000,44300,0x190340,0x8a0c80,56576,0x194300,37504,0xa94000,21504
.long 0x655000,0xb68400,42,7744
.zero 48
.long 0xa9ec00,37804,9,0x2a3020,7424,0x1a2000,0x1a3008,0x8a3800,48396,0x198340,0x8a0cc0,56576,0x19c300,37764,0xa9c400,21504
.long 0x675000,0xb68c00,42,7744
.zero 48
.long 0xa97000,37552,9,0x2e0020,8028,0x1e2000,0x1e2004,0x8e2000,44808,0x190380,0x8c0c80,56832,0x190380,37376,0xa90000,22528
.long 0x695000,0xb70000,42,7168
.zero 48
.long 0xa9f400,37812,9,0x2e1020,7996,0x1e2000,0x1e2008,0x8e2800,48904,0x198380,0x8c0cc0,56832,0x198380,37636,0xa98400,22528
.long 0x6b5000,0xb70800,42,7168
.zero 48
.long 0xa97800,37560,9,0x2e2020,7964,0x1e2000,0x1e3004,0x8e3000,44812,0x1903c0,0x8e0c80,57088,0x194380,37504,0xa94000,23552
.long 0x6d5000,0xb78400,42,7232
.zero 48
.long 0xa9fc00,37820,9,0x2e3020,7936,0x1e2000,0x1e3008,0x8e3800,48908,0x1983c0,0x8e0cc0,57088,0x19c380,37764,0xa9c400,23552
.long 0x6f5000,0xb78c00,42,7232
.zero 48
.long 0x926000,25760,5,0x124000,4444,0x24000,0x24004,0x724000,41232,0x20300,0x880100,60416,0x20300,25600,0x920000,20480
.long 0x5fe000,0xb60000,0xfffffffc,7680
.zero 48
.long 0x92e400,26020,6,0x125000,4412,0x24000,0x24008,0x724800,45328,0x28300,0x880140,60416,0x28300,25860,0x928400,20480
.long 0x61e000,0xb60800,0xfffffffc,7680
.zero 48
.long 0x926800,25768,5,0x126000,4380,0x24000,0x25004,0x725000,41236,0x20340,0x8a0100,60672,0x24300,25728,0x924000,21504
.long 0x63e000,0xb68400,0xfffffffc,7744
.zero 48
.long 0x92ec00,26028,6,0x127000,4352,0x24000,0x25008,0x725800,45332,0x28340,0x8a0140,60672,0x2c300,25988,0x92c400,21504
.long 0x65e000,0xb68c00,0xfffffffc,7744
.zero 48
.long 0x927000,25776,5,0x164000,4956,0x64000,0x64004,0x764000,41744,0x20380,0x8c0100,60928,0x20380,25600,0x920000,22528
.long 0x67e000,0xb70000,0xfffffffc,7168
.zero 48
.long 0x92f400,26036,6,0x165000,4924,0x64000,0x64008,0x764800,45840,0x28380,0x8c0140,60928,0x28380,25860,0x928400,22528
.long 0x69e000,0xb70800,0xfffffffc,7168
.zero 48
.long 0x927800,25784,5,0x166000,4892,0x64000,0x65004,0x765000,41748,0x203c0,0x8e0100,61184,0x24380,25728,0x924000,23552
.long 0x6be000,0xb78400,0xfffffffc,7232
.zero 48
.long 0x92fc00,26044,6,0x167000,4864,0x64000,0x65008,0x765800,45844,0x283c0,0x8e0140,61184,0x2c380,25988,0x92c400,23552
.long 0x6de000,0xb78c00,0xfffffffc,7232
.zero 48
.long 0x9a6000,29856,9,0x1a4000,5468,0xa4000,0xa4004,0x7a4000,42256,0xa0300,0x880500,60416,0xa0300,29696,0x9a0000,20480
.long 0x606000,0xb60000,12,7680
.zero 48
.long 0x9ae400,30116,9,0x1a5000,5436,0xa4000,0xa4008,0x7a4800,46352,0xa8300,0x880540,60416,0xa8300,29956,0x9a8400,20480
.long 0x626000,0xb60800,12,7680
.zero 48
.long 0x9a6800,29864,9,0x1a6000,5404,0xa4000,0xa5004,0x7a5000,42260,0xa0340,0x8a0500,60672,0xa4300,29824,0x9a4000,21504
.long 0x646000,0xb68400,12,7744
.zero 48
.long 0x9aec00,30124,9,0x1a7000,5376,0xa4000,0xa5008,0x7a5800,46356,0xa8340,0x8a0540,60672,0xac300,30084,0x9ac400,21504
.long 0x666000,0xb68c00,12,7744
.zero 48
.long 0x9a7000,29872,9,0x1e4000,5980,0xe4000,0xe4004,0x7e4000,42768,0xa0380,0x8c0500,60928,0xa0380,29696,0x9a0000,22528
.long 0x686000,0xb70000,12,7168
.zero 48
.long 0x9af400,30132,9,0x1e5000,5948,0xe4000,0xe4008,0x7e4800,46864,0xa8380,0x8c0540,60928,0xa8380,29956,0x9a8400,22528
.long 0x6a6000,0xb70800,12,7168
.zero 48
.long 0x9a7800,29880,9,0x1e6000,5916,0xe4000,0xe5004,0x7e5000,42772,0xa03c0,0x8e0500,61184,0xa4380,29824,0x9a4000,23552
.long 0x6c6000,0xb78400,12,7232
.zero 48
.long 0x9afc00,30140,9,0x1e7000,5888,0xe4000,0xe5008,0x7e5800,46868,0xa83c0,0x8e0540,61184,0xac380,30084,0x9ac400,23552
.long 0x6e6000,0xb78c00,12,7232
.zero 48
.long 0xa26000,33952,9,0x224000,6492,0x124000,0x124004,0x824000,43280,0x120300,0x880900,64512,0x120300,33792,0xa20000,20480
.long 0x60e000,0xb60000,28,7680
.zero 48
.long 0xa2e400,34212,9,0x225000,6460,0x124000,0x124008,0x824800,47376,0x128300,0x880940,64512,0x128300,34052,0xa28400,20480
.long 0x62e000,0xb60800,28,7680
.zero 48
.long 0xa26800,33960,9,0x226000,6428,0x124000,0x125004,0x825000,43284,0x120340,0x8a0900,64768,0x124300,33920,0xa24000,21504
.long 0x64e000,0xb68400,28,7744
.zero 48
.long 0xa2ec00,34220,9,0x227000,6400,0x124000,0x125008,0x825800,47380,0x128340,0x8a0940,64768,0x12c300,34180,0xa2c400,21504
.long 0x66e000,0xb68c00,28,7744
.zero 48
.long 0xa27000,33968,9,0x264000,7004,0x164000,0x164004,0x864000,43792,0x120380,0x8c0900,65024,0x120380,33792,0xa20000,22528
.long 0x68e000,0xb70000,28,7168
.zero 48
.long 0xa2f400,34228,9,0x265000,6972,0x164000,0x164008,0x864800,47888,0x128380,0x8c0940,65024,0x128380,34052,0xa28400,22528
.long 0x6ae000,0xb70800,28,7168
.zero 48
.long 0xa27800,33976,9,0x266000,6940,0x164000,0x165004,0x865000,43796,0x1203c0,0x8e0900,65280,0x124380,33920,0xa24000,23552
.long 0x6ce000,0xb78400,28,7232
.zero 48
.long 0xa2fc00,34236,9,0x267000,6912,0x164000,0x165008,0x865800,47892,0x1283c0,0x8e0940,65280,0x12c380,34180,0xa2c400,23552
.long 0x6ee000,0xb78c00,28,7232
.zero 48
.long 0xaa6000,38048,9,0x2a4000,7516,0x1a4000,0x1a4004,0x8a4000,44304,0x1a0300,0x880d00,64512,0x1a0300,37888,0xaa0000,20480
.long 0x616000,0xb60000,44,7680
.zero 48
.long 0xaae400,38308,9,0x2a5000,7484,0x1a4000,0x1a4008,0x8a4800,48400,0x1a8300,0x880d40,64512,0x1a8300,38148,0xaa8400,20480
.long 0x636000,0xb60800,44,7680
.zero 48
.long 0xaa6800,38056,9,0x2a6000,7452,0x1a4000,0x1a5004,0x8a5000,44308,0x1a0340,0x8a0d00,64768,0x1a4300,38016,0xaa4000,21504
.long 0x656000,0xb68400,44,7744
.zero 48
.long 0xaaec00,38316,9,0x2a7000,7424,0x1a4000,0x1a5008,0x8a5800,48404,0x1a8340,0x8a0d40,64768,0x1ac300,38276,0xaac400,21504
.long 0x676000,0xb68c00,44,7744
.zero 48
.long 0xaa7000,38064,9,0x2e4000,8028,0x1e4000,0x1e4004,0x8e4000,44816,0x1a0380,0x8c0d00,65024,0x1a0380,37888,0xaa0000,22528
.long 0x696000,0xb70000,44,7168
.zero 48
.long 0xaaf400,38324,9,0x2e5000,7996,0x1e4000,0x1e4008,0x8e4800,48912,0x1a8380,0x8c0d40,65024,0x1a8380,38148,0xaa8400,22528
.long 0x6b6000,0xb70800,44,7168
.zero 48
.long 0xaa7800,38072,9,0x2e6000,7964,0x1e4000,0x1e5004,0x8e5000,44820,0x1a03c0,0x8e0d00,65280,0x1a4380,38016,0xaa4000,23552
.long 0x6d6000,0xb78400,44,7232
.zero 48
.long 0xaafc00,38332,9,0x2e7000,7936,0x1e4000,0x1e5008,0x8e5800,48916,0x1a83c0,0x8e0d40,65280,0x1ac380,38276,0xaac400,23552
.long 0x6f6000,0xb78c00,44,7232
.zero 48
.long 0x936000,26272,7,0x124020,4444,0x26000,0x26004,0x726000,41240,0x30300,0x880180,68608,0x30300,26112,0x930000,20480
.long 0x5ff000,0xb60000,0xfffffffe,7680
.zero 48
.long 0x93e400,26532,8,0x125020,4412,0x26000,0x26008,0x726800,45336,0x38300,0x8801c0,68608,0x38300,26372,0x938400,20480
.long 0x61f000,0xb60800,0xfffffffe,7680
.zero 48
.long 0x936800,26280,7,0x126020,4380,0x26000,0x27004,0x727000,41244,0x30340,0x8a0180,68864,0x34300,26240,0x934000,21504
.long 0x63f000,0xb68400,0xfffffffe,7744
.zero 48
.long 0x93ec00,26540,8,0x127020,4352,0x26000,0x27008,0x727800,45340,0x38340,0x8a01c0,68864,0x3c300,26500,0x93c400,21504
.long 0x65f000,0xb68c00,0xfffffffe,7744
.zero 48
.long 0x937000,26288,7,0x164020,4956,0x66000,0x66004,0x766000,41752,0x30380,0x8c0180,69120,0x30380,26112,0x930000,22528
.long 0x67f000,0xb70000,0xfffffffe,7168
.zero 48
.long 0x93f400,26548,8,0x165020,4924,0x66000,0x66008,0x766800,45848,0x38380,0x8c01c0,69120,0x38380,26372,0x938400,22528
.long 0x69f000,0xb70800,0xfffffffe,7168
.zero 48
.long 0x937800,26296,7,0x166020,4892,0x66000,0x67004,0x767000,41756,0x303c0,0x8e0180,69376,0x34380,26240,0x934000,23552
.long 0x6bf000,0xb78400,0xfffffffe,7232
.zero 48
.long 0x93fc00,26556,8,0x167020,4864,0x66000,0x67008,0x767800,45852,0x383c0,0x8e01c0,69376,0x3c380,26500,0x93c400,23552
.long 0x6df000,0xb78c00,0xfffffffe,7232
.zero 48
.long 0x9b6000,30368,9,0x1a4020,5468,0xa6000,0xa6004,0x7a6000,42264,0xb0300,0x880580,68608,0xb0300,30208,0x9b0000,20480
.long 0x607000,0xb60000,14,7680
.zero 48
.long 0x9be400,30628,9,0x1a5020,5436,0xa6000,0xa6008,0x7a6800,46360,0xb8300,0x8805c0,68608,0xb8300,30468,0x9b8400,20480
.long 0x627000,0xb60800,14,7680
.zero 48
.long 0x9b6800,30376,9,0x1a6020,5404,0xa6000,0xa7004,0x7a7000,42268,0xb0340,0x8a0580,68864,0xb4300,30336,0x9b4000,21504
.long 0x647000,0xb68400,14,7744
.zero 48
.long 0x9bec00,30636,9,0x1a7020,5376,0xa6000,0xa7008,0x7a7800,46364,0xb8340,0x8a05c0,68864,0xbc300,30596,0x9bc400,21504
.long 0x667000,0xb68c00,14,7744
.zero 48
.long 0x9b7000,30384,9,0x1e4020,5980,0xe6000,0xe6004,0x7e6000,42776,0xb0380,0x8c0580,69120,0xb0380,30208,0x9b0000,22528
.long 0x687000,0xb70000,14,7168
.zero 48
.long 0x9bf400,30644,9,0x1e5020,5948,0xe6000,0xe6008,0x7e6800,46872,0xb8380,0x8c05c0,69120,0xb8380,30468,0x9b8400,22528
.long 0x6a7000,0xb70800,14,7168
.zero 48
.long 0x9b7800,30392,9,0x1e6020,5916,0xe6000,0xe7004,0x7e7000,42780,0xb03c0,0x8e0580,69376,0xb4380,30336,0x9b4000,23552
.long 0x6c7000,0xb78400,14,7232
.zero 48
.long 0x9bfc00,30652,9,0x1e7020,5888,0xe6000,0xe7008,0x7e7800,46876,0xb83c0,0x8e05c0,69376,0xbc380,30596,0x9bc400,23552
.long 0x6e7000,0xb78c00,14,7232
.zero 48
.long 0xa36000,34464,9,0x224020,6492,0x126000,0x126004,0x826000,43288,0x130300,0x880980,72704,0x130300,34304,0xa30000,20480
.long 0x60f000,0xb60000,30,7680
.zero 48
.long 0xa3e400,34724,9,0x225020,6460,0x126000,0x126008,0x826800,47384,0x138300,0x8809c0,72704,0x138300,34564,0xa38400,20480
.long 0x62f000,0xb60800,30,7680
.zero 48
.long 0xa36800,34472,9,0x226020,6428,0x126000,0x127004,0x827000,43292,0x130340,0x8a0980,72960,0x134300,34432,0xa34000,21504
.long 0x64f000,0xb68400,30,7744
.zero 48
.long 0xa3ec00,34732,9,0x227020,6400,0x126000,0x127008,0x827800,47388,0x138340,0x8a09c0,72960,0x13c300,34692,0xa3c400,21504
.long 0x66f000,0xb68c00,30,7744
.zero 48
.long 0xa37000,34480,9,0x264020,7004,0x166000,0x166004,0x866000,43800,0x130380,0x8c0980,73216,0x130380,34304,0xa30000,22528
.long 0x68f000,0xb70000,30,7168
.zero 48
.long 0xa3f400,34740,9,0x265020,6972,0x166000,0x166008,0x866800,47896,0x138380,0x8c09c0,73216,0x138380,34564,0xa38400,22528
.long 0x6af000,0xb70800,30,7168
.zero 48
.long 0xa37800,34488,9,0x266020,6940,0x166000,0x167004,0x867000,43804,0x1303c0,0x8e0980,73472,0x134380,34432,0xa34000,23552
.long 0x6cf000,0xb78400,30,7232
.zero 48
.long 0xa3fc00,34748,9,0x267020,6912,0x166000,0x167008,0x867800,47900,0x1383c0,0x8e09c0,73472,0x13c380,34692,0xa3c400,23552
.long 0x6ef000,0xb78c00,30,7232
.zero 48
.long 0xab6000,38560,9,0x2a4020,7516,0x1a6000,0x1a6004,0x8a6000,44312,0x1b0300,0x880d80,72704,0x1b0300,38400,0xab0000,20480
.long 0x617000,0xb60000,46,7680
.zero 48
.long 0xabe400,38820,9,0x2a5020,7484,0x1a6000,0x1a6008,0x8a6800,48408,0x1b8300,0x880dc0,72704,0x1b8300,38660,0xab8400,20480
.long 0x637000,0xb60800,46,7680
.zero 48
.long 0xab6800,38568,9,0x2a6020,7452,0x1a6000,0x1a7004,0x8a7000,44316,0x1b0340,0x8a0d80,72960,0x1b4300,38528,0xab4000,21504
.long 0x657000,0xb68400,46,7744
.zero 48
.long 0xabec00,38828,9,0x2a7020,7424,0x1a6000,0x1a7008,0x8a7800,48412,0x1b8340,0x8a0dc0,72960,0x1bc300,38788,0xabc400,21504
.long 0x677000,0xb68c00,46,7744
.zero 48
.long 0xab7000,38576,9,0x2e4020,8028,0x1e6000,0x1e6004,0x8e6000,44824,0x1b0380,0x8c0d80,73216,0x1b0380,38400,0xab0000,22528
.long 0x697000,0xb70000,46,7168
.zero 48
.long 0xabf400,38836,9,0x2e5020,7996,0x1e6000,0x1e6008,0x8e6800,48920,0x1b8380,0x8c0dc0,73216,0x1b8380,38660,0xab8400,22528
.long 0x6b7000,0xb70800,46,7168
.zero 48
.long 0xab7800,38584,9,0x2e6020,7964,0x1e6000,0x1e7004,0x8e7000,44828,0x1b03c0,0x8e0d80,73472,0x1b4380,38528,0xab4000,23552
.long 0x6d7000,0xb78400,46,7232
.zero 48
.long 0xabfc00,38844,9,0x2e7020,7936,0x1e6000,0x1e7008,0x8e7800,48924,0x1b83c0,0x8e0dc0,73472,0x1bc380,38788,0xabc400,23552
.long 0x6f7000,0xb78c00,46,7232
.zero 48
.long 0x946000,26784,9,0x128000,4444,0x28000,0x28004,0x728000,41248,0x40300,0x880200,44032,0x40300,26624,0x940000,20480
.long 0x600000,0xb60000,0,7680
.zero 48
.long 0x94e400,27044,9,0x129000,4412,0x28000,0x28008,0x728800,45344,0x48300,0x880240,44032,0x48300,26884,0x948400,20480
.long 0x620000,0xb60800,0,7680
.zero 48
.long 0x946800,26792,9,0x12a000,4380,0x28000,0x29004,0x729000,41252,0x40340,0x8a0200,44288,0x44300,26752,0x944000,21504
.long 0x640000,0xb68400,0,7744
.zero 48
.long 0x94ec00,27052,9,0x12b000,4352,0x28000,0x29008,0x729800,45348,0x48340,0x8a0240,44288,0x4c300,27012,0x94c400,21504
.long 0x660000,0xb68c00,0,7744
.zero 48
.long 0x947000,26800,9,0x168000,4956,0x68000,0x68004,0x768000,41760,0x40380,0x8c0200,44544,0x40380,26624,0x940000,22528
.long 0x680000,0xb70000,0,7168
.zero 48
.long 0x94f400,27060,9,0x169000,4924,0x68000,0x68008,0x768800,45856,0x48380,0x8c0240,44544,0x48380,26884,0x948400,22528
.long 0x6a0000,0xb70800,0,7168
.zero 48
.long 0x947800,26808,9,0x16a000,4892,0x68000,0x69004,0x769000,41764,0x403c0,0x8e0200,44800,0x44380,26752,0x944000,23552
.long 0x6c0000,0xb78400,0,7232
.zero 48
.long 0x94fc00,27068,9,0x16b000,4864,0x68000,0x69008,0x769800,45860,0x483c0,0x8e0240,44800,0x4c380,27012,0x94c400,23552
.long 0x6e0000,0xb78c00,0,7232
.zero 48
.long 0x9c6000,30880,9,0x1a8000,5468,0xa8000,0xa8004,0x7a8000,42272,0xc0300,0x880600,44032,0xc0300,30720,0x9c0000,20480
.long 0x608000,0xb60000,16,7680
.zero 48
.long 0x9ce400,31140,9,0x1a9000,5436,0xa8000,0xa8008,0x7a8800,46368,0xc8300,0x880640,44032,0xc8300,30980,0x9c8400,20480
.long 0x628000,0xb60800,16,7680
.zero 48
.long 0x9c6800,30888,9,0x1aa000,5404,0xa8000,0xa9004,0x7a9000,42276,0xc0340,0x8a0600,44288,0xc4300,30848,0x9c4000,21504
.long 0x648000,0xb68400,16,7744
.zero 48
.long 0x9cec00,31148,9,0x1ab000,5376,0xa8000,0xa9008,0x7a9800,46372,0xc8340,0x8a0640,44288,0xcc300,31108,0x9cc400,21504
.long 0x668000,0xb68c00,16,7744
.zero 48
.long 0x9c7000,30896,9,0x1e8000,5980,0xe8000,0xe8004,0x7e8000,42784,0xc0380,0x8c0600,44544,0xc0380,30720,0x9c0000,22528
.long 0x688000,0xb70000,16,7168
.zero 48
.long 0x9cf400,31156,9,0x1e9000,5948,0xe8000,0xe8008,0x7e8800,46880,0xc8380,0x8c0640,44544,0xc8380,30980,0x9c8400,22528
.long 0x6a8000,0xb70800,16,7168
.zero 48
.long 0x9c7800,30904,9,0x1ea000,5916,0xe8000,0xe9004,0x7e9000,42788,0xc03c0,0x8e0600,44800,0xc4380,30848,0x9c4000,23552
.long 0x6c8000,0xb78400,16,7232
.zero 48
.long 0x9cfc00,31164,9,0x1eb000,5888,0xe8000,0xe9008,0x7e9800,46884,0xc83c0,0x8e0640,44800,0xcc380,31108,0x9cc400,23552
.long 0x6e8000,0xb78c00,16,7232
.zero 48
.long 0xa46000,34976,9,0x228000,6492,0x128000,0x128004,0x828000,43296,0x140300,0x880a00,48128,0x140300,34816,0xa40000,20480
.long 0x610000,0xb60000,32,7680
.zero 48
.long 0xa4e400,35236,9,0x229000,6460,0x128000,0x128008,0x828800,47392,0x148300,0x880a40,48128,0x148300,35076,0xa48400,20480
.long 0x630000,0xb60800,32,7680
.zero 48
.long 0xa46800,34984,9,0x22a000,6428,0x128000,0x129004,0x829000,43300,0x140340,0x8a0a00,48384,0x144300,34944,0xa44000,21504
.long 0x650000,0xb68400,32,7744
.zero 48
.long 0xa4ec00,35244,9,0x22b000,6400,0x128000,0x129008,0x829800,47396,0x148340,0x8a0a40,48384,0x14c300,35204,0xa4c400,21504
.long 0x670000,0xb68c00,32,7744
.zero 48
.long 0xa47000,34992,9,0x268000,7004,0x168000,0x168004,0x868000,43808,0x140380,0x8c0a00,48640,0x140380,34816,0xa40000,22528
.long 0x690000,0xb70000,32,7168
.zero 48
.long 0xa4f400,35252,9,0x269000,6972,0x168000,0x168008,0x868800,47904,0x148380,0x8c0a40,48640,0x148380,35076,0xa48400,22528
.long 0x6b0000,0xb70800,32,7168
.zero 48
.long 0xa47800,35000,9,0x26a000,6940,0x168000,0x169004,0x869000,43812,0x1403c0,0x8e0a00,48896,0x144380,34944,0xa44000,23552
.long 0x6d0000,0xb78400,32,7232
.zero 48
.long 0xa4fc00,35260,9,0x26b000,6912,0x168000,0x169008,0x869800,47908,0x1483c0,0x8e0a40,48896,0x14c380,35204,0xa4c400,23552
.long 0x6f0000,0xb78c00,32,7232
.zero 48
.long 0xac6000,39072,9,0x2a8000,7516,0x1a8000,0x1a8004,0x8a8000,44320,0x1c0300,0x880e00,48128,0x1c0300,38912,0xac0000,20480
.long 0x618000,0xb60000,48,7680
.zero 48
.long 0xace400,39332,9,0x2a9000,7484,0x1a8000,0x1a8008,0x8a8800,48416,0x1c8300,0x880e40,48128,0x1c8300,39172,0xac8400,20480
.long 0x638000,0xb60800,48,7680
.zero 48
.long 0xac6800,39080,9,0x2aa000,7452,0x1a8000,0x1a9004,0x8a9000,44324,0x1c0340,0x8a0e00,48384,0x1c4300,39040,0xac4000,21504
.long 0x658000,0xb68400,48,7744
.zero 48
.long 0xacec00,39340,9,0x2ab000,7424,0x1a8000,0x1a9008,0x8a9800,48420,0x1c8340,0x8a0e40,48384,0x1cc300,39300,0xacc400,21504
.long 0x678000,0xb68c00,48,7744
.zero 48
.long 0xac7000,39088,9,0x2e8000,8028,0x1e8000,0x1e8004,0x8e8000,44832,0x1c0380,0x8c0e00,48640,0x1c0380,38912,0xac0000,22528
.long 0x698000,0xb70000,48,7168
.zero 48
.long 0xacf400,39348,9,0x2e9000,7996,0x1e8000,0x1e8008,0x8e8800,48928,0x1c8380,0x8c0e40,48640,0x1c8380,39172,0xac8400,22528
.long 0x6b8000,0xb70800,48,7168
.zero 48
.long 0xac7800,39096,9,0x2ea000,7964,0x1e8000,0x1e9004,0x8e9000,44836,0x1c03c0,0x8e0e00,48896,0x1c4380,39040,0xac4000,23552
.long 0x6d8000,0xb78400,48,7232
.zero 48
.long 0xacfc00,39356,9,0x2eb000,7936,0x1e8000,0x1e9008,0x8e9800,48932,0x1c83c0,0x8e0e40,48896,0x1cc380,39300,0xacc400,23552
.long 0x6f8000,0xb78c00,48,7232
.zero 48
.long 0x956000,27296,9,0x128020,4444,0x2a000,0x2a004,0x72a000,41256,0x50300,0x880280,52224,0x50300,27136,0x950000,20480
.long 0x601000,0xb60000,2,7680
.zero 48
.long 0x95e400,27556,9,0x129020,4412,0x2a000,0x2a008,0x72a800,45352,0x58300,0x8802c0,52224,0x58300,27396,0x958400,20480
.long 0x621000,0xb60800,2,7680
.zero 48
.long 0x956800,27304,9,0x12a020,4380,0x2a000,0x2b004,0x72b000,41260,0x50340,0x8a0280,52480,0x54300,27264,0x954000,21504
.long 0x641000,0xb68400,2,7744
.zero 48
.long 0x95ec00,27564,9,0x12b020,4352,0x2a000,0x2b008,0x72b800,45356,0x58340,0x8a02c0,52480,0x5c300,27524,0x95c400,21504
.long 0x661000,0xb68c00,2,7744
.zero 48
.long 0x957000,27312,9,0x168020,4956,0x6a000,0x6a004,0x76a000,41768,0x50380,0x8c0280,52736,0x50380,27136,0x950000,22528
.long 0x681000,0xb70000,2,7168
.zero 48
.long 0x95f400,27572,9,0x169020,4924,0x6a000,0x6a008,0x76a800,45864,0x58380,0x8c02c0,52736,0x58380,27396,0x958400,22528
.long 0x6a1000,0xb70800,2,7168
.zero 48
.long 0x957800,27320,9,0x16a020,4892,0x6a000,0x6b004,0x76b000,41772,0x503c0,0x8e0280,52992,0x54380,27264,0x954000,23552
.long 0x6c1000,0xb78400,2,7232
.zero 48
.long 0x95fc00,27580,9,0x16b020,4864,0x6a000,0x6b008,0x76b800,45868,0x583c0,0x8e02c0,52992,0x5c380,27524,0x95c400,23552
.long 0x6e1000,0xb78c00,2,7232
.zero 48
.long 0x9d6000,31392,9,0x1a8020,5468,0xaa000,0xaa004,0x7aa000,42280,0xd0300,0x880680,52224,0xd0300,31232,0x9d0000,20480
.long 0x609000,0xb60000,18,7680
.zero 48
.long 0x9de400,31652,9,0x1a9020,5436,0xaa000,0xaa008,0x7aa800,46376,0xd8300,0x8806c0,52224,0xd8300,31492,0x9d8400,20480
.long 0x629000,0xb60800,18,7680
.zero 48
.long 0x9d6800,31400,9,0x1aa020,5404,0xaa000,0xab004,0x7ab000,42284,0xd0340,0x8a0680,52480,0xd4300,31360,0x9d4000,21504
.long 0x649000,0xb68400,18,7744
.zero 48
.long 0x9dec00,31660,9,0x1ab020,5376,0xaa000,0xab008,0x7ab800,46380,0xd8340,0x8a06c0,52480,0xdc300,31620,0x9dc400,21504
.long 0x669000,0xb68c00,18,7744
.zero 48
.long 0x9d7000,31408,9,0x1e8020,5980,0xea000,0xea004,0x7ea000,42792,0xd0380,0x8c0680,52736,0xd0380,31232,0x9d0000,22528
.long 0x689000,0xb70000,18,7168
.zero 48
.long 0x9df400,31668,9,0x1e9020,5948,0xea000,0xea008,0x7ea800,46888,0xd8380,0x8c06c0,52736,0xd8380,31492,0x9d8400,22528
.long 0x6a9000,0xb70800,18,7168
.zero 48
.long 0x9d7800,31416,9,0x1ea020,5916,0xea000,0xeb004,0x7eb000,42796,0xd03c0,0x8e0680,52992,0xd4380,31360,0x9d4000,23552
.long 0x6c9000,0xb78400,18,7232
.zero 48
.long 0x9dfc00,31676,9,0x1eb020,5888,0xea000,0xeb008,0x7eb800,46892,0xd83c0,0x8e06c0,52992,0xdc380,31620,0x9dc400,23552
.long 0x6e9000,0xb78c00,18,7232
.zero 48
.long 0xa56000,35488,9,0x228020,6492,0x12a000,0x12a004,0x82a000,43304,0x150300,0x880a80,56320,0x150300,35328,0xa50000,20480
.long 0x611000,0xb60000,34,7680
.zero 48
.long 0xa5e400,35748,9,0x229020,6460,0x12a000,0x12a008,0x82a800,47400,0x158300,0x880ac0,56320,0x158300,35588,0xa58400,20480
.long 0x631000,0xb60800,34,7680
.zero 48
.long 0xa56800,35496,9,0x22a020,6428,0x12a000,0x12b004,0x82b000,43308,0x150340,0x8a0a80,56576,0x154300,35456,0xa54000,21504
.long 0x651000,0xb68400,34,7744
.zero 48
.long 0xa5ec00,35756,9,0x22b020,6400,0x12a000,0x12b008,0x82b800,47404,0x158340,0x8a0ac0,56576,0x15c300,35716,0xa5c400,21504
.long 0x671000,0xb68c00,34,7744
.zero 48
.long 0xa57000,35504,9,0x268020,7004,0x16a000,0x16a004,0x86a000,43816,0x150380,0x8c0a80,56832,0x150380,35328,0xa50000,22528
.long 0x691000,0xb70000,34,7168
.zero 48
.long 0xa5f400,35764,9,0x269020,6972,0x16a000,0x16a008,0x86a800,47912,0x158380,0x8c0ac0,56832,0x158380,35588,0xa58400,22528
.long 0x6b1000,0xb70800,34,7168
.zero 48
.long 0xa57800,35512,9,0x26a020,6940,0x16a000,0x16b004,0x86b000,43820,0x1503c0,0x8e0a80,57088,0x154380,35456,0xa54000,23552
.long 0x6d1000,0xb78400,34,7232
.zero 48
.long 0xa5fc00,35772,9,0x26b020,6912,0x16a000,0x16b008,0x86b800,47916,0x1583c0,0x8e0ac0,57088,0x15c380,35716,0xa5c400,23552
.long 0x6f1000,0xb78c00,34,7232
.zero 48
.long 0xad6000,39584,9,0x2a8020,7516,0x1aa000,0x1aa004,0x8aa000,44328,0x1d0300,0x880e80,56320,0x1d0300,39424,0xad0000,20480
.long 0x619000,0xb60000,50,7680
.zero 48
.long 0xade400,39844,9,0x2a9020,7484,0x1aa000,0x1aa008,0x8aa800,48424,0x1d8300,0x880ec0,56320,0x1d8300,39684,0xad8400,20480
.long 0x639000,0xb60800,50,7680
.zero 48
.long 0xad6800,39592,9,0x2aa020,7452,0x1aa000,0x1ab004,0x8ab000,44332,0x1d0340,0x8a0e80,56576,0x1d4300,39552,0xad4000,21504
.long 0x659000,0xb68400,50,7744
.zero 48
.long 0xadec00,39852,9,0x2ab020,7424,0x1aa000,0x1ab008,0x8ab800,48428,0x1d8340,0x8a0ec0,56576,0x1dc300,39812,0xadc400,21504
.long 0x679000,0xb68c00,50,7744
.zero 48
.long 0xad7000,39600,9,0x2e8020,8028,0x1ea000,0x1ea004,0x8ea000,44840,0x1d0380,0x8c0e80,56832,0x1d0380,39424,0xad0000,22528
.long 0x699000,0xb70000,50,7168
.zero 48
.long 0xadf400,39860,9,0x2e9020,7996,0x1ea000,0x1ea008,0x8ea800,48936,0x1d8380,0x8c0ec0,56832,0x1d8380,39684,0xad8400,22528
.long 0x6b9000,0xb70800,50,7168
.zero 48
.long 0xad7800,39608,9,0x2ea020,7964,0x1ea000,0x1eb004,0x8eb000,44844,0x1d03c0,0x8e0e80,57088,0x1d4380,39552,0xad4000,23552
.long 0x6d9000,0xb78400,50,7232
.zero 48
.long 0xadfc00,39868,9,0x2eb020,7936,0x1ea000,0x1eb008,0x8eb800,48940,0x1d83c0,0x8e0ec0,57088,0x1dc380,39812,0xadc400,23552
.long 0x6f9000,0xb78c00,50,7232
.zero 48
.long 0x966000,27808,9,0x12c000,4444,0x2c000,0x2c004,0x72c000,41264,0x60300,0x880300,60416,0x60300,27648,0x960000,20480
.long 0x602000,0xb60000,4,7680
.zero 48
.long 0x96e400,28068,9,0x12d000,4412,0x2c000,0x2c008,0x72c800,45360,0x68300,0x880340,60416,0x68300,27908,0x968400,20480
.long 0x622000,0xb60800,4,7680
.zero 48
.long 0x966800,27816,9,0x12e000,4380,0x2c000,0x2d004,0x72d000,41268,0x60340,0x8a0300,60672,0x64300,27776,0x964000,21504
.long 0x642000,0xb68400,4,7744
.zero 48
.long 0x96ec00,28076,9,0x12f000,4352,0x2c000,0x2d008,0x72d800,45364,0x68340,0x8a0340,60672,0x6c300,28036,0x96c400,21504
.long 0x662000,0xb68c00,4,7744
.zero 48
.long 0x967000,27824,9,0x16c000,4956,0x6c000,0x6c004,0x76c000,41776,0x60380,0x8c0300,60928,0x60380,27648,0x960000,22528
.long 0x682000,0xb70000,4,7168
.zero 48
.long 0x96f400,28084,9,0x16d000,4924,0x6c000,0x6c008,0x76c800,45872,0x68380,0x8c0340,60928,0x68380,27908,0x968400,22528
.long 0x6a2000,0xb70800,4,7168
.zero 48
.long 0x967800,27832,9,0x16e000,4892,0x6c000,0x6d004,0x76d000,41780,0x603c0,0x8e0300,61184,0x64380,27776,0x964000,23552
.long 0x6c2000,0xb78400,4,7232
.zero 48
.long 0x96fc00,28092,9,0x16f000,4864,0x6c000,0x6d008,0x76d800,45876,0x683c0,0x8e0340,61184,0x6c380,28036,0x96c400,23552
.long 0x6e2000,0xb78c00,4,7232
.zero 48
.long 0x9e6000,31904,9,0x1ac000,5468,0xac000,0xac004,0x7ac000,42288,0xe0300,0x880700,60416,0xe0300,31744,0x9e0000,20480
.long 0x60a000,0xb60000,20,7680
.zero 48
.long 0x9ee400,32164,9,0x1ad000,5436,0xac000,0xac008,0x7ac800,46384,0xe8300,0x880740,60416,0xe8300,32004,0x9e8400,20480
.long 0x62a000,0xb60800,20,7680
.zero 48
.long 0x9e6800,31912,9,0x1ae000,5404,0xac000,0xad004,0x7ad000,42292,0xe0340,0x8a0700,60672,0xe4300,31872,0x9e4000,21504
.long 0x64a000,0xb68400,20,7744
.zero 48
.long 0x9eec00,32172,9,0x1af000,5376,0xac000,0xad008,0x7ad800,46388,0xe8340,0x8a0740,60672,0xec300,32132,0x9ec400,21504
.long 0x66a000,0xb68c00,20,7744
.zero 48
.long 0x9e7000,31920,9,0x1ec000,5980,0xec000,0xec004,0x7ec000,42800,0xe0380,0x8c0700,60928,0xe0380,31744,0x9e0000,22528
.long 0x68a000,0xb70000,20,7168
.zero 48
.long 0x9ef400,32180,9,0x1ed000,5948,0xec000,0xec008,0x7ec800,46896,0xe8380,0x8c0740,60928,0xe8380,32004,0x9e8400,22528
.long 0x6aa000,0xb70800,20,7168
.zero 48
.long 0x9e7800,31928,9,0x1ee000,5916,0xec000,0xed004,0x7ed000,42804,0xe03c0,0x8e0700,61184,0xe4380,31872,0x9e4000,23552
.long 0x6ca000,0xb78400,20,7232
.zero 48
.long 0x9efc00,32188,9,0x1ef000,5888,0xec000,0xed008,0x7ed800,46900,0xe83c0,0x8e0740,61184,0xec380,32132,0x9ec400,23552
.long 0x6ea000,0xb78c00,20,7232
.zero 48
.long 0xa66000,36000,9,0x22c000,6492,0x12c000,0x12c004,0x82c000,43312,0x160300,0x880b00,64512,0x160300,35840,0xa60000,20480
.long 0x612000,0xb60000,36,7680
.zero 48
.long 0xa6e400,36260,9,0x22d000,6460,0x12c000,0x12c008,0x82c800,47408,0x168300,0x880b40,64512,0x168300,36100,0xa68400,20480
.long 0x632000,0xb60800,36,7680
.zero 48
.long 0xa66800,36008,9,0x22e000,6428,0x12c000,0x12d004,0x82d000,43316,0x160340,0x8a0b00,64768,0x164300,35968,0xa64000,21504
.long 0x652000,0xb68400,36,7744
.zero 48
.long 0xa6ec00,36268,9,0x22f000,6400,0x12c000,0x12d008,0x82d800,47412,0x168340,0x8a0b40,64768,0x16c300,36228,0xa6c400,21504
.long 0x672000,0xb68c00,36,7744
.zero 48
.long 0xa67000,36016,9,0x26c000,7004,0x16c000,0x16c004,0x86c000,43824,0x160380,0x8c0b00,65024,0x160380,35840,0xa60000,22528
.long 0x692000,0xb70000,36,7168
.zero 48
.long 0xa6f400,36276,9,0x26d000,6972,0x16c000,0x16c008,0x86c800,47920,0x168380,0x8c0b40,65024,0x168380,36100,0xa68400,22528
.long 0x6b2000,0xb70800,36,7168
.zero 48
.long 0xa67800,36024,9,0x26e000,6940,0x16c000,0x16d004,0x86d000,43828,0x1603c0,0x8e0b00,65280,0x164380,35968,0xa64000,23552
.long 0x6d2000,0xb78400,36,7232
.zero 48
.long 0xa6fc00,36284,9,0x26f000,6912,0x16c000,0x16d008,0x86d800,47924,0x1683c0,0x8e0b40,65280,0x16c380,36228,0xa6c400,23552
.long 0x6f2000,0xb78c00,36,7232
.zero 48
.long 0xae6000,40096,9,0x2ac000,7516,0x1ac000,0x1ac004,0x8ac000,44336,0x1e0300,0x880f00,64512,0x1e0300,39936,0xae0000,20480
.long 0x61a000,0xb60000,52,7680
.zero 48
.long 0xaee400,40356,9,0x2ad000,7484,0x1ac000,0x1ac008,0x8ac800,48432,0x1e8300,0x880f40,64512,0x1e8300,40196,0xae8400,20480
.long 0x63a000,0xb60800,52,7680
.zero 48
.long 0xae6800,40104,9,0x2ae000,7452,0x1ac000,0x1ad004,0x8ad000,44340,0x1e0340,0x8a0f00,64768,0x1e4300,40064,0xae4000,21504
.long 0x65a000,0xb68400,52,7744
.zero 48
.long 0xaeec00,40364,9,0x2af000,7424,0x1ac000,0x1ad008,0x8ad800,48436,0x1e8340,0x8a0f40,64768,0x1ec300,40324,0xaec400,21504
.long 0x67a000,0xb68c00,52,7744
.zero 48
.long 0xae7000,40112,9,0x2ec000,8028,0x1ec000,0x1ec004,0x8ec000,44848,0x1e0380,0x8c0f00,65024,0x1e0380,39936,0xae0000,22528
.long 0x69a000,0xb70000,52,7168
.zero 48
.long 0xaef400,40372,9,0x2ed000,7996,0x1ec000,0x1ec008,0x8ec800,48944,0x1e8380,0x8c0f40,65024,0x1e8380,40196,0xae8400,22528
.long 0x6ba000,0xb70800,52,7168
.zero 48
.long 0xae7800,40120,9,0x2ee000,7964,0x1ec000,0x1ed004,0x8ed000,44852,0x1e03c0,0x8e0f00,65280,0x1e4380,40064,0xae4000,23552
.long 0x6da000,0xb78400,52,7232
.zero 48
.long 0xaefc00,40380,9,0x2ef000,7936,0x1ec000,0x1ed008,0x8ed800,48948,0x1e83c0,0x8e0f40,65280,0x1ec380,40324,0xaec400,23552
.long 0x6fa000,0xb78c00,52,7232
.zero 48
.long 0x976000,28320,9,0x12c020,4444,0x2e000,0x2e004,0x72e000,41272,0x70300,0x880380,68608,0x70300,28160,0x970000,20480
.long 0x603000,0xb60000,6,7680
.zero 48
.long 0x97e400,28580,9,0x12d020,4412,0x2e000,0x2e008,0x72e800,45368,0x78300,0x8803c0,68608,0x78300,28420,0x978400,20480
.long 0x623000,0xb60800,6,7680
.zero 48
.long 0x976800,28328,9,0x12e020,4380,0x2e000,0x2f004,0x72f000,41276,0x70340,0x8a0380,68864,0x74300,28288,0x974000,21504
.long 0x643000,0xb68400,6,7744
.zero 48
.long 0x97ec00,28588,9,0x12f020,4352,0x2e000,0x2f008,0x72f800,45372,0x78340,0x8a03c0,68864,0x7c300,28548,0x97c400,21504
.long 0x663000,0xb68c00,6,7744
.zero 48
.long 0x977000,28336,9,0x16c020,4956,0x6e000,0x6e004,0x76e000,41784,0x70380,0x8c0380,69120,0x70380,28160,0x970000,22528
.long 0x683000,0xb70000,6,7168
.zero 48
.long 0x97f400,28596,9,0x16d020,4924,0x6e000,0x6e008,0x76e800,45880,0x78380,0x8c03c0,69120,0x78380,28420,0x978400,22528
.long 0x6a3000,0xb70800,6,7168
.zero 48
.long 0x977800,28344,9,0x16e020,4892,0x6e000,0x6f004,0x76f000,41788,0x703c0,0x8e0380,69376,0x74380,28288,0x974000,23552
.long 0x6c3000,0xb78400,6,7232
.zero 48
.long 0x97fc00,28604,9,0x16f020,4864,0x6e000,0x6f008,0x76f800,45884,0x783c0,0x8e03c0,69376,0x7c380,28548,0x97c400,23552
.long 0x6e3000,0xb78c00,6,7232
.zero 48
.long 0x9f6000,32416,9,0x1ac020,5468,0xae000,0xae004,0x7ae000,42296,0xf0300,0x880780,68608,0xf0300,32256,0x9f0000,20480
.long 0x60b000,0xb60000,22,7680
.zero 48
.long 0x9fe400,32676,9,0x1ad020,5436,0xae000,0xae008,0x7ae800,46392,0xf8300,0x8807c0,68608,0xf8300,32516,0x9f8400,20480
.long 0x62b000,0xb60800,22,7680
.zero 48
.long 0x9f6800,32424,9,0x1ae020,5404,0xae000,0xaf004,0x7af000,42300,0xf0340,0x8a0780,68864,0xf4300,32384,0x9f4000,21504
.long 0x64b000,0xb68400,22,7744
.zero 48
.long 0x9fec00,32684,9,0x1af020,5376,0xae000,0xaf008,0x7af800,46396,0xf8340,0x8a07c0,68864,0xfc300,32644,0x9fc400,21504
.long 0x66b000,0xb68c00,22,7744
.zero 48
.long 0x9f7000,32432,9,0x1ec020,5980,0xee000,0xee004,0x7ee000,42808,0xf0380,0x8c0780,69120,0xf0380,32256,0x9f0000,22528
.long 0x68b000,0xb70000,22,7168
.zero 48
.long 0x9ff400,32692,9,0x1ed020,5948,0xee000,0xee008,0x7ee800,46904,0xf8380,0x8c07c0,69120,0xf8380,32516,0x9f8400,22528
.long 0x6ab000,0xb70800,22,7168
.zero 48
.long 0x9f7800,32440,9,0x1ee020,5916,0xee000,0xef004,0x7ef000,42812,0xf03c0,0x8e0780,69376,0xf4380,32384,0x9f4000,23552
.long 0x6cb000,0xb78400,22,7232
.zero 48
.long 0x9ffc00,32700,9,0x1ef020,5888,0xee000,0xef008,0x7ef800,46908,0xf83c0,0x8e07c0,69376,0xfc380,32644,0x9fc400,23552
.long 0x6eb000,0xb78c00,22,7232
.zero 48
.long 0xa76000,36512,9,0x22c020,6492,0x12e000,0x12e004,0x82e000,43320,0x170300,0x880b80,72704,0x170300,36352,0xa70000,20480
.long 0x613000,0xb60000,38,7680
.zero 48
.long 0xa7e400,36772,9,0x22d020,6460,0x12e000,0x12e008,0x82e800,47416,0x178300,0x880bc0,72704,0x178300,36612,0xa78400,20480
.long 0x633000,0xb60800,38,7680
.zero 48
.long 0xa76800,36520,9,0x22e020,6428,0x12e000,0x12f004,0x82f000,43324,0x170340,0x8a0b80,72960,0x174300,36480,0xa74000,21504
.long 0x653000,0xb68400,38,7744
.zero 48
.long 0xa7ec00,36780,9,0x22f020,6400,0x12e000,0x12f008,0x82f800,47420,0x178340,0x8a0bc0,72960,0x17c300,36740,0xa7c400,21504
.long 0x673000,0xb68c00,38,7744
.zero 48
.long 0xa77000,36528,9,0x26c020,7004,0x16e000,0x16e004,0x86e000,43832,0x170380,0x8c0b80,73216,0x170380,36352,0xa70000,22528
.long 0x693000,0xb70000,38,7168
.zero 48
.long 0xa7f400,36788,9,0x26d020,6972,0x16e000,0x16e008,0x86e800,47928,0x178380,0x8c0bc0,73216,0x178380,36612,0xa78400,22528
.long 0x6b3000,0xb70800,38,7168
.zero 48
.long 0xa77800,36536,9,0x26e020,6940,0x16e000,0x16f004,0x86f000,43836,0x1703c0,0x8e0b80,73472,0x174380,36480,0xa74000,23552
.long 0x6d3000,0xb78400,38,7232
.zero 48
.long 0xa7fc00,36796,9,0x26f020,6912,0x16e000,0x16f008,0x86f800,47932,0x1783c0,0x8e0bc0,73472,0x17c380,36740,0xa7c400,23552
.long 0x6f3000,0xb78c00,38,7232
.zero 48
.long 0xaf6000,40608,9,0x2ac020,7516,0x1ae000,0x1ae004,0x8ae000,44344,0x1f0300,0x880f80,72704,0x1f0300,40448,0xaf0000,20480
.long 0x61b000,0xb60000,54,7680
.zero 48
.long 0xafe400,40868,9,0x2ad020,7484,0x1ae000,0x1ae008,0x8ae800,48440,0x1f8300,0x880fc0,72704,0x1f8300,40708,0xaf8400,20480
.long 0x63b000,0xb60800,54,7680
.zero 48
.long 0xaf6800,40616,9,0x2ae020,7452,0x1ae000,0x1af004,0x8af000,44348,0x1f0340,0x8a0f80,72960,0x1f4300,40576,0xaf4000,21504
.long 0x65b000,0xb68400,54,7744
.zero 48
.long 0xafec00,40876,9,0x2af020,7424,0x1ae000,0x1af008,0x8af800,48444,0x1f8340,0x8a0fc0,72960,0x1fc300,40836,0xafc400,21504
.long 0x67b000,0xb68c00,54,7744
.zero 48
.long 0xaf7000,40624,9,0x2ec020,8028,0x1ee000,0x1ee004,0x8ee000,44856,0x1f0380,0x8c0f80,73216,0x1f0380,40448,0xaf0000,22528
.long 0x69b000,0xb70000,54,7168
.zero 48
.long 0xaff400,40884,9,0x2ed020,7996,0x1ee000,0x1ee008,0x8ee800,48952,0x1f8380,0x8c0fc0,73216,0x1f8380,40708,0xaf8400,22528
.long 0x6bb000,0xb70800,54,7168
.zero 48
.long 0xaf7800,40632,9,0x2ee020,7964,0x1ee000,0x1ef004,0x8ef000,44860,0x1f03c0,0x8e0f80,73472,0x1f4380,40576,0xaf4000,23552
.long 0x6db000,0xb78400,54,7232
.zero 48
.long 0xaffc00,40892,9,0x2ef020,7936,0x1ee000,0x1ef008,0x8ef800,48956,0x1f83c0,0x8e0fc0,73472,0x1fc380,40836,0xafc400,23552
.long 0x6fb000,0xb78c00,54,7232
.zero 48
.long 0x904000,24704,1,0x130000,4572,0x30000,0x30004,0x730000,41344,512,0x800000,43008,512,24576,0x900000,16384
.long 0x4fc000,0xb40000,0xfffffff8,6656
.zero 48
.long 0x90c400,24964,2,0x131000,4540,0x30000,0x30008,0x730800,45440,33280,0x800040,43008,33280,24836,0x908400,16384
.long 0x51c000,0xb40800,0xfffffff8,6656
.zero 48
.long 0x904800,24712,1,0x132000,4508,0x30000,0x31004,0x731000,41348,576,0x820000,43264,16896,24704,0x904000,17408
.long 0x53c000,0xb48400,0xfffffff8,6720
.zero 48
.long 0x90cc00,24972,2,0x133000,4480,0x30000,0x31008,0x731800,45444,33344,0x820040,43264,49664,24964,0x90c400,17408
.long 0x55c000,0xb48c00,0xfffffff8,6720
.zero 48
.long 0x905000,24720,1,0x170000,5084,0x70000,0x70004,0x770000,41856,640,0x840000,43520,640,24576,0x900000,18432
.long 0x57c000,0xb50000,0xfffffff8,6144
.zero 48
.long 0x90d400,24980,2,0x171000,5052,0x70000,0x70008,0x770800,45952,33408,0x840040,43520,33408,24836,0x908400,18432
.long 0x59c000,0xb50800,0xfffffff8,6144
.zero 48
.long 0x905800,24728,1,0x172000,5020,0x70000,0x71004,0x771000,41860,704,0x860000,43776,17024,24704,0x904000,19456
.long 0x5bc000,0xb58400,0xfffffff8,6208
.zero 48
.long 0x90dc00,24988,2,0x173000,4992,0x70000,0x71008,0x771800,45956,33472,0x860040,43776,49792,24964,0x90c400,19456
.long 0x5dc000,0xb58c00,0xfffffff8,6208
.zero 48
.long 0x984000,28800,9,0x1b0000,5596,0xb0000,0xb0004,0x7b0000,42368,0x80200,0x800400,43008,0x80200,28672,0x980000,16384
.long 0x504000,0xb40000,8,6656
.zero 48
.long 0x98c400,29060,9,0x1b1000,5564,0xb0000,0xb0008,0x7b0800,46464,0x88200,0x800440,43008,0x88200,28932,0x988400,16384
.long 0x524000,0xb40800,8,6656
.zero 48
.long 0x984800,28808,9,0x1b2000,5532,0xb0000,0xb1004,0x7b1000,42372,0x80240,0x820400,43264,0x84200,28800,0x984000,17408
.long 0x544000,0xb48400,8,6720
.zero 48
.long 0x98cc00,29068,9,0x1b3000,5504,0xb0000,0xb1008,0x7b1800,46468,0x88240,0x820440,43264,0x8c200,29060,0x98c400,17408
.long 0x564000,0xb48c00,8,6720
.zero 48
.long 0x985000,28816,9,0x1f0000,6108,0xf0000,0xf0004,0x7f0000,42880,0x80280,0x840400,43520,0x80280,28672,0x980000,18432
.long 0x584000,0xb50000,8,6144
.zero 48
.long 0x98d400,29076,9,0x1f1000,6076,0xf0000,0xf0008,0x7f0800,46976,0x88280,0x840440,43520,0x88280,28932,0x988400,18432
.long 0x5a4000,0xb50800,8,6144
.zero 48
.long 0x985800,28824,9,0x1f2000,6044,0xf0000,0xf1004,0x7f1000,42884,0x802c0,0x860400,43776,0x84280,28800,0x984000,19456
.long 0x5c4000,0xb58400,8,6208
.zero 48
.long 0x98dc00,29084,9,0x1f3000,6016,0xf0000,0xf1008,0x7f1800,46980,0x882c0,0x860440,43776,0x8c280,29060,0x98c400,19456
.long 0x5e4000,0xb58c00,8,6208
.zero 48
.long 0xa04000,32896,9,0x230000,6620,0x130000,0x130004,0x830000,43392,0x100200,0x800800,47104,0x100200,32768,0xa00000,16384
.long 0x50c000,0xb40000,24,6656
.zero 48
.long 0xa0c400,33156,9,0x231000,6588,0x130000,0x130008,0x830800,47488,0x108200,0x800840,47104,0x108200,33028,0xa08400,16384
.long 0x52c000,0xb40800,24,6656
.zero 48
.long 0xa04800,32904,9,0x232000,6556,0x130000,0x131004,0x831000,43396,0x100240,0x820800,47360,0x104200,32896,0xa04000,17408
.long 0x54c000,0xb48400,24,6720
.zero 48
.long 0xa0cc00,33164,9,0x233000,6528,0x130000,0x131008,0x831800,47492,0x108240,0x820840,47360,0x10c200,33156,0xa0c400,17408
.long 0x56c000,0xb48c00,24,6720
.zero 48
.long 0xa05000,32912,9,0x270000,7132,0x170000,0x170004,0x870000,43904,0x100280,0x840800,47616,0x100280,32768,0xa00000,18432
.long 0x58c000,0xb50000,24,6144
.zero 48
.long 0xa0d400,33172,9,0x271000,7100,0x170000,0x170008,0x870800,48000,0x108280,0x840840,47616,0x108280,33028,0xa08400,18432
.long 0x5ac000,0xb50800,24,6144
.zero 48
.long 0xa05800,32920,9,0x272000,7068,0x170000,0x171004,0x871000,43908,0x1002c0,0x860800,47872,0x104280,32896,0xa04000,19456
.long 0x5cc000,0xb58400,24,6208
.zero 48
.long 0xa0dc00,33180,9,0x273000,7040,0x170000,0x171008,0x871800,48004,0x1082c0,0x860840,47872,0x10c280,33156,0xa0c400,19456
.long 0x5ec000,0xb58c00,24,6208
.zero 48
.long 0xa84000,36992,9,0x2b0000,7644,0x1b0000,0x1b0004,0x8b0000,44416,0x180200,0x800c00,47104,0x180200,36864,0xa80000,16384
.long 0x514000,0xb40000,40,6656
.zero 48
.long 0xa8c400,37252,9,0x2b1000,7612,0x1b0000,0x1b0008,0x8b0800,48512,0x188200,0x800c40,47104,0x188200,37124,0xa88400,16384
.long 0x534000,0xb40800,40,6656
.zero 48
.long 0xa84800,37000,9,0x2b2000,7580,0x1b0000,0x1b1004,0x8b1000,44420,0x180240,0x820c00,47360,0x184200,36992,0xa84000,17408
.long 0x554000,0xb48400,40,6720
.zero 48
.long 0xa8cc00,37260,9,0x2b3000,7552,0x1b0000,0x1b1008,0x8b1800,48516,0x188240,0x820c40,47360,0x18c200,37252,0xa8c400,17408
.long 0x574000,0xb48c00,40,6720
.zero 48
.long 0xa85000,37008,9,0x2f0000,8156,0x1f0000,0x1f0004,0x8f0000,44928,0x180280,0x840c00,47616,0x180280,36864,0xa80000,18432
.long 0x594000,0xb50000,40,6144
.zero 48
.long 0xa8d400,37268,9,0x2f1000,8124,0x1f0000,0x1f0008,0x8f0800,49024,0x188280,0x840c40,47616,0x188280,37124,0xa88400,18432
.long 0x5b4000,0xb50800,40,6144
.zero 48
.long 0xa85800,37016,9,0x2f2000,8092,0x1f0000,0x1f1004,0x8f1000,44932,0x1802c0,0x860c00,47872,0x184280,36992,0xa84000,19456
.long 0x5d4000,0xb58400,40,6208
.zero 48
.long 0xa8dc00,37276,9,0x2f3000,8064,0x1f0000,0x1f1008,0x8f1800,49028,0x1882c0,0x860c40,47872,0x18c280,37252,0xa8c400,19456
.long 0x5f4000,0xb58c00,40,6208
.zero 48
.long 0x914000,25216,3,0x130020,4572,0x32000,0x32004,0x732000,41352,66048,0x800080,51200,66048,25088,0x910000,16384
.long 0x4fd000,0xb40000,0xfffffffa,6656
.zero 48
.long 0x91c400,25476,4,0x131020,4540,0x32000,0x32008,0x732800,45448,98816,0x8000c0,51200,98816,25348,0x918400,16384
.long 0x51d000,0xb40800,0xfffffffa,6656
.zero 48
.long 0x914800,25224,3,0x132020,4508,0x32000,0x33004,0x733000,41356,66112,0x820080,51456,82432,25216,0x914000,17408
.long 0x53d000,0xb48400,0xfffffffa,6720
.zero 48
.long 0x91cc00,25484,4,0x133020,4480,0x32000,0x33008,0x733800,45452,98880,0x8200c0,51456,0x1c200,25476,0x91c400,17408
.long 0x55d000,0xb48c00,0xfffffffa,6720
.zero 48
.long 0x915000,25232,3,0x170020,5084,0x72000,0x72004,0x772000,41864,66176,0x840080,51712,66176,25088,0x910000,18432
.long 0x57d000,0xb50000,0xfffffffa,6144
.zero 48
.long 0x91d400,25492,4,0x171020,5052,0x72000,0x72008,0x772800,45960,98944,0x8400c0,51712,98944,25348,0x918400,18432
.long 0x59d000,0xb50800,0xfffffffa,6144
.zero 48
.long 0x915800,25240,3,0x172020,5020,0x72000,0x73004,0x773000,41868,66240,0x860080,51968,82560,25216,0x914000,19456
.long 0x5bd000,0xb58400,0xfffffffa,6208
.zero 48
.long 0x91dc00,25500,4,0x173020,4992,0x72000,0x73008,0x773800,45964,99008,0x8600c0,51968,0x1c280,25476,0x91c400,19456
.long 0x5dd000,0xb58c00,0xfffffffa,6208
.zero 48
.long 0x994000,29312,9,0x1b0020,5596,0xb2000,0xb2004,0x7b2000,42376,0x90200,0x800480,51200,0x90200,29184,0x990000,16384
.long 0x505000,0xb40000,10,6656
.zero 48
.long 0x99c400,29572,9,0x1b1020,5564,0xb2000,0xb2008,0x7b2800,46472,0x98200,0x8004c0,51200,0x98200,29444,0x998400,16384
.long 0x525000,0xb40800,10,6656
.zero 48
.long 0x994800,29320,9,0x1b2020,5532,0xb2000,0xb3004,0x7b3000,42380,0x90240,0x820480,51456,0x94200,29312,0x994000,17408
.long 0x545000,0xb48400,10,6720
.zero 48
.long 0x99cc00,29580,9,0x1b3020,5504,0xb2000,0xb3008,0x7b3800,46476,0x98240,0x8204c0,51456,0x9c200,29572,0x99c400,17408
.long 0x565000,0xb48c00,10,6720
.zero 48
.long 0x995000,29328,9,0x1f0020,6108,0xf2000,0xf2004,0x7f2000,42888,0x90280,0x840480,51712,0x90280,29184,0x990000,18432
.long 0x585000,0xb50000,10,6144
.zero 48
.long 0x99d400,29588,9,0x1f1020,6076,0xf2000,0xf2008,0x7f2800,46984,0x98280,0x8404c0,51712,0x98280,29444,0x998400,18432
.long 0x5a5000,0xb50800,10,6144
.zero 48
.long 0x995800,29336,9,0x1f2020,6044,0xf2000,0xf3004,0x7f3000,42892,0x902c0,0x860480,51968,0x94280,29312,0x994000,19456
.long 0x5c5000,0xb58400,10,6208
.zero 48
.long 0x99dc00,29596,9,0x1f3020,6016,0xf2000,0xf3008,0x7f3800,46988,0x982c0,0x8604c0,51968,0x9c280,29572,0x99c400,19456
.long 0x5e5000,0xb58c00,10,6208
.zero 48
.long 0xa14000,33408,9,0x230020,6620,0x132000,0x132004,0x832000,43400,0x110200,0x800880,55296,0x110200,33280,0xa10000,16384
.long 0x50d000,0xb40000,26,6656
.zero 48
.long 0xa1c400,33668,9,0x231020,6588,0x132000,0x132008,0x832800,47496,0x118200,0x8008c0,55296,0x118200,33540,0xa18400,16384
.long 0x52d000,0xb40800,26,6656
.zero 48
.long 0xa14800,33416,9,0x232020,6556,0x132000,0x133004,0x833000,43404,0x110240,0x820880,55552,0x114200,33408,0xa14000,17408
.long 0x54d000,0xb48400,26,6720
.zero 48
.long 0xa1cc00,33676,9,0x233020,6528,0x132000,0x133008,0x833800,47500,0x118240,0x8208c0,55552,0x11c200,33668,0xa1c400,17408
.long 0x56d000,0xb48c00,26,6720
.zero 48
.long 0xa15000,33424,9,0x270020,7132,0x172000,0x172004,0x872000,43912,0x110280,0x840880,55808,0x110280,33280,0xa10000,18432
.long 0x58d000,0xb50000,26,6144
.zero 48
.long 0xa1d400,33684,9,0x271020,7100,0x172000,0x172008,0x872800,48008,0x118280,0x8408c0,55808,0x118280,33540,0xa18400,18432
.long 0x5ad000,0xb50800,26,6144
.zero 48
.long 0xa15800,33432,9,0x272020,7068,0x172000,0x173004,0x873000,43916,0x1102c0,0x860880,56064,0x114280,33408,0xa14000,19456
.long 0x5cd000,0xb58400,26,6208
.zero 48
.long 0xa1dc00,33692,9,0x273020,7040,0x172000,0x173008,0x873800,48012,0x1182c0,0x8608c0,56064,0x11c280,33668,0xa1c400,19456
.long 0x5ed000,0xb58c00,26,6208
.zero 48
.long 0xa94000,37504,9,0x2b0020,7644,0x1b2000,0x1b2004,0x8b2000,44424,0x190200,0x800c80,55296,0x190200,37376,0xa90000,16384
.long 0x515000,0xb40000,42,6656
.zero 48
.long 0xa9c400,37764,9,0x2b1020,7612,0x1b2000,0x1b2008,0x8b2800,48520,0x198200,0x800cc0,55296,0x198200,37636,0xa98400,16384
.long 0x535000,0xb40800,42,6656
.zero 48
.long 0xa94800,37512,9,0x2b2020,7580,0x1b2000,0x1b3004,0x8b3000,44428,0x190240,0x820c80,55552,0x194200,37504,0xa94000,17408
.long 0x555000,0xb48400,42,6720
.zero 48
.long 0xa9cc00,37772,9,0x2b3020,7552,0x1b2000,0x1b3008,0x8b3800,48524,0x198240,0x820cc0,55552,0x19c200,37764,0xa9c400,17408
.long 0x575000,0xb48c00,42,6720
.zero 48
.long 0xa95000,37520,9,0x2f0020,8156,0x1f2000,0x1f2004,0x8f2000,44936,0x190280,0x840c80,55808,0x190280,37376,0xa90000,18432
.long 0x595000,0xb50000,42,6144
.zero 48
.long 0xa9d400,37780,9,0x2f1020,8124,0x1f2000,0x1f2008,0x8f2800,49032,0x198280,0x840cc0,55808,0x198280,37636,0xa98400,18432
.long 0x5b5000,0xb50800,42,6144
.zero 48
.long 0xa95800,37528,9,0x2f2020,8092,0x1f2000,0x1f3004,0x8f3000,44940,0x1902c0,0x860c80,56064,0x194280,37504,0xa94000,19456
.long 0x5d5000,0xb58400,42,6208
.zero 48
.long 0xa9dc00,37788,9,0x2f3020,8064,0x1f2000,0x1f3008,0x8f3800,49036,0x1982c0,0x860cc0,56064,0x19c280,37764,0xa9c400,19456
.long 0x5f5000,0xb58c00,42,6208
.zero 48
.long 0x924000,25728,5,0x134000,4572,0x34000,0x34004,0x734000,41360,0x20200,0x800100,59392,0x20200,25600,0x920000,16384
.long 0x4fe000,0xb40000,0xfffffffc,6656
.zero 48
.long 0x92c400,25988,6,0x135000,4540,0x34000,0x34008,0x734800,45456,0x28200,0x800140,59392,0x28200,25860,0x928400,16384
.long 0x51e000,0xb40800,0xfffffffc,6656
.zero 48
.long 0x924800,25736,5,0x136000,4508,0x34000,0x35004,0x735000,41364,0x20240,0x820100,59648,0x24200,25728,0x924000,17408
.long 0x53e000,0xb48400,0xfffffffc,6720
.zero 48
.long 0x92cc00,25996,6,0x137000,4480,0x34000,0x35008,0x735800,45460,0x28240,0x820140,59648,0x2c200,25988,0x92c400,17408
.long 0x55e000,0xb48c00,0xfffffffc,6720
.zero 48
.long 0x925000,25744,5,0x174000,5084,0x74000,0x74004,0x774000,41872,0x20280,0x840100,59904,0x20280,25600,0x920000,18432
.long 0x57e000,0xb50000,0xfffffffc,6144
.zero 48
.long 0x92d400,26004,6,0x175000,5052,0x74000,0x74008,0x774800,45968,0x28280,0x840140,59904,0x28280,25860,0x928400,18432
.long 0x59e000,0xb50800,0xfffffffc,6144
.zero 48
.long 0x925800,25752,5,0x176000,5020,0x74000,0x75004,0x775000,41876,0x202c0,0x860100,60160,0x24280,25728,0x924000,19456
.long 0x5be000,0xb58400,0xfffffffc,6208
.zero 48
.long 0x92dc00,26012,6,0x177000,4992,0x74000,0x75008,0x775800,45972,0x282c0,0x860140,60160,0x2c280,25988,0x92c400,19456
.long 0x5de000,0xb58c00,0xfffffffc,6208
.zero 48
.long 0x9a4000,29824,9,0x1b4000,5596,0xb4000,0xb4004,0x7b4000,42384,0xa0200,0x800500,59392,0xa0200,29696,0x9a0000,16384
.long 0x506000,0xb40000,12,6656
.zero 48
.long 0x9ac400,30084,9,0x1b5000,5564,0xb4000,0xb4008,0x7b4800,46480,0xa8200,0x800540,59392,0xa8200,29956,0x9a8400,16384
.long 0x526000,0xb40800,12,6656
.zero 48
.long 0x9a4800,29832,9,0x1b6000,5532,0xb4000,0xb5004,0x7b5000,42388,0xa0240,0x820500,59648,0xa4200,29824,0x9a4000,17408
.long 0x546000,0xb48400,12,6720
.zero 48
.long 0x9acc00,30092,9,0x1b7000,5504,0xb4000,0xb5008,0x7b5800,46484,0xa8240,0x820540,59648,0xac200,30084,0x9ac400,17408
.long 0x566000,0xb48c00,12,6720
.zero 48
.long 0x9a5000,29840,9,0x1f4000,6108,0xf4000,0xf4004,0x7f4000,42896,0xa0280,0x840500,59904,0xa0280,29696,0x9a0000,18432
.long 0x586000,0xb50000,12,6144
.zero 48
.long 0x9ad400,30100,9,0x1f5000,6076,0xf4000,0xf4008,0x7f4800,46992,0xa8280,0x840540,59904,0xa8280,29956,0x9a8400,18432
.long 0x5a6000,0xb50800,12,6144
.zero 48
.long 0x9a5800,29848,9,0x1f6000,6044,0xf4000,0xf5004,0x7f5000,42900,0xa02c0,0x860500,60160,0xa4280,29824,0x9a4000,19456
.long 0x5c6000,0xb58400,12,6208
.zero 48
.long 0x9adc00,30108,9,0x1f7000,6016,0xf4000,0xf5008,0x7f5800,46996,0xa82c0,0x860540,60160,0xac280,30084,0x9ac400,19456
.long 0x5e6000,0xb58c00,12,6208
.zero 48
.long 0xa24000,33920,9,0x234000,6620,0x134000,0x134004,0x834000,43408,0x120200,0x800900,63488,0x120200,33792,0xa20000,16384
.long 0x50e000,0xb40000,28,6656
.zero 48
.long 0xa2c400,34180,9,0x235000,6588,0x134000,0x134008,0x834800,47504,0x128200,0x800940,63488,0x128200,34052,0xa28400,16384
.long 0x52e000,0xb40800,28,6656
.zero 48
.long 0xa24800,33928,9,0x236000,6556,0x134000,0x135004,0x835000,43412,0x120240,0x820900,63744,0x124200,33920,0xa24000,17408
.long 0x54e000,0xb48400,28,6720
.zero 48
.long 0xa2cc00,34188,9,0x237000,6528,0x134000,0x135008,0x835800,47508,0x128240,0x820940,63744,0x12c200,34180,0xa2c400,17408
.long 0x56e000,0xb48c00,28,6720
.zero 48
.long 0xa25000,33936,9,0x274000,7132,0x174000,0x174004,0x874000,43920,0x120280,0x840900,64000,0x120280,33792,0xa20000,18432
.long 0x58e000,0xb50000,28,6144
.zero 48
.long 0xa2d400,34196,9,0x275000,7100,0x174000,0x174008,0x874800,48016,0x128280,0x840940,64000,0x128280,34052,0xa28400,18432
.long 0x5ae000,0xb50800,28,6144
.zero 48
.long 0xa25800,33944,9,0x276000,7068,0x174000,0x175004,0x875000,43924,0x1202c0,0x860900,64256,0x124280,33920,0xa24000,19456
.long 0x5ce000,0xb58400,28,6208
.zero 48
.long 0xa2dc00,34204,9,0x277000,7040,0x174000,0x175008,0x875800,48020,0x1282c0,0x860940,64256,0x12c280,34180,0xa2c400,19456
.long 0x5ee000,0xb58c00,28,6208
.zero 48
.long 0xaa4000,38016,9,0x2b4000,7644,0x1b4000,0x1b4004,0x8b4000,44432,0x1a0200,0x800d00,63488,0x1a0200,37888,0xaa0000,16384
.long 0x516000,0xb40000,44,6656
.zero 48
.long 0xaac400,38276,9,0x2b5000,7612,0x1b4000,0x1b4008,0x8b4800,48528,0x1a8200,0x800d40,63488,0x1a8200,38148,0xaa8400,16384
.long 0x536000,0xb40800,44,6656
.zero 48
.long 0xaa4800,38024,9,0x2b6000,7580,0x1b4000,0x1b5004,0x8b5000,44436,0x1a0240,0x820d00,63744,0x1a4200,38016,0xaa4000,17408
.long 0x556000,0xb48400,44,6720
.zero 48
.long 0xaacc00,38284,9,0x2b7000,7552,0x1b4000,0x1b5008,0x8b5800,48532,0x1a8240,0x820d40,63744,0x1ac200,38276,0xaac400,17408
.long 0x576000,0xb48c00,44,6720
.zero 48
.long 0xaa5000,38032,9,0x2f4000,8156,0x1f4000,0x1f4004,0x8f4000,44944,0x1a0280,0x840d00,64000,0x1a0280,37888,0xaa0000,18432
.long 0x596000,0xb50000,44,6144
.zero 48
.long 0xaad400,38292,9,0x2f5000,8124,0x1f4000,0x1f4008,0x8f4800,49040,0x1a8280,0x840d40,64000,0x1a8280,38148,0xaa8400,18432
.long 0x5b6000,0xb50800,44,6144
.zero 48
.long 0xaa5800,38040,9,0x2f6000,8092,0x1f4000,0x1f5004,0x8f5000,44948,0x1a02c0,0x860d00,64256,0x1a4280,38016,0xaa4000,19456
.long 0x5d6000,0xb58400,44,6208
.zero 48
.long 0xaadc00,38300,9,0x2f7000,8064,0x1f4000,0x1f5008,0x8f5800,49044,0x1a82c0,0x860d40,64256,0x1ac280,38276,0xaac400,19456
.long 0x5f6000,0xb58c00,44,6208
.zero 48
.long 0x934000,26240,7,0x134020,4572,0x36000,0x36004,0x736000,41368,0x30200,0x800180,67584,0x30200,26112,0x930000,16384
.long 0x4ff000,0xb40000,0xfffffffe,6656
.zero 48
.long 0x93c400,26500,8,0x135020,4540,0x36000,0x36008,0x736800,45464,0x38200,0x8001c0,67584,0x38200,26372,0x938400,16384
.long 0x51f000,0xb40800,0xfffffffe,6656
.zero 48
.long 0x934800,26248,7,0x136020,4508,0x36000,0x37004,0x737000,41372,0x30240,0x820180,67840,0x34200,26240,0x934000,17408
.long 0x53f000,0xb48400,0xfffffffe,6720
.zero 48
.long 0x93cc00,26508,8,0x137020,4480,0x36000,0x37008,0x737800,45468,0x38240,0x8201c0,67840,0x3c200,26500,0x93c400,17408
.long 0x55f000,0xb48c00,0xfffffffe,6720
.zero 48
.long 0x935000,26256,7,0x174020,5084,0x76000,0x76004,0x776000,41880,0x30280,0x840180,68096,0x30280,26112,0x930000,18432
.long 0x57f000,0xb50000,0xfffffffe,6144
.zero 48
.long 0x93d400,26516,8,0x175020,5052,0x76000,0x76008,0x776800,45976,0x38280,0x8401c0,68096,0x38280,26372,0x938400,18432
.long 0x59f000,0xb50800,0xfffffffe,6144
.zero 48
.long 0x935800,26264,7,0x176020,5020,0x76000,0x77004,0x777000,41884,0x302c0,0x860180,68352,0x34280,26240,0x934000,19456
.long 0x5bf000,0xb58400,0xfffffffe,6208
.zero 48
.long 0x93dc00,26524,8,0x177020,4992,0x76000,0x77008,0x777800,45980,0x382c0,0x8601c0,68352,0x3c280,26500,0x93c400,19456
.long 0x5df000,0xb58c00,0xfffffffe,6208
.zero 48
.long 0x9b4000,30336,9,0x1b4020,5596,0xb6000,0xb6004,0x7b6000,42392,0xb0200,0x800580,67584,0xb0200,30208,0x9b0000,16384
.long 0x507000,0xb40000,14,6656
.zero 48
.long 0x9bc400,30596,9,0x1b5020,5564,0xb6000,0xb6008,0x7b6800,46488,0xb8200,0x8005c0,67584,0xb8200,30468,0x9b8400,16384
.long 0x527000,0xb40800,14,6656
.zero 48
.long 0x9b4800,30344,9,0x1b6020,5532,0xb6000,0xb7004,0x7b7000,42396,0xb0240,0x820580,67840,0xb4200,30336,0x9b4000,17408
.long 0x547000,0xb48400,14,6720
.zero 48
.long 0x9bcc00,30604,9,0x1b7020,5504,0xb6000,0xb7008,0x7b7800,46492,0xb8240,0x8205c0,67840,0xbc200,30596,0x9bc400,17408
.long 0x567000,0xb48c00,14,6720
.zero 48
.long 0x9b5000,30352,9,0x1f4020,6108,0xf6000,0xf6004,0x7f6000,42904,0xb0280,0x840580,68096,0xb0280,30208,0x9b0000,18432
.long 0x587000,0xb50000,14,6144
.zero 48
.long 0x9bd400,30612,9,0x1f5020,6076,0xf6000,0xf6008,0x7f6800,47000,0xb8280,0x8405c0,68096,0xb8280,30468,0x9b8400,18432
.long 0x5a7000,0xb50800,14,6144
.zero 48
.long 0x9b5800,30360,9,0x1f6020,6044,0xf6000,0xf7004,0x7f7000,42908,0xb02c0,0x860580,68352,0xb4280,30336,0x9b4000,19456
.long 0x5c7000,0xb58400,14,6208
.zero 48
.long 0x9bdc00,30620,9,0x1f7020,6016,0xf6000,0xf7008,0x7f7800,47004,0xb82c0,0x8605c0,68352,0xbc280,30596,0x9bc400,19456
.long 0x5e7000,0xb58c00,14,6208
.zero 48
.long 0xa34000,34432,9,0x234020,6620,0x136000,0x136004,0x836000,43416,0x130200,0x800980,71680,0x130200,34304,0xa30000,16384
.long 0x50f000,0xb40000,30,6656
.zero 48
.long 0xa3c400,34692,9,0x235020,6588,0x136000,0x136008,0x836800,47512,0x138200,0x8009c0,71680,0x138200,34564,0xa38400,16384
.long 0x52f000,0xb40800,30,6656
.zero 48
.long 0xa34800,34440,9,0x236020,6556,0x136000,0x137004,0x837000,43420,0x130240,0x820980,71936,0x134200,34432,0xa34000,17408
.long 0x54f000,0xb48400,30,6720
.zero 48
.long 0xa3cc00,34700,9,0x237020,6528,0x136000,0x137008,0x837800,47516,0x138240,0x8209c0,71936,0x13c200,34692,0xa3c400,17408
.long 0x56f000,0xb48c00,30,6720
.zero 48
.long 0xa35000,34448,9,0x274020,7132,0x176000,0x176004,0x876000,43928,0x130280,0x840980,72192,0x130280,34304,0xa30000,18432
.long 0x58f000,0xb50000,30,6144
.zero 48
.long 0xa3d400,34708,9,0x275020,7100,0x176000,0x176008,0x876800,48024,0x138280,0x8409c0,72192,0x138280,34564,0xa38400,18432
.long 0x5af000,0xb50800,30,6144
.zero 48
.long 0xa35800,34456,9,0x276020,7068,0x176000,0x177004,0x877000,43932,0x1302c0,0x860980,72448,0x134280,34432,0xa34000,19456
.long 0x5cf000,0xb58400,30,6208
.zero 48
.long 0xa3dc00,34716,9,0x277020,7040,0x176000,0x177008,0x877800,48028,0x1382c0,0x8609c0,72448,0x13c280,34692,0xa3c400,19456
.long 0x5ef000,0xb58c00,30,6208
.zero 48
.long 0xab4000,38528,9,0x2b4020,7644,0x1b6000,0x1b6004,0x8b6000,44440,0x1b0200,0x800d80,71680,0x1b0200,38400,0xab0000,16384
.long 0x517000,0xb40000,46,6656
.zero 48
.long 0xabc400,38788,9,0x2b5020,7612,0x1b6000,0x1b6008,0x8b6800,48536,0x1b8200,0x800dc0,71680,0x1b8200,38660,0xab8400,16384
.long 0x537000,0xb40800,46,6656
.zero 48
.long 0xab4800,38536,9,0x2b6020,7580,0x1b6000,0x1b7004,0x8b7000,44444,0x1b0240,0x820d80,71936,0x1b4200,38528,0xab4000,17408
.long 0x557000,0xb48400,46,6720
.zero 48
.long 0xabcc00,38796,9,0x2b7020,7552,0x1b6000,0x1b7008,0x8b7800,48540,0x1b8240,0x820dc0,71936,0x1bc200,38788,0xabc400,17408
.long 0x577000,0xb48c00,46,6720
.zero 48
.long 0xab5000,38544,9,0x2f4020,8156,0x1f6000,0x1f6004,0x8f6000,44952,0x1b0280,0x840d80,72192,0x1b0280,38400,0xab0000,18432
.long 0x597000,0xb50000,46,6144
.zero 48
.long 0xabd400,38804,9,0x2f5020,8124,0x1f6000,0x1f6008,0x8f6800,49048,0x1b8280,0x840dc0,72192,0x1b8280,38660,0xab8400,18432
.long 0x5b7000,0xb50800,46,6144
.zero 48
.long 0xab5800,38552,9,0x2f6020,8092,0x1f6000,0x1f7004,0x8f7000,44956,0x1b02c0,0x860d80,72448,0x1b4280,38528,0xab4000,19456
.long 0x5d7000,0xb58400,46,6208
.zero 48
.long 0xabdc00,38812,9,0x2f7020,8064,0x1f6000,0x1f7008,0x8f7800,49052,0x1b82c0,0x860dc0,72448,0x1bc280,38788,0xabc400,19456
.long 0x5f7000,0xb58c00,46,6208
.zero 48
.long 0x944000,26752,9,0x138000,4572,0x38000,0x38004,0x738000,41376,0x40200,0x800200,43008,0x40200,26624,0x940000,16384
.long 0x500000,0xb40000,0,6656
.zero 48
.long 0x94c400,27012,9,0x139000,4540,0x38000,0x38008,0x738800,45472,0x48200,0x800240,43008,0x48200,26884,0x948400,16384
.long 0x520000,0xb40800,0,6656
.zero 48
.long 0x944800,26760,9,0x13a000,4508,0x38000,0x39004,0x739000,41380,0x40240,0x820200,43264,0x44200,26752,0x944000,17408
.long 0x540000,0xb48400,0,6720
.zero 48
.long 0x94cc00,27020,9,0x13b000,4480,0x38000,0x39008,0x739800,45476,0x48240,0x820240,43264,0x4c200,27012,0x94c400,17408
.long 0x560000,0xb48c00,0,6720
.zero 48
.long 0x945000,26768,9,0x178000,5084,0x78000,0x78004,0x778000,41888,0x40280,0x840200,43520,0x40280,26624,0x940000,18432
.long 0x580000,0xb50000,0,6144
.zero 48
.long 0x94d400,27028,9,0x179000,5052,0x78000,0x78008,0x778800,45984,0x48280,0x840240,43520,0x48280,26884,0x948400,18432
.long 0x5a0000,0xb50800,0,6144
.zero 48
.long 0x945800,26776,9,0x17a000,5020,0x78000,0x79004,0x779000,41892,0x402c0,0x860200,43776,0x44280,26752,0x944000,19456
.long 0x5c0000,0xb58400,0,6208
.zero 48
.long 0x94dc00,27036,9,0x17b000,4992,0x78000,0x79008,0x779800,45988,0x482c0,0x860240,43776,0x4c280,27012,0x94c400,19456
.long 0x5e0000,0xb58c00,0,6208
.zero 48
.long 0x9c4000,30848,9,0x1b8000,5596,0xb8000,0xb8004,0x7b8000,42400,0xc0200,0x800600,43008,0xc0200,30720,0x9c0000,16384
.long 0x508000,0xb40000,16,6656
.zero 48
.long 0x9cc400,31108,9,0x1b9000,5564,0xb8000,0xb8008,0x7b8800,46496,0xc8200,0x800640,43008,0xc8200,30980,0x9c8400,16384
.long 0x528000,0xb40800,16,6656
.zero 48
.long 0x9c4800,30856,9,0x1ba000,5532,0xb8000,0xb9004,0x7b9000,42404,0xc0240,0x820600,43264,0xc4200,30848,0x9c4000,17408
.long 0x548000,0xb48400,16,6720
.zero 48
.long 0x9ccc00,31116,9,0x1bb000,5504,0xb8000,0xb9008,0x7b9800,46500,0xc8240,0x820640,43264,0xcc200,31108,0x9cc400,17408
.long 0x568000,0xb48c00,16,6720
.zero 48
.long 0x9c5000,30864,9,0x1f8000,6108,0xf8000,0xf8004,0x7f8000,42912,0xc0280,0x840600,43520,0xc0280,30720,0x9c0000,18432
.long 0x588000,0xb50000,16,6144
.zero 48
.long 0x9cd400,31124,9,0x1f9000,6076,0xf8000,0xf8008,0x7f8800,47008,0xc8280,0x840640,43520,0xc8280,30980,0x9c8400,18432
.long 0x5a8000,0xb50800,16,6144
.zero 48
.long 0x9c5800,30872,9,0x1fa000,6044,0xf8000,0xf9004,0x7f9000,42916,0xc02c0,0x860600,43776,0xc4280,30848,0x9c4000,19456
.long 0x5c8000,0xb58400,16,6208
.zero 48
.long 0x9cdc00,31132,9,0x1fb000,6016,0xf8000,0xf9008,0x7f9800,47012,0xc82c0,0x860640,43776,0xcc280,31108,0x9cc400,19456
.long 0x5e8000,0xb58c00,16,6208
.zero 48
.long 0xa44000,34944,9,0x238000,6620,0x138000,0x138004,0x838000,43424,0x140200,0x800a00,47104,0x140200,34816,0xa40000,16384
.long 0x510000,0xb40000,32,6656
.zero 48
.long 0xa4c400,35204,9,0x239000,6588,0x138000,0x138008,0x838800,47520,0x148200,0x800a40,47104,0x148200,35076,0xa48400,16384
.long 0x530000,0xb40800,32,6656
.zero 48
.long 0xa44800,34952,9,0x23a000,6556,0x138000,0x139004,0x839000,43428,0x140240,0x820a00,47360,0x144200,34944,0xa44000,17408
.long 0x550000,0xb48400,32,6720
.zero 48
.long 0xa4cc00,35212,9,0x23b000,6528,0x138000,0x139008,0x839800,47524,0x148240,0x820a40,47360,0x14c200,35204,0xa4c400,17408
.long 0x570000,0xb48c00,32,6720
.zero 48
.long 0xa45000,34960,9,0x278000,7132,0x178000,0x178004,0x878000,43936,0x140280,0x840a00,47616,0x140280,34816,0xa40000,18432
.long 0x590000,0xb50000,32,6144
.zero 48
.long 0xa4d400,35220,9,0x279000,7100,0x178000,0x178008,0x878800,48032,0x148280,0x840a40,47616,0x148280,35076,0xa48400,18432
.long 0x5b0000,0xb50800,32,6144
.zero 48
.long 0xa45800,34968,9,0x27a000,7068,0x178000,0x179004,0x879000,43940,0x1402c0,0x860a00,47872,0x144280,34944,0xa44000,19456
.long 0x5d0000,0xb58400,32,6208
.zero 48
.long 0xa4dc00,35228,9,0x27b000,7040,0x178000,0x179008,0x879800,48036,0x1482c0,0x860a40,47872,0x14c280,35204,0xa4c400,19456
.long 0x5f0000,0xb58c00,32,6208
.zero 48
.long 0xac4000,39040,9,0x2b8000,7644,0x1b8000,0x1b8004,0x8b8000,44448,0x1c0200,0x800e00,47104,0x1c0200,38912,0xac0000,16384
.long 0x518000,0xb40000,48,6656
.zero 48
.long 0xacc400,39300,9,0x2b9000,7612,0x1b8000,0x1b8008,0x8b8800,48544,0x1c8200,0x800e40,47104,0x1c8200,39172,0xac8400,16384
.long 0x538000,0xb40800,48,6656
.zero 48
.long 0xac4800,39048,9,0x2ba000,7580,0x1b8000,0x1b9004,0x8b9000,44452,0x1c0240,0x820e00,47360,0x1c4200,39040,0xac4000,17408
.long 0x558000,0xb48400,48,6720
.zero 48
.long 0xaccc00,39308,9,0x2bb000,7552,0x1b8000,0x1b9008,0x8b9800,48548,0x1c8240,0x820e40,47360,0x1cc200,39300,0xacc400,17408
.long 0x578000,0xb48c00,48,6720
.zero 48
.long 0xac5000,39056,9,0x2f8000,8156,0x1f8000,0x1f8004,0x8f8000,44960,0x1c0280,0x840e00,47616,0x1c0280,38912,0xac0000,18432
.long 0x598000,0xb50000,48,6144
.zero 48
.long 0xacd400,39316,9,0x2f9000,8124,0x1f8000,0x1f8008,0x8f8800,49056,0x1c8280,0x840e40,47616,0x1c8280,39172,0xac8400,18432
.long 0x5b8000,0xb50800,48,6144
.zero 48
.long 0xac5800,39064,9,0x2fa000,8092,0x1f8000,0x1f9004,0x8f9000,44964,0x1c02c0,0x860e00,47872,0x1c4280,39040,0xac4000,19456
.long 0x5d8000,0xb58400,48,6208
.zero 48
.long 0xacdc00,39324,9,0x2fb000,8064,0x1f8000,0x1f9008,0x8f9800,49060,0x1c82c0,0x860e40,47872,0x1cc280,39300,0xacc400,19456
.long 0x5f8000,0xb58c00,48,6208
.zero 48
.long 0x954000,27264,9,0x138020,4572,0x3a000,0x3a004,0x73a000,41384,0x50200,0x800280,51200,0x50200,27136,0x950000,16384
.long 0x501000,0xb40000,2,6656
.zero 48
.long 0x95c400,27524,9,0x139020,4540,0x3a000,0x3a008,0x73a800,45480,0x58200,0x8002c0,51200,0x58200,27396,0x958400,16384
.long 0x521000,0xb40800,2,6656
.zero 48
.long 0x954800,27272,9,0x13a020,4508,0x3a000,0x3b004,0x73b000,41388,0x50240,0x820280,51456,0x54200,27264,0x954000,17408
.long 0x541000,0xb48400,2,6720
.zero 48
.long 0x95cc00,27532,9,0x13b020,4480,0x3a000,0x3b008,0x73b800,45484,0x58240,0x8202c0,51456,0x5c200,27524,0x95c400,17408
.long 0x561000,0xb48c00,2,6720
.zero 48
.long 0x955000,27280,9,0x178020,5084,0x7a000,0x7a004,0x77a000,41896,0x50280,0x840280,51712,0x50280,27136,0x950000,18432
.long 0x581000,0xb50000,2,6144
.zero 48
.long 0x95d400,27540,9,0x179020,5052,0x7a000,0x7a008,0x77a800,45992,0x58280,0x8402c0,51712,0x58280,27396,0x958400,18432
.long 0x5a1000,0xb50800,2,6144
.zero 48
.long 0x955800,27288,9,0x17a020,5020,0x7a000,0x7b004,0x77b000,41900,0x502c0,0x860280,51968,0x54280,27264,0x954000,19456
.long 0x5c1000,0xb58400,2,6208
.zero 48
.long 0x95dc00,27548,9,0x17b020,4992,0x7a000,0x7b008,0x77b800,45996,0x582c0,0x8602c0,51968,0x5c280,27524,0x95c400,19456
.long 0x5e1000,0xb58c00,2,6208
.zero 48
.long 0x9d4000,31360,9,0x1b8020,5596,0xba000,0xba004,0x7ba000,42408,0xd0200,0x800680,51200,0xd0200,31232,0x9d0000,16384
.long 0x509000,0xb40000,18,6656
.zero 48
.long 0x9dc400,31620,9,0x1b9020,5564,0xba000,0xba008,0x7ba800,46504,0xd8200,0x8006c0,51200,0xd8200,31492,0x9d8400,16384
.long 0x529000,0xb40800,18,6656
.zero 48
.long 0x9d4800,31368,9,0x1ba020,5532,0xba000,0xbb004,0x7bb000,42412,0xd0240,0x820680,51456,0xd4200,31360,0x9d4000,17408
.long 0x549000,0xb48400,18,6720
.zero 48
.long 0x9dcc00,31628,9,0x1bb020,5504,0xba000,0xbb008,0x7bb800,46508,0xd8240,0x8206c0,51456,0xdc200,31620,0x9dc400,17408
.long 0x569000,0xb48c00,18,6720
.zero 48
.long 0x9d5000,31376,9,0x1f8020,6108,0xfa000,0xfa004,0x7fa000,42920,0xd0280,0x840680,51712,0xd0280,31232,0x9d0000,18432
.long 0x589000,0xb50000,18,6144
.zero 48
.long 0x9dd400,31636,9,0x1f9020,6076,0xfa000,0xfa008,0x7fa800,47016,0xd8280,0x8406c0,51712,0xd8280,31492,0x9d8400,18432
.long 0x5a9000,0xb50800,18,6144
.zero 48
.long 0x9d5800,31384,9,0x1fa020,6044,0xfa000,0xfb004,0x7fb000,42924,0xd02c0,0x860680,51968,0xd4280,31360,0x9d4000,19456
.long 0x5c9000,0xb58400,18,6208
.zero 48
.long 0x9ddc00,31644,9,0x1fb020,6016,0xfa000,0xfb008,0x7fb800,47020,0xd82c0,0x8606c0,51968,0xdc280,31620,0x9dc400,19456
.long 0x5e9000,0xb58c00,18,6208
.zero 48
.long 0xa54000,35456,9,0x238020,6620,0x13a000,0x13a004,0x83a000,43432,0x150200,0x800a80,55296,0x150200,35328,0xa50000,16384
.long 0x511000,0xb40000,34,6656
.zero 48
.long 0xa5c400,35716,9,0x239020,6588,0x13a000,0x13a008,0x83a800,47528,0x158200,0x800ac0,55296,0x158200,35588,0xa58400,16384
.long 0x531000,0xb40800,34,6656
.zero 48
.long 0xa54800,35464,9,0x23a020,6556,0x13a000,0x13b004,0x83b000,43436,0x150240,0x820a80,55552,0x154200,35456,0xa54000,17408
.long 0x551000,0xb48400,34,6720
.zero 48
.long 0xa5cc00,35724,9,0x23b020,6528,0x13a000,0x13b008,0x83b800,47532,0x158240,0x820ac0,55552,0x15c200,35716,0xa5c400,17408
.long 0x571000,0xb48c00,34,6720
.zero 48
.long 0xa55000,35472,9,0x278020,7132,0x17a000,0x17a004,0x87a000,43944,0x150280,0x840a80,55808,0x150280,35328,0xa50000,18432
.long 0x591000,0xb50000,34,6144
.zero 48
.long 0xa5d400,35732,9,0x279020,7100,0x17a000,0x17a008,0x87a800,48040,0x158280,0x840ac0,55808,0x158280,35588,0xa58400,18432
.long 0x5b1000,0xb50800,34,6144
.zero 48
.long 0xa55800,35480,9,0x27a020,7068,0x17a000,0x17b004,0x87b000,43948,0x1502c0,0x860a80,56064,0x154280,35456,0xa54000,19456
.long 0x5d1000,0xb58400,34,6208
.zero 48
.long 0xa5dc00,35740,9,0x27b020,7040,0x17a000,0x17b008,0x87b800,48044,0x1582c0,0x860ac0,56064,0x15c280,35716,0xa5c400,19456
.long 0x5f1000,0xb58c00,34,6208
.zero 48
.long 0xad4000,39552,9,0x2b8020,7644,0x1ba000,0x1ba004,0x8ba000,44456,0x1d0200,0x800e80,55296,0x1d0200,39424,0xad0000,16384
.long 0x519000,0xb40000,50,6656
.zero 48
.long 0xadc400,39812,9,0x2b9020,7612,0x1ba000,0x1ba008,0x8ba800,48552,0x1d8200,0x800ec0,55296,0x1d8200,39684,0xad8400,16384
.long 0x539000,0xb40800,50,6656
.zero 48
.long 0xad4800,39560,9,0x2ba020,7580,0x1ba000,0x1bb004,0x8bb000,44460,0x1d0240,0x820e80,55552,0x1d4200,39552,0xad4000,17408
.long 0x559000,0xb48400,50,6720
.zero 48
.long 0xadcc00,39820,9,0x2bb020,7552,0x1ba000,0x1bb008,0x8bb800,48556,0x1d8240,0x820ec0,55552,0x1dc200,39812,0xadc400,17408
.long 0x579000,0xb48c00,50,6720
.zero 48
.long 0xad5000,39568,9,0x2f8020,8156,0x1fa000,0x1fa004,0x8fa000,44968,0x1d0280,0x840e80,55808,0x1d0280,39424,0xad0000,18432
.long 0x599000,0xb50000,50,6144
.zero 48
.long 0xadd400,39828,9,0x2f9020,8124,0x1fa000,0x1fa008,0x8fa800,49064,0x1d8280,0x840ec0,55808,0x1d8280,39684,0xad8400,18432
.long 0x5b9000,0xb50800,50,6144
.zero 48
.long 0xad5800,39576,9,0x2fa020,8092,0x1fa000,0x1fb004,0x8fb000,44972,0x1d02c0,0x860e80,56064,0x1d4280,39552,0xad4000,19456
.long 0x5d9000,0xb58400,50,6208
.zero 48
.long 0xaddc00,39836,9,0x2fb020,8064,0x1fa000,0x1fb008,0x8fb800,49068,0x1d82c0,0x860ec0,56064,0x1dc280,39812,0xadc400,19456
.long 0x5f9000,0xb58c00,50,6208
.zero 48
.long 0x964000,27776,9,0x13c000,4572,0x3c000,0x3c004,0x73c000,41392,0x60200,0x800300,59392,0x60200,27648,0x960000,16384
.long 0x502000,0xb40000,4,6656
.zero 48
.long 0x96c400,28036,9,0x13d000,4540,0x3c000,0x3c008,0x73c800,45488,0x68200,0x800340,59392,0x68200,27908,0x968400,16384
.long 0x522000,0xb40800,4,6656
.zero 48
.long 0x964800,27784,9,0x13e000,4508,0x3c000,0x3d004,0x73d000,41396,0x60240,0x820300,59648,0x64200,27776,0x964000,17408
.long 0x542000,0xb48400,4,6720
.zero 48
.long 0x96cc00,28044,9,0x13f000,4480,0x3c000,0x3d008,0x73d800,45492,0x68240,0x820340,59648,0x6c200,28036,0x96c400,17408
.long 0x562000,0xb48c00,4,6720
.zero 48
.long 0x965000,27792,9,0x17c000,5084,0x7c000,0x7c004,0x77c000,41904,0x60280,0x840300,59904,0x60280,27648,0x960000,18432
.long 0x582000,0xb50000,4,6144
.zero 48
.long 0x96d400,28052,9,0x17d000,5052,0x7c000,0x7c008,0x77c800,46000,0x68280,0x840340,59904,0x68280,27908,0x968400,18432
.long 0x5a2000,0xb50800,4,6144
.zero 48
.long 0x965800,27800,9,0x17e000,5020,0x7c000,0x7d004,0x77d000,41908,0x602c0,0x860300,60160,0x64280,27776,0x964000,19456
.long 0x5c2000,0xb58400,4,6208
.zero 48
.long 0x96dc00,28060,9,0x17f000,4992,0x7c000,0x7d008,0x77d800,46004,0x682c0,0x860340,60160,0x6c280,28036,0x96c400,19456
.long 0x5e2000,0xb58c00,4,6208
.zero 48
.long 0x9e4000,31872,9,0x1bc000,5596,0xbc000,0xbc004,0x7bc000,42416,0xe0200,0x800700,59392,0xe0200,31744,0x9e0000,16384
.long 0x50a000,0xb40000,20,6656
.zero 48
.long 0x9ec400,32132,9,0x1bd000,5564,0xbc000,0xbc008,0x7bc800,46512,0xe8200,0x800740,59392,0xe8200,32004,0x9e8400,16384
.long 0x52a000,0xb40800,20,6656
.zero 48
.long 0x9e4800,31880,9,0x1be000,5532,0xbc000,0xbd004,0x7bd000,42420,0xe0240,0x820700,59648,0xe4200,31872,0x9e4000,17408
.long 0x54a000,0xb48400,20,6720
.zero 48
.long 0x9ecc00,32140,9,0x1bf000,5504,0xbc000,0xbd008,0x7bd800,46516,0xe8240,0x820740,59648,0xec200,32132,0x9ec400,17408
.long 0x56a000,0xb48c00,20,6720
.zero 48
.long 0x9e5000,31888,9,0x1fc000,6108,0xfc000,0xfc004,0x7fc000,42928,0xe0280,0x840700,59904,0xe0280,31744,0x9e0000,18432
.long 0x58a000,0xb50000,20,6144
.zero 48
.long 0x9ed400,32148,9,0x1fd000,6076,0xfc000,0xfc008,0x7fc800,47024,0xe8280,0x840740,59904,0xe8280,32004,0x9e8400,18432
.long 0x5aa000,0xb50800,20,6144
.zero 48
.long 0x9e5800,31896,9,0x1fe000,6044,0xfc000,0xfd004,0x7fd000,42932,0xe02c0,0x860700,60160,0xe4280,31872,0x9e4000,19456
.long 0x5ca000,0xb58400,20,6208
.zero 48
.long 0x9edc00,32156,9,0x1ff000,6016,0xfc000,0xfd008,0x7fd800,47028,0xe82c0,0x860740,60160,0xec280,32132,0x9ec400,19456
.long 0x5ea000,0xb58c00,20,6208
.zero 48
.long 0xa64000,35968,9,0x23c000,6620,0x13c000,0x13c004,0x83c000,43440,0x160200,0x800b00,63488,0x160200,35840,0xa60000,16384
.long 0x512000,0xb40000,36,6656
.zero 48
.long 0xa6c400,36228,9,0x23d000,6588,0x13c000,0x13c008,0x83c800,47536,0x168200,0x800b40,63488,0x168200,36100,0xa68400,16384
.long 0x532000,0xb40800,36,6656
.zero 48
.long 0xa64800,35976,9,0x23e000,6556,0x13c000,0x13d004,0x83d000,43444,0x160240,0x820b00,63744,0x164200,35968,0xa64000,17408
.long 0x552000,0xb48400,36,6720
.zero 48
.long 0xa6cc00,36236,9,0x23f000,6528,0x13c000,0x13d008,0x83d800,47540,0x168240,0x820b40,63744,0x16c200,36228,0xa6c400,17408
.long 0x572000,0xb48c00,36,6720
.zero 48
.long 0xa65000,35984,9,0x27c000,7132,0x17c000,0x17c004,0x87c000,43952,0x160280,0x840b00,64000,0x160280,35840,0xa60000,18432
.long 0x592000,0xb50000,36,6144
.zero 48
.long 0xa6d400,36244,9,0x27d000,7100,0x17c000,0x17c008,0x87c800,48048,0x168280,0x840b40,64000,0x168280,36100,0xa68400,18432
.long 0x5b2000,0xb50800,36,6144
.zero 48
.long 0xa65800,35992,9,0x27e000,7068,0x17c000,0x17d004,0x87d000,43956,0x1602c0,0x860b00,64256,0x164280,35968,0xa64000,19456
.long 0x5d2000,0xb58400,36,6208
.zero 48
.long 0xa6dc00,36252,9,0x27f000,7040,0x17c000,0x17d008,0x87d800,48052,0x1682c0,0x860b40,64256,0x16c280,36228,0xa6c400,19456
.long 0x5f2000,0xb58c00,36,6208
.zero 48
.long 0xae4000,40064,9,0x2bc000,7644,0x1bc000,0x1bc004,0x8bc000,44464,0x1e0200,0x800f00,63488,0x1e0200,39936,0xae0000,16384
.long 0x51a000,0xb40000,52,6656
.zero 48
.long 0xaec400,40324,9,0x2bd000,7612,0x1bc000,0x1bc008,0x8bc800,48560,0x1e8200,0x800f40,63488,0x1e8200,40196,0xae8400,16384
.long 0x53a000,0xb40800,52,6656
.zero 48
.long 0xae4800,40072,9,0x2be000,7580,0x1bc000,0x1bd004,0x8bd000,44468,0x1e0240,0x820f00,63744,0x1e4200,40064,0xae4000,17408
.long 0x55a000,0xb48400,52,6720
.zero 48
.long 0xaecc00,40332,9,0x2bf000,7552,0x1bc000,0x1bd008,0x8bd800,48564,0x1e8240,0x820f40,63744,0x1ec200,40324,0xaec400,17408
.long 0x57a000,0xb48c00,52,6720
.zero 48
.long 0xae5000,40080,9,0x2fc000,8156,0x1fc000,0x1fc004,0x8fc000,44976,0x1e0280,0x840f00,64000,0x1e0280,39936,0xae0000,18432
.long 0x59a000,0xb50000,52,6144
.zero 48
.long 0xaed400,40340,9,0x2fd000,8124,0x1fc000,0x1fc008,0x8fc800,49072,0x1e8280,0x840f40,64000,0x1e8280,40196,0xae8400,18432
.long 0x5ba000,0xb50800,52,6144
.zero 48
.long 0xae5800,40088,9,0x2fe000,8092,0x1fc000,0x1fd004,0x8fd000,44980,0x1e02c0,0x860f00,64256,0x1e4280,40064,0xae4000,19456
.long 0x5da000,0xb58400,52,6208
.zero 48
.long 0xaedc00,40348,9,0x2ff000,8064,0x1fc000,0x1fd008,0x8fd800,49076,0x1e82c0,0x860f40,64256,0x1ec280,40324,0xaec400,19456
.long 0x5fa000,0xb58c00,52,6208
.zero 48
.long 0x974000,28288,9,0x13c020,4572,0x3e000,0x3e004,0x73e000,41400,0x70200,0x800380,67584,0x70200,28160,0x970000,16384
.long 0x503000,0xb40000,6,6656
.zero 48
.long 0x97c400,28548,9,0x13d020,4540,0x3e000,0x3e008,0x73e800,45496,0x78200,0x8003c0,67584,0x78200,28420,0x978400,16384
.long 0x523000,0xb40800,6,6656
.zero 48
.long 0x974800,28296,9,0x13e020,4508,0x3e000,0x3f004,0x73f000,41404,0x70240,0x820380,67840,0x74200,28288,0x974000,17408
.long 0x543000,0xb48400,6,6720
.zero 48
.long 0x97cc00,28556,9,0x13f020,4480,0x3e000,0x3f008,0x73f800,45500,0x78240,0x8203c0,67840,0x7c200,28548,0x97c400,17408
.long 0x563000,0xb48c00,6,6720
.zero 48
.long 0x975000,28304,9,0x17c020,5084,0x7e000,0x7e004,0x77e000,41912,0x70280,0x840380,68096,0x70280,28160,0x970000,18432
.long 0x583000,0xb50000,6,6144
.zero 48
.long 0x97d400,28564,9,0x17d020,5052,0x7e000,0x7e008,0x77e800,46008,0x78280,0x8403c0,68096,0x78280,28420,0x978400,18432
.long 0x5a3000,0xb50800,6,6144
.zero 48
.long 0x975800,28312,9,0x17e020,5020,0x7e000,0x7f004,0x77f000,41916,0x702c0,0x860380,68352,0x74280,28288,0x974000,19456
.long 0x5c3000,0xb58400,6,6208
.zero 48
.long 0x97dc00,28572,9,0x17f020,4992,0x7e000,0x7f008,0x77f800,46012,0x782c0,0x8603c0,68352,0x7c280,28548,0x97c400,19456
.long 0x5e3000,0xb58c00,6,6208
.zero 48
.long 0x9f4000,32384,9,0x1bc020,5596,0xbe000,0xbe004,0x7be000,42424,0xf0200,0x800780,67584,0xf0200,32256,0x9f0000,16384
.long 0x50b000,0xb40000,22,6656
.zero 48
.long 0x9fc400,32644,9,0x1bd020,5564,0xbe000,0xbe008,0x7be800,46520,0xf8200,0x8007c0,67584,0xf8200,32516,0x9f8400,16384
.long 0x52b000,0xb40800,22,6656
.zero 48
.long 0x9f4800,32392,9,0x1be020,5532,0xbe000,0xbf004,0x7bf000,42428,0xf0240,0x820780,67840,0xf4200,32384,0x9f4000,17408
.long 0x54b000,0xb48400,22,6720
.zero 48
.long 0x9fcc00,32652,9,0x1bf020,5504,0xbe000,0xbf008,0x7bf800,46524,0xf8240,0x8207c0,67840,0xfc200,32644,0x9fc400,17408
.long 0x56b000,0xb48c00,22,6720
.zero 48
.long 0x9f5000,32400,9,0x1fc020,6108,0xfe000,0xfe004,0x7fe000,42936,0xf0280,0x840780,68096,0xf0280,32256,0x9f0000,18432
.long 0x58b000,0xb50000,22,6144
.zero 48
.long 0x9fd400,32660,9,0x1fd020,6076,0xfe000,0xfe008,0x7fe800,47032,0xf8280,0x8407c0,68096,0xf8280,32516,0x9f8400,18432
.long 0x5ab000,0xb50800,22,6144
.zero 48
.long 0x9f5800,32408,9,0x1fe020,6044,0xfe000,0xff004,0x7ff000,42940,0xf02c0,0x860780,68352,0xf4280,32384,0x9f4000,19456
.long 0x5cb000,0xb58400,22,6208
.zero 48
.long 0x9fdc00,32668,9,0x1ff020,6016,0xfe000,0xff008,0x7ff800,47036,0xf82c0,0x8607c0,68352,0xfc280,32644,0x9fc400,19456
.long 0x5eb000,0xb58c00,22,6208
.zero 48
.long 0xa74000,36480,9,0x23c020,6620,0x13e000,0x13e004,0x83e000,43448,0x170200,0x800b80,71680,0x170200,36352,0xa70000,16384
.long 0x513000,0xb40000,38,6656
.zero 48
.long 0xa7c400,36740,9,0x23d020,6588,0x13e000,0x13e008,0x83e800,47544,0x178200,0x800bc0,71680,0x178200,36612,0xa78400,16384
.long 0x533000,0xb40800,38,6656
.zero 48
.long 0xa74800,36488,9,0x23e020,6556,0x13e000,0x13f004,0x83f000,43452,0x170240,0x820b80,71936,0x174200,36480,0xa74000,17408
.long 0x553000,0xb48400,38,6720
.zero 48
.long 0xa7cc00,36748,9,0x23f020,6528,0x13e000,0x13f008,0x83f800,47548,0x178240,0x820bc0,71936,0x17c200,36740,0xa7c400,17408
.long 0x573000,0xb48c00,38,6720
.zero 48
.long 0xa75000,36496,9,0x27c020,7132,0x17e000,0x17e004,0x87e000,43960,0x170280,0x840b80,72192,0x170280,36352,0xa70000,18432
.long 0x593000,0xb50000,38,6144
.zero 48
.long 0xa7d400,36756,9,0x27d020,7100,0x17e000,0x17e008,0x87e800,48056,0x178280,0x840bc0,72192,0x178280,36612,0xa78400,18432
.long 0x5b3000,0xb50800,38,6144
.zero 48
.long 0xa75800,36504,9,0x27e020,7068,0x17e000,0x17f004,0x87f000,43964,0x1702c0,0x860b80,72448,0x174280,36480,0xa74000,19456
.long 0x5d3000,0xb58400,38,6208
.zero 48
.long 0xa7dc00,36764,9,0x27f020,7040,0x17e000,0x17f008,0x87f800,48060,0x1782c0,0x860bc0,72448,0x17c280,36740,0xa7c400,19456
.long 0x5f3000,0xb58c00,38,6208
.zero 48
.long 0xaf4000,40576,9,0x2bc020,7644,0x1be000,0x1be004,0x8be000,44472,0x1f0200,0x800f80,71680,0x1f0200,40448,0xaf0000,16384
.long 0x51b000,0xb40000,54,6656
.zero 48
.long 0xafc400,40836,9,0x2bd020,7612,0x1be000,0x1be008,0x8be800,48568,0x1f8200,0x800fc0,71680,0x1f8200,40708,0xaf8400,16384
.long 0x53b000,0xb40800,54,6656
.zero 48
.long 0xaf4800,40584,9,0x2be020,7580,0x1be000,0x1bf004,0x8bf000,44476,0x1f0240,0x820f80,71936,0x1f4200,40576,0xaf4000,17408
.long 0x55b000,0xb48400,54,6720
.zero 48
.long 0xafcc00,40844,9,0x2bf020,7552,0x1be000,0x1bf008,0x8bf800,48572,0x1f8240,0x820fc0,71936,0x1fc200,40836,0xafc400,17408
.long 0x57b000,0xb48c00,54,6720
.zero 48
.long 0xaf5000,40592,9,0x2fc020,8156,0x1fe000,0x1fe004,0x8fe000,44984,0x1f0280,0x840f80,72192,0x1f0280,40448,0xaf0000,18432
.long 0x59b000,0xb50000,54,6144
.zero 48
.long 0xafd400,40852,9,0x2fd020,8124,0x1fe000,0x1fe008,0x8fe800,49080,0x1f8280,0x840fc0,72192,0x1f8280,40708,0xaf8400,18432
.long 0x5bb000,0xb50800,54,6144
.zero 48
.long 0xaf5800,40600,9,0x2fe020,8092,0x1fe000,0x1ff004,0x8ff000,44988,0x1f02c0,0x860f80,72448,0x1f4280,40576,0xaf4000,19456
.long 0x5db000,0xb58400,54,6208
.zero 48
.long 0xafdc00,40860,9,0x2ff020,8064,0x1fe000,0x1ff008,0x8ff800,49084,0x1f82c0,0x860fc0,72448,0x1fc280,40836,0xafc400,19456
.long 0x5fb000,0xb58c00,54,6208
.zero 48
```
